```python
import torch

def _softmax(x, axis=-1):
    return torch.softmax(x, dim=axis)
def _gelu(x):
    return torch.nn.functional.gelu(x, approximate="tanh")
def _silu(x):
    return torch.nn.functional.silu(x)
def _sigmoid(x):
    return torch.sigmoid(x)
def _layernorm(x, axis=-1, eps=1e-5):
    m = x.mean(dim=axis, keepdim=True)
    v = x.var(dim=axis, keepdim=True, unbiased=False)
    return (x - m) / torch.sqrt(v + eps)
def _scatter_add(tgt, idx, src, axis=0):
    return tgt.clone().index_add_(axis, idx, src)
def _segment_sum(src, seg, n):
    out = torch.zeros((n,) + src.shape[1:], dtype=src.dtype)
    return out.index_add_(0, seg, src)
def _pad(x, pw):
    flat = tuple(v for pair in reversed(pw) for v in pair)
    return torch.nn.functional.pad(x, flat)

kernel_name = 'sequential_preLN__linear_attn_block__swiglu_ffn__prompt'

def setup_inputs():

    _w = (lambda a: (lambda t: t.to(torch.bfloat16) if t.is_floating_point() else t)(torch.as_tensor(a)))
    def _A_setup():
        B, S, D = 1, 2048, 576
        return {
            "x": _w((lambda *s: torch.randn(*s, dtype=torch.bfloat16) * 0.05)(B, S, D)),
            "wqkv": _w((lambda *s: torch.randn(*s, dtype=torch.bfloat16) * 0.05)(D, 3 * D)),
            "wo": _w((lambda *s: torch.randn(*s, dtype=torch.bfloat16) * 0.05)(D, D)),
        }
    _A_in = _A_setup()

    def _B_setup():
        B, S, D, F = 1, 2048, 576, 4608
        return {
            "x": _w((lambda *s: torch.randn(*s, dtype=torch.bfloat16) * 0.05)(B, S, D)),
            "w_gate": _w((lambda *s: torch.randn(*s, dtype=torch.bfloat16) * 0.05)(D, F)),
            "w_up": _w((lambda *s: torch.randn(*s, dtype=torch.bfloat16) * 0.05)(D, F)),
            "w_down": _w((lambda *s: torch.randn(*s, dtype=torch.bfloat16) * 0.05)(F, D)),
        }
    _B_in = _B_setup()

    return {
        "A_x": _A_in["x"],
        "A_wqkv": _A_in["wqkv"],
        "A_wo": _A_in["wo"],
        "B_x": _B_in["x"],
        "B_w_gate": _B_in["w_gate"],
        "B_w_up": _B_in["w_up"],
        "B_w_down": _B_in["w_down"],
    }

def reference(A_x, A_wqkv, A_wo, B_x, B_w_gate, B_w_up, B_w_down):
    def _A_ref(x, wqkv, wo):
        B, S, D = x.shape
        H = 32; Dh = D // H
        qkv = (lambda x, *d: x.permute(*d))((x @ wqkv).reshape(B, S, 3, H, Dh), 2, 0, 3, 1, 4)
        q, k, v = qkv[0], qkv[1], qkv[2]
        phi = lambda t: torch.where(t > 0, t + 1, torch.exp(t)) + 1e-6
        pq, pk = phi(q), phi(k)
        kv = torch.einsum("bhsd,bhse->bhde", pk, v)
        z = torch.einsum("bhsd->bhd", pk)
        num = torch.einsum("bhqd,bhde->bhqe", pq, kv)
        den = torch.einsum("bhqd,bhd->bhq", pq, z)[..., None] + 1e-6
        o = num / den
        return (lambda x, *d: x.permute(*d))(o, 0, 2, 1, 3).reshape(B, S, D) @ wo

    def _B_ref(x, w_gate, w_up, w_down):
        g = _silu(x @ w_gate)
        u = x @ w_up
        return (g * u) @ w_down

    x = A_x
    h = x + _A_ref(_layernorm(x, axis=-1), A_wqkv, A_wo)
    h2 = h + _B_ref(_layernorm(h, axis=-1), B_w_gate, B_w_up, B_w_down)
    return h2
```

```asm
; @launch kernel=k1_kernel grid=(256,1,1) block=(512,1,1) lds=151168
; @launch kernel=k2_kernel grid=(256,1,1) block=(512,1,1) lds=142912
; @launch kernel=k3_kernel grid=(256,1,1) block=(256,1,1) lds=149504
; @launch kernel=k4_kernel grid=(256,1,1) block=(256,1,1) lds=112640
; @launch kernel=k5_kernel grid=(576,1,1) block=(256,1,1) lds=0
.amdgcn_target "amdgcn-amd-amdhsa--gfx950"
.text
.globl k1_kernel
.p2align 8
.type k1_kernel,@function
k1_kernel:
    s_cmp_ge_u32 s2, 256
    s_cbranch_scc1 k1_kernel_end
    s_getpc_b64 s[16:17]
k1_kernel_pc:
    v_lshlrev_b32 v146, 7, v0
    v_min_u32 v146, k1_kernel_end-k1_kernel_pc, v146
    global_load_dword v147, v146, s[16:17]
    s_load_dwordx2 s[4:5], s[0:1], 72
    s_load_dwordx4 s[8:11], s[0:1], 0
    s_load_dwordx2 s[14:15], s[0:1], 64
    s_load_dwordx2 s[12:13], s[0:1], 16
    s_load_dwordx4 s[84:87], s[0:1], 32
    s_and_b32 s25, s2, 3
    s_lshl_b32 s25, s25, 2
    s_bfe_u32 s24, s2, 0x20003
    s_add_u32 s25, s25, s24
    s_bfe_u32 s24, s2, 0x10002
    s_lshl_b32 s24, s24, 3
    s_lshr_b32 s22, s2, 5
    s_add_u32 s24, s24, s22
    s_lshr_b32 s22, s2, 2
    s_and_b32 s23, s2, 3
    v_mov_b32 v1, v0
    v_lshrrev_b32 v2, 6, v0
    v_and_b32 v0, 63, v0
    v_readfirstlane_b32 s26, v2
    s_nop 0
    s_and_b32 s20, s26, 3
    s_lshr_b32 s21, s26, 2
    v_lshrrev_b32 v2, 4, v0
    v_and_b32 v3, 15, v0
    v_bfe_u32 v4, v0, 2, 2
    v_and_b32 v5, 3, v0
    v_lshlrev_b32 v6, 4, v0
    v_mov_b32 v7, 0x7f000000
    v_cmp_eq_u32 s[30:31], 0, v2
    v_mov_b32 v12, 0
    v_mov_b32 v13, 0
    v_mov_b32 v14, 0
    v_mov_b32 v15, 0
    v_lshlrev_b32 v9, 2, v1
    v_add_u32 v9, 149504, v9
    v_cmp_gt_u32 vcc, 144, v1
    s_nop 0
    s_and_saveexec_b64 s[28:29], vcc
    ds_write_b32 v9, v12
    s_mov_b64 exec, s[28:29]
    s_mov_b32 s28, 0x11111112
    s_mov_b32 s29, 0x33333334
    s_mov_b32 s32, 0xe38e38f
    v_add_u32 v9, 0, v0
    v_lshrrev_b32 v10, 3, v9
    v_xor_b32 v11, v9, v10
    v_and_b32 v11, 7, v11
    v_mul_u32_u24 v10, 1152, v10
    v_lshl_add_u32 v16, v11, 4, v10
    v_mul_hi_u32 v10, v9, s28
    v_mul_u32_u24 v11, 15, v10
    v_sub_u32 v11, v9, v11
    v_mul_hi_u32 v8, v11, s29
    v_mul_u32_u24 v23, 5, v8
    v_sub_u32 v23, v11, v23
    v_mul_u32_u24 v10, 3456, v10
    v_mul_u32_u24 v8, 1152, v8
    v_lshlrev_b32 v23, 4, v23
    v_add3_u32 v18, v10, v8, v23
    v_add_u32 v9, 64, v0
    v_lshrrev_b32 v10, 3, v9
    v_xor_b32 v11, v9, v10
    v_and_b32 v11, 7, v11
    v_mul_u32_u24 v10, 1152, v10
    v_lshl_add_u32 v17, v11, 4, v10
    v_mul_hi_u32 v10, v9, s28
    v_mul_u32_u24 v11, 15, v10
    v_sub_u32 v11, v9, v11
    v_mul_hi_u32 v8, v11, s29
    v_mul_u32_u24 v23, 5, v8
    v_sub_u32 v23, v11, v23
    v_mul_u32_u24 v10, 3456, v10
    v_mul_u32_u24 v8, 1152, v8
    v_lshlrev_b32 v23, 4, v23
    v_add3_u32 v19, v10, v8, v23
    v_lshl_add_u32 v11, v2, 3, v4
    v_mul_u32_u24 v11, 240, v11
    v_lshl_add_u32 v11, v5, 3, v11
    s_and_b32 s27, s24, 1
    s_lshl_b32 s27, s27, 3
    s_add_u32 s27, s27, 16384
    s_mul_i32 s28, s21, 7680
    s_add_u32 s27, s27, s28
    v_add_u32 v24, s27, v11
    v_add_u32 v25, 63488, v24
    s_lshl_b32 s34, s26, 11
    s_lshl_b32 s27, s21, 2
    s_lshl_b32 s28, s20, 12
    s_lshl_b32 s29, s21, 11
    s_add_u32 s28, s28, s29
    v_add_u32 v9, s27, v2
    v_xor_b32 v9, v9, v3
    v_and_b32 v9, 7, v9
    v_lshlrev_b32 v9, 4, v9
    v_lshl_add_u32 v9, v3, 7, v9
    v_add_u32 v26, s28, v9
    v_xor_b32 v27, 0x800, v26
    v_add_u32 v28, 63488, v26
    v_add_u32 v29, 63488, v27
    s_waitcnt lgkmcnt(0)
    s_mov_b32 s64, s8
    s_mov_b32 s65, s9
    s_mov_b32 s66, 0x240000
    s_mov_b32 s67, 0x20000
    s_mov_b32 s68, s10
    s_mov_b32 s69, s11
    s_mov_b32 s70, 0x1e6000
    s_mov_b32 s71, 0x20000
    s_mov_b32 s76, s14
    s_mov_b32 s77, s15
    s_mov_b32 s78, 0x100
    s_mov_b32 s79, 0x20000
    s_add_u32 s80, s4, 0x3100000
    s_addc_u32 s81, s5, 0
    s_mov_b32 s82, 0x1c000
    s_mov_b32 s83, 0x20000
    s_bfe_u32 s18, s2, 0x10002
    s_cmp_eq_u32 s18, 0
    s_cselect_b32 s18, s84, s86
    s_cselect_b32 s19, s85, s87
    s_add_u32 s84, s4, 0x10000
    s_addc_u32 s85, s5, 0
    s_mov_b32 s86, 0x9000
    s_mov_b32 s87, 0x20000
    s_lshl_b32 s32, s25, 7
    s_lshl_b32 s33, s26, 4
    s_add_u32 s32, s32, s33
    s_mul_i32 s32, s32, 1152
    s_mul_i32 s33, s26, 27648
    s_mul_i32 s35, s24, 72
    s_and_b32 s35, s35, 0xfffffff0
    s_add_u32 s33, s33, s35
    s_mul_i32 s35, s26, 1920
    s_add_u32 s35, s35, 16384
    s_add_u32 s37, s33, 0
    s_add_u32 m0, s35, 0
    s_nop 0
    buffer_load_dwordx4 v18, s[68:71], s37 offen lds
    s_add_u32 s36, s32, 0
    s_add_u32 m0, s34, 0
    s_nop 0
    buffer_load_dwordx4 v16, s[64:67], s36 offen lds
    s_add_u32 m0, s35, 1024
    s_mov_b32 exec_hi, 0xffffff
    buffer_load_dwordx4 v19, s[68:71], s37 offen lds
    s_mov_b64 exec, -1
    s_add_u32 m0, s34, 1024
    s_nop 0
    buffer_load_dwordx4 v17, s[64:67], s36 offen lds
    s_add_u32 s37, s33, 221184
    s_add_u32 m0, s35, 31744
    s_nop 0
    buffer_load_dwordx4 v18, s[68:71], s37 offen lds
    s_add_u32 s36, s32, 128
    s_add_u32 m0, s34, 31744
    s_nop 0
    buffer_load_dwordx4 v16, s[64:67], s36 offen lds
    s_add_u32 m0, s35, 32768
    s_mov_b32 exec_hi, 0xffffff
    buffer_load_dwordx4 v19, s[68:71], s37 offen lds
    s_mov_b64 exec, -1
    s_add_u32 m0, s34, 32768
    s_nop 0
    buffer_load_dwordx4 v17, s[64:67], s36 offen lds
    s_add_u32 s37, s33, 442368
    s_add_u32 m0, s35, 63488
    s_nop 0
    buffer_load_dwordx4 v18, s[68:71], s37 offen lds
    s_add_u32 s36, s32, 256
    s_add_u32 m0, s34, 63488
    s_nop 0
    buffer_load_dwordx4 v16, s[64:67], s36 offen lds
    s_add_u32 m0, s35, 64512
    s_mov_b32 exec_hi, 0xffffff
    buffer_load_dwordx4 v19, s[68:71], s37 offen lds
    s_mov_b64 exec, -1
    s_add_u32 m0, s34, 64512
    s_nop 0
    buffer_load_dwordx4 v17, s[64:67], s36 offen lds
    v_mov_b32 v11, 1
    s_lshl_b32 s29, s24, 2
    s_cmp_lg_u32 s26, 0
    s_cbranch_scc1 k1_kernel_notk_1
    v_lshlrev_b32 v9, 2, v0
    v_cmp_gt_u32 vcc, 36, v0
    s_nop 1
    v_cndmask_b32 v9, v7, v9, vcc
    s_mul_i32 s38, s2, 144
    buffer_store_dword v12, v9, s[84:87], s38 offen
    s_cmp_lg_u32 s25, 0
    s_cbranch_scc1 k1_kernel_notk_1
    s_mov_b64 exec, 1
    buffer_atomic_add v11, v12, s[76:79], s29 offen sc0 sc1
    s_mov_b64 exec, -1
k1_kernel_notk_1:
    s_mov_b32 s40, 1
    v_accvgpr_write_b32 a0, 0
    v_accvgpr_write_b32 a1, 0
    v_accvgpr_write_b32 a2, 0
    v_accvgpr_write_b32 a3, 0
    v_accvgpr_write_b32 a4, 0
    v_accvgpr_write_b32 a5, 0
    v_accvgpr_write_b32 a6, 0
    v_accvgpr_write_b32 a7, 0
    v_accvgpr_write_b32 a8, 0
    v_accvgpr_write_b32 a9, 0
    v_accvgpr_write_b32 a10, 0
    v_accvgpr_write_b32 a11, 0
    v_mov_b32 v32, 0x3f803f80
    v_mov_b32 v33, 0x3f803f80
    v_mov_b32 v34, 0x3f803f80
    v_mov_b32 v35, 0x3f803f80
    s_waitcnt lgkmcnt(0)
    s_waitcnt vmcnt(8)
    s_barrier
    ds_read_b128 v[40:43], v26 offset:0
    ds_read_b128 v[44:47], v27 offset:0
    ds_read_b64_tr_b16 a[28:29], v24 offset:0
    ds_read_b64_tr_b16 a[30:31], v24 offset:960
    ds_read_b64_tr_b16 a[32:33], v24 offset:32
    ds_read_b64_tr_b16 a[34:35], v24 offset:992
    ds_read_b64_tr_b16 a[36:37], v24 offset:64
    ds_read_b64_tr_b16 a[38:39], v24 offset:1024
    ds_read_b64_tr_b16 a[40:41], v24 offset:80
    ds_read_b64_tr_b16 a[42:43], v24 offset:1040
    ds_read_b64_tr_b16 a[44:45], v24 offset:112
    ds_read_b64_tr_b16 a[46:47], v24 offset:1072
    ds_read_b64_tr_b16 a[48:49], v24 offset:144
    ds_read_b64_tr_b16 a[50:51], v24 offset:1104
    ds_read_b64_tr_b16 a[52:53], v24 offset:160
    ds_read_b64_tr_b16 a[54:55], v24 offset:1120
    ds_read_b64_tr_b16 a[56:57], v24 offset:192
    ds_read_b64_tr_b16 a[58:59], v24 offset:1152
    s_waitcnt lgkmcnt(14)
    v_mfma_f32_16x16x32_bf16 v[56:59], a[28:31], v[40:43], 0
    v_mfma_f32_16x16x32_bf16 v[60:63], a[28:31], v[44:47], 0
    v_mfma_f32_16x16x32_bf16 a[12:15], v[32:35], v[40:43], 0
    v_mfma_f32_16x16x32_bf16 a[16:19], v[40:43], v[40:43], 0
    s_mov_b32 s38, 0x1c71c71d
    s_mov_b32 s39, 0x33333334
    v_mul_hi_u32 v20, v1, s38
    v_mul_u32_u24 v21, 9, v20
    v_sub_u32 v21, v1, v21
    v_mul_u32_u24 v20, 1152, v20
    v_lshl_add_u32 v20, v21, 7, v20
    v_cmp_gt_u32 vcc, 144, v1
    s_nop 1
    v_cndmask_b32 v20, v7, v20, vcc
    s_and_b32 s41, s2, 3
    s_lshl_b32 s41, s41, 9
    s_lshr_b32 s42, s2, 3
    s_lshl_b32 s43, s42, 4
    s_add_u32 s41, s41, s43
    s_mul_i32 s41, s41, 1152
    buffer_load_dword v147, v20, s[64:67], s41 offen
    v_subrev_u32 v20, 144, v1
    v_mul_hi_u32 v21, v20, s39
    v_mul_u32_u24 v23, 5, v21
    v_sub_u32 v23, v20, v23
    v_mul_u32_u24 v21, 1152, v21
    v_lshl_add_u32 v21, v23, 7, v21
    v_cmp_gt_u32 vcc, 270, v20
    s_nop 1
    v_cndmask_b32 v21, v7, v21, vcc
    s_mul_i32 s41, s42, 62208
    s_bfe_u32 s43, s2, 0x10002
    s_lshl_b32 s43, s43, 9
    s_add_u32 s41, s41, s43
    buffer_load_dword v147, v21, s[68:71], s41 offen
    ds_read_b64_tr_b16 a[60:61], v24 offset:224
    ds_read_b64_tr_b16 a[62:63], v24 offset:1184
    s_waitcnt lgkmcnt(14)
    v_mfma_f32_16x16x32_bf16 v[64:67], a[32:35], v[40:43], 0
    v_mfma_f32_16x16x32_bf16 v[68:71], a[32:35], v[44:47], 0
    v_mfma_f32_16x16x32_bf16 a[20:23], v[32:35], v[44:47], 0
    v_mfma_f32_16x16x32_bf16 a[24:27], v[44:47], v[44:47], 0
    s_add_u32 s37, s33, 663552
    s_add_u32 m0, s35, 95232
    s_nop 0
    buffer_load_dwordx4 v18, s[68:71], s37 offen lds
    s_add_u32 s36, s32, 384
    s_add_u32 m0, s34, 95232
    s_nop 0
    buffer_load_dwordx4 v16, s[64:67], s36 offen lds
    s_add_u32 m0, s35, 96256
    s_mov_b32 exec_hi, 0xffffff
    buffer_load_dwordx4 v19, s[68:71], s37 offen lds
    s_mov_b64 exec, -1
    s_add_u32 m0, s34, 96256
    s_nop 0
    buffer_load_dwordx4 v17, s[64:67], s36 offen lds
    s_mov_b32 s48, s12
    s_mov_b32 s49, s13
    s_mov_b32 s50, 0xa2000
    s_mov_b32 s51, 0x20000
    s_mul_i32 s38, s2, 162
    v_add_u32 v20, s38, v1
    s_mov_b32 s38, 0x38e38e4
    s_mov_b32 s39, 0x1c71c71d
    v_mul_hi_u32 v21, v20, s38
    v_mul_u32_u24 v22, 72, v21
    v_sub_u32 v22, v20, v22
    v_mul_hi_u32 v23, v22, s39
    v_mul_u32_u24 v30, 9, v23
    v_sub_u32 v22, v22, v30
    v_mul_u32_u24 v23, 576, v23
    v_add_u32 v23, v23, v21
    v_mul_u32_u24 v23, 144, v23
    v_lshl_add_u32 v23, v22, 4, v23
    v_lshlrev_b32 v20, 4, v20
    v_cmp_gt_u32 vcc, 162, v1
    s_nop 1
    v_cndmask_b32 v20, v7, v20, vcc
    v_cndmask_b32 v146, v7, v23, vcc
    buffer_load_dwordx4 v[128:131], v20, s[48:51], 0 offen
    s_waitcnt vmcnt(11)
    s_barrier
    ds_read_b128 v[48:51], v26 offset:31744
    ds_read_b128 v[52:55], v27 offset:31744
    ds_read_b64_tr_b16 a[64:65], v24 offset:31744
    ds_read_b64_tr_b16 a[66:67], v24 offset:32704
    s_waitcnt lgkmcnt(15)
    v_mfma_f32_16x16x32_bf16 v[72:75], a[36:39], v[40:43], 0
    v_mfma_f32_16x16x32_bf16 v[76:79], a[36:39], v[44:47], 0
    s_cmp_lg_u32 s20, 0
    s_cbranch_scc1 k1_kernel_nocs_2
    v_mfma_f32_16x16x32_bf16 a[0:3], v[32:35], a[28:31], a[0:3]
    v_mfma_f32_16x16x32_bf16 a[4:7], v[32:35], a[32:35], a[4:7]
    v_mfma_f32_16x16x32_bf16 a[8:11], v[32:35], a[36:39], a[8:11]
k1_kernel_nocs_2:
    ds_read_b64_tr_b16 a[68:69], v24 offset:31776
    ds_read_b64_tr_b16 a[70:71], v24 offset:32736
    s_waitcnt lgkmcnt(15)
    v_mfma_f32_16x16x32_bf16 v[80:83], v[40:43], a[40:43], 0
    v_mfma_f32_16x16x32_bf16 v[84:87], v[44:47], a[40:43], 0
    ds_read_b64_tr_b16 a[72:73], v24 offset:31808
    ds_read_b64_tr_b16 a[74:75], v24 offset:32768
    s_waitcnt lgkmcnt(15)
    v_mfma_f32_16x16x32_bf16 v[88:91], v[40:43], a[44:47], 0
    v_mfma_f32_16x16x32_bf16 v[92:95], v[44:47], a[44:47], 0
    ds_read_b64_tr_b16 a[76:77], v24 offset:31824
    ds_read_b64_tr_b16 a[78:79], v24 offset:32784
    s_waitcnt lgkmcnt(15)
    v_mfma_f32_16x16x32_bf16 v[96:99], v[40:43], a[48:51], 0
    v_mfma_f32_16x16x32_bf16 v[100:103], v[44:47], a[48:51], 0
    s_cmp_lg_u32 s20, 1
    s_cbranch_scc1 k1_kernel_nocs_3
    v_mfma_f32_16x16x32_bf16 a[0:3], v[32:35], a[40:43], a[0:3]
    v_mfma_f32_16x16x32_bf16 a[4:7], v[32:35], a[44:47], a[4:7]
    v_mfma_f32_16x16x32_bf16 a[8:11], v[32:35], a[48:51], a[8:11]
k1_kernel_nocs_3:
    ds_read_b64_tr_b16 a[80:81], v24 offset:31856
    ds_read_b64_tr_b16 a[82:83], v24 offset:32816
    s_waitcnt lgkmcnt(15)
    v_mfma_f32_16x16x32_bf16 v[104:107], v[40:43], a[52:55], 0
    v_mfma_f32_16x16x32_bf16 v[108:111], v[44:47], a[52:55], 0
    ds_read_b64_tr_b16 a[84:85], v24 offset:31888
    ds_read_b64_tr_b16 a[86:87], v24 offset:32848
    s_waitcnt lgkmcnt(15)
    v_mfma_f32_16x16x32_bf16 v[112:115], v[40:43], a[56:59], 0
    v_mfma_f32_16x16x32_bf16 v[116:119], v[44:47], a[56:59], 0
    ds_read_b64_tr_b16 a[88:89], v24 offset:31904
    ds_read_b64_tr_b16 a[90:91], v24 offset:32864
    s_waitcnt lgkmcnt(15)
    v_mfma_f32_16x16x32_bf16 v[120:123], v[40:43], a[60:63], 0
    v_mfma_f32_16x16x32_bf16 v[124:127], v[44:47], a[60:63], 0
    s_cmp_lg_u32 s20, 2
    s_cbranch_scc1 k1_kernel_nocs_4
    v_mfma_f32_16x16x32_bf16 a[0:3], v[32:35], a[52:55], a[0:3]
    v_mfma_f32_16x16x32_bf16 a[4:7], v[32:35], a[56:59], a[4:7]
    v_mfma_f32_16x16x32_bf16 a[8:11], v[32:35], a[60:63], a[8:11]
k1_kernel_nocs_4:
    ds_read_b64_tr_b16 a[92:93], v24 offset:31936
    ds_read_b64_tr_b16 a[94:95], v24 offset:32896
    s_waitcnt lgkmcnt(14)
    v_mfma_f32_16x16x32_bf16 v[56:59], a[64:67], v[48:51], v[56:59]
    v_mfma_f32_16x16x32_bf16 v[60:63], a[64:67], v[52:55], v[60:63]
    v_mfma_f32_16x16x32_bf16 a[12:15], v[32:35], v[48:51], a[12:15]
    v_mfma_f32_16x16x32_bf16 a[16:19], v[48:51], v[48:51], a[16:19]
    ds_read_b64_tr_b16 a[96:97], v24 offset:31968
    ds_read_b64_tr_b16 a[98:99], v24 offset:32928
    s_waitcnt lgkmcnt(14)
    v_mfma_f32_16x16x32_bf16 v[64:67], a[68:71], v[48:51], v[64:67]
    v_mfma_f32_16x16x32_bf16 v[68:71], a[68:71], v[52:55], v[68:71]
    v_mfma_f32_16x16x32_bf16 a[20:23], v[32:35], v[52:55], a[20:23]
    v_mfma_f32_16x16x32_bf16 a[24:27], v[52:55], v[52:55], a[24:27]
    s_waitcnt vmcnt(7)
    s_barrier
    ds_read_b128 v[40:43], v28 offset:0
    ds_read_b128 v[44:47], v29 offset:0
    ds_read_b64_tr_b16 a[28:29], v25 offset:0
    ds_read_b64_tr_b16 a[30:31], v25 offset:960
    s_waitcnt lgkmcnt(15)
    v_mfma_f32_16x16x32_bf16 v[72:75], a[72:75], v[48:51], v[72:75]
    v_mfma_f32_16x16x32_bf16 v[76:79], a[72:75], v[52:55], v[76:79]
    s_add_u32 s37, s33, 884736
    s_add_u32 m0, s35, 0
    s_nop 0
    buffer_load_dwordx4 v18, s[68:71], s37 offen lds
    s_cmp_lg_u32 s20, 0
    s_cbranch_scc1 k1_kernel_nocs_5
    v_mfma_f32_16x16x32_bf16 a[0:3], v[32:35], a[64:67], a[0:3]
    v_mfma_f32_16x16x32_bf16 a[4:7], v[32:35], a[68:71], a[4:7]
    v_mfma_f32_16x16x32_bf16 a[8:11], v[32:35], a[72:75], a[8:11]
k1_kernel_nocs_5:
    ds_read_b64_tr_b16 a[32:33], v25 offset:32
    ds_read_b64_tr_b16 a[34:35], v25 offset:992
    s_waitcnt lgkmcnt(15)
    v_mfma_f32_16x16x32_bf16 v[80:83], v[48:51], a[76:79], v[80:83]
    v_mfma_f32_16x16x32_bf16 v[84:87], v[52:55], a[76:79], v[84:87]
    s_add_u32 s36, s32, 512
    s_add_u32 m0, s34, 0
    s_nop 0
    buffer_load_dwordx4 v16, s[64:67], s36 offen lds
    ds_read_b64_tr_b16 a[36:37], v25 offset:64
    ds_read_b64_tr_b16 a[38:39], v25 offset:1024
    s_waitcnt lgkmcnt(15)
    v_mfma_f32_16x16x32_bf16 v[88:91], v[48:51], a[80:83], v[88:91]
    v_mfma_f32_16x16x32_bf16 v[92:95], v[52:55], a[80:83], v[92:95]
    s_add_u32 m0, s35, 1024
    s_mov_b32 exec_hi, 0xffffff
    buffer_load_dwordx4 v19, s[68:71], s37 offen lds
    s_mov_b64 exec, -1
    ds_read_b64_tr_b16 a[40:41], v25 offset:80
    ds_read_b64_tr_b16 a[42:43], v25 offset:1040
    s_waitcnt lgkmcnt(15)
    v_mfma_f32_16x16x32_bf16 v[96:99], v[48:51], a[84:87], v[96:99]
    v_mfma_f32_16x16x32_bf16 v[100:103], v[52:55], a[84:87], v[100:103]
    s_add_u32 m0, s34, 1024
    s_nop 0
    buffer_load_dwordx4 v17, s[64:67], s36 offen lds
    s_cmp_lg_u32 s20, 1
    s_cbranch_scc1 k1_kernel_nocs_6
    v_mfma_f32_16x16x32_bf16 a[0:3], v[32:35], a[76:79], a[0:3]
    v_mfma_f32_16x16x32_bf16 a[4:7], v[32:35], a[80:83], a[4:7]
    v_mfma_f32_16x16x32_bf16 a[8:11], v[32:35], a[84:87], a[8:11]
k1_kernel_nocs_6:
    ds_read_b64_tr_b16 a[44:45], v25 offset:112
    ds_read_b64_tr_b16 a[46:47], v25 offset:1072
    s_waitcnt lgkmcnt(15)
    v_mfma_f32_16x16x32_bf16 v[104:107], v[48:51], a[88:91], v[104:107]
    v_mfma_f32_16x16x32_bf16 v[108:111], v[52:55], a[88:91], v[108:111]
    ds_read_b64_tr_b16 a[48:49], v25 offset:144
    ds_read_b64_tr_b16 a[50:51], v25 offset:1104
    s_waitcnt lgkmcnt(15)
    v_mfma_f32_16x16x32_bf16 v[112:115], v[48:51], a[92:95], v[112:115]
    v_mfma_f32_16x16x32_bf16 v[116:119], v[52:55], a[92:95], v[116:119]
    ds_read_b64_tr_b16 a[52:53], v25 offset:160
    ds_read_b64_tr_b16 a[54:55], v25 offset:1120
    s_waitcnt lgkmcnt(15)
    v_mfma_f32_16x16x32_bf16 v[120:123], v[48:51], a[96:99], v[120:123]
    v_mfma_f32_16x16x32_bf16 v[124:127], v[52:55], a[96:99], v[124:127]
    s_cmp_lg_u32 s20, 2
    s_cbranch_scc1 k1_kernel_nocs_7
    v_mfma_f32_16x16x32_bf16 a[0:3], v[32:35], a[88:91], a[0:3]
    v_mfma_f32_16x16x32_bf16 a[4:7], v[32:35], a[92:95], a[4:7]
    v_mfma_f32_16x16x32_bf16 a[8:11], v[32:35], a[96:99], a[8:11]
k1_kernel_nocs_7:
    ds_read_b64_tr_b16 a[56:57], v25 offset:192
    ds_read_b64_tr_b16 a[58:59], v25 offset:1152
    s_waitcnt lgkmcnt(14)
    v_mfma_f32_16x16x32_bf16 v[56:59], a[28:31], v[40:43], v[56:59]
    v_mfma_f32_16x16x32_bf16 v[60:63], a[28:31], v[44:47], v[60:63]
    v_mfma_f32_16x16x32_bf16 a[12:15], v[32:35], v[40:43], a[12:15]
    v_mfma_f32_16x16x32_bf16 a[16:19], v[40:43], v[40:43], a[16:19]
    ds_read_b64_tr_b16 a[60:61], v25 offset:224
    ds_read_b64_tr_b16 a[62:63], v25 offset:1184
    s_waitcnt lgkmcnt(14)
    v_mfma_f32_16x16x32_bf16 v[64:67], a[32:35], v[40:43], v[64:67]
    v_mfma_f32_16x16x32_bf16 v[68:71], a[32:35], v[44:47], v[68:71]
    v_mfma_f32_16x16x32_bf16 a[20:23], v[32:35], v[44:47], a[20:23]
    v_mfma_f32_16x16x32_bf16 a[24:27], v[44:47], v[44:47], a[24:27]
    s_waitcnt vmcnt(5)
    s_or_b32 s41, s26, s25
    s_cmp_lg_u32 s41, 0
    s_cbranch_scc1 k1_kernel_nozero_8
    v_readfirstlane_b32 s40, v11
    s_nop 0
    s_cmp_lg_u32 s40, 0
    s_cbranch_scc1 k1_kernel_nozero_8
    s_mul_i32 s41, s24, 7168
    s_add_u32 s42, s41, 4096
    buffer_store_dwordx4 v[12:15], v6, s[80:83], s41 offen offset:0 sc0 sc1
    buffer_store_dwordx4 v[12:15], v6, s[80:83], s41 offen offset:1024 sc0 sc1
    buffer_store_dwordx4 v[12:15], v6, s[80:83], s41 offen offset:2048 sc0 sc1
    buffer_store_dwordx4 v[12:15], v6, s[80:83], s41 offen offset:3072 sc0 sc1
    buffer_store_dwordx4 v[12:15], v6, s[80:83], s42 offen offset:0 sc0 sc1
    buffer_store_dwordx4 v[12:15], v6, s[80:83], s42 offen offset:1024 sc0 sc1
    buffer_store_dwordx4 v[12:15], v6, s[80:83], s42 offen offset:2048 sc0 sc1
k1_kernel_nozero_8:
    s_barrier
    ds_read_b128 v[48:51], v28 offset:31744
    ds_read_b128 v[52:55], v29 offset:31744
    ds_read_b64_tr_b16 a[64:65], v25 offset:31744
    ds_read_b64_tr_b16 a[66:67], v25 offset:32704
    s_waitcnt lgkmcnt(15)
    v_mfma_f32_16x16x32_bf16 v[72:75], a[36:39], v[40:43], v[72:75]
    v_mfma_f32_16x16x32_bf16 v[76:79], a[36:39], v[44:47], v[76:79]
    s_add_u32 s37, s33, 1105920
    s_add_u32 m0, s35, 31744
    s_nop 0
    buffer_load_dwordx4 v18, s[68:71], s37 offen lds
    s_cmp_lg_u32 s20, 0
    s_cbranch_scc1 k1_kernel_nocs_9
    v_mfma_f32_16x16x32_bf16 a[0:3], v[32:35], a[28:31], a[0:3]
    v_mfma_f32_16x16x32_bf16 a[4:7], v[32:35], a[32:35], a[4:7]
    v_mfma_f32_16x16x32_bf16 a[8:11], v[32:35], a[36:39], a[8:11]
k1_kernel_nocs_9:
    ds_read_b64_tr_b16 a[68:69], v25 offset:31776
    ds_read_b64_tr_b16 a[70:71], v25 offset:32736
    s_waitcnt lgkmcnt(15)
    v_mfma_f32_16x16x32_bf16 v[80:83], v[40:43], a[40:43], v[80:83]
    v_mfma_f32_16x16x32_bf16 v[84:87], v[44:47], a[40:43], v[84:87]
    s_add_u32 s36, s32, 640
    s_add_u32 m0, s34, 31744
    s_nop 0
    buffer_load_dwordx4 v16, s[64:67], s36 offen lds
    ds_read_b64_tr_b16 a[72:73], v25 offset:31808
    ds_read_b64_tr_b16 a[74:75], v25 offset:32768
    s_waitcnt lgkmcnt(15)
    v_mfma_f32_16x16x32_bf16 v[88:91], v[40:43], a[44:47], v[88:91]
    v_mfma_f32_16x16x32_bf16 v[92:95], v[44:47], a[44:47], v[92:95]
    s_add_u32 m0, s35, 32768
    s_mov_b32 exec_hi, 0xffffff
    buffer_load_dwordx4 v19, s[68:71], s37 offen lds
    s_mov_b64 exec, -1
    ds_read_b64_tr_b16 a[76:77], v25 offset:31824
    ds_read_b64_tr_b16 a[78:79], v25 offset:32784
    s_waitcnt lgkmcnt(15)
    v_mfma_f32_16x16x32_bf16 v[96:99], v[40:43], a[48:51], v[96:99]
    v_mfma_f32_16x16x32_bf16 v[100:103], v[44:47], a[48:51], v[100:103]
    s_add_u32 m0, s34, 32768
    s_nop 0
    buffer_load_dwordx4 v17, s[64:67], s36 offen lds
    s_cmp_lg_u32 s20, 1
    s_cbranch_scc1 k1_kernel_nocs_10
    v_mfma_f32_16x16x32_bf16 a[0:3], v[32:35], a[40:43], a[0:3]
    v_mfma_f32_16x16x32_bf16 a[4:7], v[32:35], a[44:47], a[4:7]
    v_mfma_f32_16x16x32_bf16 a[8:11], v[32:35], a[48:51], a[8:11]
k1_kernel_nocs_10:
    ds_read_b64_tr_b16 a[80:81], v25 offset:31856
    ds_read_b64_tr_b16 a[82:83], v25 offset:32816
    s_waitcnt lgkmcnt(15)
    v_mfma_f32_16x16x32_bf16 v[104:107], v[40:43], a[52:55], v[104:107]
    v_mfma_f32_16x16x32_bf16 v[108:111], v[44:47], a[52:55], v[108:111]
    ds_read_b64_tr_b16 a[84:85], v25 offset:31888
    ds_read_b64_tr_b16 a[86:87], v25 offset:32848
    s_waitcnt lgkmcnt(15)
    v_mfma_f32_16x16x32_bf16 v[112:115], v[40:43], a[56:59], v[112:115]
    v_mfma_f32_16x16x32_bf16 v[116:119], v[44:47], a[56:59], v[116:119]
    ds_read_b64_tr_b16 a[88:89], v25 offset:31904
    ds_read_b64_tr_b16 a[90:91], v25 offset:32864
    s_waitcnt lgkmcnt(15)
    v_mfma_f32_16x16x32_bf16 v[120:123], v[40:43], a[60:63], v[120:123]
    v_mfma_f32_16x16x32_bf16 v[124:127], v[44:47], a[60:63], v[124:127]
    s_cmp_lg_u32 s20, 2
    s_cbranch_scc1 k1_kernel_nocs_11
    v_mfma_f32_16x16x32_bf16 a[0:3], v[32:35], a[52:55], a[0:3]
    v_mfma_f32_16x16x32_bf16 a[4:7], v[32:35], a[56:59], a[4:7]
    v_mfma_f32_16x16x32_bf16 a[8:11], v[32:35], a[60:63], a[8:11]
k1_kernel_nocs_11:
    ds_read_b64_tr_b16 a[92:93], v25 offset:31936
    ds_read_b64_tr_b16 a[94:95], v25 offset:32896
    s_waitcnt lgkmcnt(14)
    v_mfma_f32_16x16x32_bf16 v[56:59], a[64:67], v[48:51], v[56:59]
    v_mfma_f32_16x16x32_bf16 v[60:63], a[64:67], v[52:55], v[60:63]
    v_mfma_f32_16x16x32_bf16 a[12:15], v[32:35], v[48:51], a[12:15]
    v_mfma_f32_16x16x32_bf16 a[16:19], v[48:51], v[48:51], a[16:19]
    ds_read_b64_tr_b16 a[96:97], v25 offset:31968
    ds_read_b64_tr_b16 a[98:99], v25 offset:32928
    s_waitcnt lgkmcnt(14)
    v_mfma_f32_16x16x32_bf16 v[64:67], a[68:71], v[48:51], v[64:67]
    v_mfma_f32_16x16x32_bf16 v[68:71], a[68:71], v[52:55], v[68:71]
    v_mfma_f32_16x16x32_bf16 a[20:23], v[32:35], v[52:55], a[20:23]
    v_mfma_f32_16x16x32_bf16 a[24:27], v[52:55], v[52:55], a[24:27]
    s_waitcnt vmcnt(4)
    s_barrier
    ds_read_b128 v[40:43], v26 offset:0
    ds_read_b128 v[44:47], v27 offset:0
    ds_read_b64_tr_b16 a[28:29], v24 offset:0
    ds_read_b64_tr_b16 a[30:31], v24 offset:960
    s_waitcnt lgkmcnt(15)
    v_mfma_f32_16x16x32_bf16 v[72:75], a[72:75], v[48:51], v[72:75]
    v_mfma_f32_16x16x32_bf16 v[76:79], a[72:75], v[52:55], v[76:79]
    s_add_u32 s37, s33, 1327104
    s_add_u32 m0, s35, 63488
    s_nop 0
    buffer_load_dwordx4 v18, s[68:71], s37 offen lds
    s_cmp_lg_u32 s20, 0
    s_cbranch_scc1 k1_kernel_nocs_12
    v_mfma_f32_16x16x32_bf16 a[0:3], v[32:35], a[64:67], a[0:3]
    v_mfma_f32_16x16x32_bf16 a[4:7], v[32:35], a[68:71], a[4:7]
    v_mfma_f32_16x16x32_bf16 a[8:11], v[32:35], a[72:75], a[8:11]
k1_kernel_nocs_12:
    ds_read_b64_tr_b16 a[32:33], v24 offset:32
    ds_read_b64_tr_b16 a[34:35], v24 offset:992
    s_waitcnt lgkmcnt(15)
    v_mfma_f32_16x16x32_bf16 v[80:83], v[48:51], a[76:79], v[80:83]
    v_mfma_f32_16x16x32_bf16 v[84:87], v[52:55], a[76:79], v[84:87]
    s_add_u32 s36, s32, 768
    s_add_u32 m0, s34, 63488
    s_nop 0
    buffer_load_dwordx4 v16, s[64:67], s36 offen lds
    ds_read_b64_tr_b16 a[36:37], v24 offset:64
    ds_read_b64_tr_b16 a[38:39], v24 offset:1024
    s_waitcnt lgkmcnt(15)
    v_mfma_f32_16x16x32_bf16 v[88:91], v[48:51], a[80:83], v[88:91]
    v_mfma_f32_16x16x32_bf16 v[92:95], v[52:55], a[80:83], v[92:95]
    s_add_u32 m0, s35, 64512
    s_mov_b32 exec_hi, 0xffffff
    buffer_load_dwordx4 v19, s[68:71], s37 offen lds
    s_mov_b64 exec, -1
    ds_read_b64_tr_b16 a[40:41], v24 offset:80
    ds_read_b64_tr_b16 a[42:43], v24 offset:1040
    s_waitcnt lgkmcnt(15)
    v_mfma_f32_16x16x32_bf16 v[96:99], v[48:51], a[84:87], v[96:99]
    v_mfma_f32_16x16x32_bf16 v[100:103], v[52:55], a[84:87], v[100:103]
    s_add_u32 m0, s34, 64512
    s_nop 0
    buffer_load_dwordx4 v17, s[64:67], s36 offen lds
    s_cmp_lg_u32 s20, 1
    s_cbranch_scc1 k1_kernel_nocs_13
    v_mfma_f32_16x16x32_bf16 a[0:3], v[32:35], a[76:79], a[0:3]
    v_mfma_f32_16x16x32_bf16 a[4:7], v[32:35], a[80:83], a[4:7]
    v_mfma_f32_16x16x32_bf16 a[8:11], v[32:35], a[84:87], a[8:11]
k1_kernel_nocs_13:
    ds_read_b64_tr_b16 a[44:45], v24 offset:112
    ds_read_b64_tr_b16 a[46:47], v24 offset:1072
    s_waitcnt lgkmcnt(15)
    v_mfma_f32_16x16x32_bf16 v[104:107], v[48:51], a[88:91], v[104:107]
    v_mfma_f32_16x16x32_bf16 v[108:111], v[52:55], a[88:91], v[108:111]
    ds_read_b64_tr_b16 a[48:49], v24 offset:144
    ds_read_b64_tr_b16 a[50:51], v24 offset:1104
    s_waitcnt lgkmcnt(15)
    v_mfma_f32_16x16x32_bf16 v[112:115], v[48:51], a[92:95], v[112:115]
    v_mfma_f32_16x16x32_bf16 v[116:119], v[52:55], a[92:95], v[116:119]
    ds_read_b64_tr_b16 a[52:53], v24 offset:160
    ds_read_b64_tr_b16 a[54:55], v24 offset:1120
    s_waitcnt lgkmcnt(15)
    v_mfma_f32_16x16x32_bf16 v[120:123], v[48:51], a[96:99], v[120:123]
    v_mfma_f32_16x16x32_bf16 v[124:127], v[52:55], a[96:99], v[124:127]
    s_cmp_lg_u32 s20, 2
    s_cbranch_scc1 k1_kernel_nocs_14
    v_mfma_f32_16x16x32_bf16 a[0:3], v[32:35], a[88:91], a[0:3]
    v_mfma_f32_16x16x32_bf16 a[4:7], v[32:35], a[92:95], a[4:7]
    v_mfma_f32_16x16x32_bf16 a[8:11], v[32:35], a[96:99], a[8:11]
k1_kernel_nocs_14:
    ds_read_b64_tr_b16 a[56:57], v24 offset:192
    ds_read_b64_tr_b16 a[58:59], v24 offset:1152
    s_waitcnt lgkmcnt(14)
    v_mfma_f32_16x16x32_bf16 v[56:59], a[28:31], v[40:43], v[56:59]
    v_mfma_f32_16x16x32_bf16 v[60:63], a[28:31], v[44:47], v[60:63]
    v_mfma_f32_16x16x32_bf16 a[12:15], v[32:35], v[40:43], a[12:15]
    v_mfma_f32_16x16x32_bf16 a[16:19], v[40:43], v[40:43], a[16:19]
    ds_read_b64_tr_b16 a[60:61], v24 offset:224
    ds_read_b64_tr_b16 a[62:63], v24 offset:1184
    s_waitcnt lgkmcnt(14)
    v_mfma_f32_16x16x32_bf16 v[64:67], a[32:35], v[40:43], v[64:67]
    v_mfma_f32_16x16x32_bf16 v[68:71], a[32:35], v[44:47], v[68:71]
    v_mfma_f32_16x16x32_bf16 a[20:23], v[32:35], v[44:47], a[20:23]
    v_mfma_f32_16x16x32_bf16 a[24:27], v[44:47], v[44:47], a[24:27]
    s_waitcnt vmcnt(4)
    s_barrier
    ds_read_b128 v[48:51], v26 offset:31744
    ds_read_b128 v[52:55], v27 offset:31744
    ds_read_b64_tr_b16 a[64:65], v24 offset:31744
    ds_read_b64_tr_b16 a[66:67], v24 offset:32704
    s_waitcnt lgkmcnt(15)
    v_mfma_f32_16x16x32_bf16 v[72:75], a[36:39], v[40:43], v[72:75]
    v_mfma_f32_16x16x32_bf16 v[76:79], a[36:39], v[44:47], v[76:79]
    s_add_u32 s37, s33, 1548288
    s_add_u32 m0, s35, 95232
    s_nop 0
    buffer_load_dwordx4 v18, s[68:71], s37 offen lds
    s_cmp_lg_u32 s20, 0
    s_cbranch_scc1 k1_kernel_nocs_15
    v_mfma_f32_16x16x32_bf16 a[0:3], v[32:35], a[28:31], a[0:3]
    v_mfma_f32_16x16x32_bf16 a[4:7], v[32:35], a[32:35], a[4:7]
    v_mfma_f32_16x16x32_bf16 a[8:11], v[32:35], a[36:39], a[8:11]
k1_kernel_nocs_15:
    ds_read_b64_tr_b16 a[68:69], v24 offset:31776
    ds_read_b64_tr_b16 a[70:71], v24 offset:32736
    s_waitcnt lgkmcnt(15)
    v_mfma_f32_16x16x32_bf16 v[80:83], v[40:43], a[40:43], v[80:83]
    v_mfma_f32_16x16x32_bf16 v[84:87], v[44:47], a[40:43], v[84:87]
    s_add_u32 s36, s32, 896
    s_add_u32 m0, s34, 95232
    s_nop 0
    buffer_load_dwordx4 v16, s[64:67], s36 offen lds
    ds_read_b64_tr_b16 a[72:73], v24 offset:31808
    ds_read_b64_tr_b16 a[74:75], v24 offset:32768
    s_waitcnt lgkmcnt(15)
    v_mfma_f32_16x16x32_bf16 v[88:91], v[40:43], a[44:47], v[88:91]
    v_mfma_f32_16x16x32_bf16 v[92:95], v[44:47], a[44:47], v[92:95]
    s_add_u32 m0, s35, 96256
    s_mov_b32 exec_hi, 0xffffff
    buffer_load_dwordx4 v19, s[68:71], s37 offen lds
    s_mov_b64 exec, -1
    ds_read_b64_tr_b16 a[76:77], v24 offset:31824
    ds_read_b64_tr_b16 a[78:79], v24 offset:32784
    s_waitcnt lgkmcnt(15)
    v_mfma_f32_16x16x32_bf16 v[96:99], v[40:43], a[48:51], v[96:99]
    v_mfma_f32_16x16x32_bf16 v[100:103], v[44:47], a[48:51], v[100:103]
    s_add_u32 m0, s34, 96256
    s_nop 0
    buffer_load_dwordx4 v17, s[64:67], s36 offen lds
    s_cmp_lg_u32 s20, 1
    s_cbranch_scc1 k1_kernel_nocs_16
    v_mfma_f32_16x16x32_bf16 a[0:3], v[32:35], a[40:43], a[0:3]
    v_mfma_f32_16x16x32_bf16 a[4:7], v[32:35], a[44:47], a[4:7]
    v_mfma_f32_16x16x32_bf16 a[8:11], v[32:35], a[48:51], a[8:11]
k1_kernel_nocs_16:
    ds_read_b64_tr_b16 a[80:81], v24 offset:31856
    ds_read_b64_tr_b16 a[82:83], v24 offset:32816
    s_waitcnt lgkmcnt(15)
    v_mfma_f32_16x16x32_bf16 v[104:107], v[40:43], a[52:55], v[104:107]
    v_mfma_f32_16x16x32_bf16 v[108:111], v[44:47], a[52:55], v[108:111]
    ds_read_b64_tr_b16 a[84:85], v24 offset:31888
    ds_read_b64_tr_b16 a[86:87], v24 offset:32848
    s_waitcnt lgkmcnt(15)
    v_mfma_f32_16x16x32_bf16 v[112:115], v[40:43], a[56:59], v[112:115]
    v_mfma_f32_16x16x32_bf16 v[116:119], v[44:47], a[56:59], v[116:119]
    ds_read_b64_tr_b16 a[88:89], v24 offset:31904
    ds_read_b64_tr_b16 a[90:91], v24 offset:32864
    s_waitcnt lgkmcnt(15)
    v_mfma_f32_16x16x32_bf16 v[120:123], v[40:43], a[60:63], v[120:123]
    v_mfma_f32_16x16x32_bf16 v[124:127], v[44:47], a[60:63], v[124:127]
    s_cmp_lg_u32 s20, 2
    s_cbranch_scc1 k1_kernel_nocs_17
    v_mfma_f32_16x16x32_bf16 a[0:3], v[32:35], a[52:55], a[0:3]
    v_mfma_f32_16x16x32_bf16 a[4:7], v[32:35], a[56:59], a[4:7]
    v_mfma_f32_16x16x32_bf16 a[8:11], v[32:35], a[60:63], a[8:11]
k1_kernel_nocs_17:
    ds_read_b64_tr_b16 a[92:93], v24 offset:31936
    ds_read_b64_tr_b16 a[94:95], v24 offset:32896
    s_waitcnt lgkmcnt(14)
    v_mfma_f32_16x16x32_bf16 v[56:59], a[64:67], v[48:51], v[56:59]
    v_mfma_f32_16x16x32_bf16 v[60:63], a[64:67], v[52:55], v[60:63]
    v_mfma_f32_16x16x32_bf16 a[12:15], v[32:35], v[48:51], a[12:15]
    v_mfma_f32_16x16x32_bf16 a[16:19], v[48:51], v[48:51], a[16:19]
    ds_read_b64_tr_b16 a[96:97], v24 offset:31968
    ds_read_b64_tr_b16 a[98:99], v24 offset:32928
    s_waitcnt lgkmcnt(14)
    v_mfma_f32_16x16x32_bf16 v[64:67], a[68:71], v[48:51], v[64:67]
    v_mfma_f32_16x16x32_bf16 v[68:71], a[68:71], v[52:55], v[68:71]
    v_mfma_f32_16x16x32_bf16 a[20:23], v[32:35], v[52:55], a[20:23]
    v_mfma_f32_16x16x32_bf16 a[24:27], v[52:55], v[52:55], a[24:27]
    s_waitcnt vmcnt(4)
    s_cmp_lg_u32 s40, 0
    s_cbranch_scc1 k1_kernel_noflag_18
    v_mov_b32 v31, 1
    s_mov_b64 exec, 1
    buffer_store_dword v31, v12, s[76:79], s29 offen offset:64 sc0 sc1
    s_mov_b64 exec, -1
k1_kernel_noflag_18:
    s_barrier
    ds_read_b128 v[40:43], v28 offset:0
    ds_read_b128 v[44:47], v29 offset:0
    ds_read_b64_tr_b16 a[28:29], v25 offset:0
    ds_read_b64_tr_b16 a[30:31], v25 offset:960
    s_waitcnt lgkmcnt(15)
    v_mfma_f32_16x16x32_bf16 v[72:75], a[72:75], v[48:51], v[72:75]
    v_mfma_f32_16x16x32_bf16 v[76:79], a[72:75], v[52:55], v[76:79]
    s_add_u32 s37, s33, 1769472
    s_add_u32 m0, s35, 0
    s_nop 0
    buffer_load_dwordx4 v18, s[68:71], s37 offen lds
    s_cmp_lg_u32 s20, 0
    s_cbranch_scc1 k1_kernel_nocs_19
    v_mfma_f32_16x16x32_bf16 a[0:3], v[32:35], a[64:67], a[0:3]
    v_mfma_f32_16x16x32_bf16 a[4:7], v[32:35], a[68:71], a[4:7]
    v_mfma_f32_16x16x32_bf16 a[8:11], v[32:35], a[72:75], a[8:11]
k1_kernel_nocs_19:
    ds_read_b64_tr_b16 a[32:33], v25 offset:32
    ds_read_b64_tr_b16 a[34:35], v25 offset:992
    s_waitcnt lgkmcnt(15)
    v_mfma_f32_16x16x32_bf16 v[80:83], v[48:51], a[76:79], v[80:83]
    v_mfma_f32_16x16x32_bf16 v[84:87], v[52:55], a[76:79], v[84:87]
    s_add_u32 s36, s32, 1024
    s_add_u32 m0, s34, 0
    s_nop 0
    buffer_load_dwordx4 v16, s[64:67], s36 offen lds
    ds_read_b64_tr_b16 a[36:37], v25 offset:64
    ds_read_b64_tr_b16 a[38:39], v25 offset:1024
    s_waitcnt lgkmcnt(15)
    v_mfma_f32_16x16x32_bf16 v[88:91], v[48:51], a[80:83], v[88:91]
    v_mfma_f32_16x16x32_bf16 v[92:95], v[52:55], a[80:83], v[92:95]
    s_add_u32 m0, s35, 1024
    s_mov_b32 exec_hi, 0xffffff
    buffer_load_dwordx4 v19, s[68:71], s37 offen lds
    s_mov_b64 exec, -1
    ds_read_b64_tr_b16 a[40:41], v25 offset:80
    ds_read_b64_tr_b16 a[42:43], v25 offset:1040
    s_waitcnt lgkmcnt(15)
    v_mfma_f32_16x16x32_bf16 v[96:99], v[48:51], a[84:87], v[96:99]
    v_mfma_f32_16x16x32_bf16 v[100:103], v[52:55], a[84:87], v[100:103]
    s_add_u32 m0, s34, 1024
    s_nop 0
    buffer_load_dwordx4 v17, s[64:67], s36 offen lds
    s_cmp_lg_u32 s20, 1
    s_cbranch_scc1 k1_kernel_nocs_20
    v_mfma_f32_16x16x32_bf16 a[0:3], v[32:35], a[76:79], a[0:3]
    v_mfma_f32_16x16x32_bf16 a[4:7], v[32:35], a[80:83], a[4:7]
    v_mfma_f32_16x16x32_bf16 a[8:11], v[32:35], a[84:87], a[8:11]
k1_kernel_nocs_20:
    ds_read_b64_tr_b16 a[44:45], v25 offset:112
    ds_read_b64_tr_b16 a[46:47], v25 offset:1072
    s_waitcnt lgkmcnt(15)
    v_mfma_f32_16x16x32_bf16 v[104:107], v[48:51], a[88:91], v[104:107]
    v_mfma_f32_16x16x32_bf16 v[108:111], v[52:55], a[88:91], v[108:111]
    s_mov_b32 s44, s18
    s_mov_b32 s45, s19
    s_mov_b32 s46, 0x510000
    s_mov_b32 s47, 0x20000
    s_and_b32 s38, s2, 3
    s_mul_i32 s38, s38, 1327104
    s_lshr_b32 s39, s2, 3
    s_mul_i32 s41, s39, 288
    s_add_u32 s38, s38, s41
    v_lshrrev_b32 v20, 2, v1
    v_and_b32 v21, 3, v1
    v_lshlrev_b32 v21, 7, v21
    v_min_u32 v21, 284, v21
    v_mul_u32_u24 v20, 9216, v20
    v_add_u32 v20, v20, v21
    buffer_load_dword v147, v20, s[44:47], s38 offen
    v_cmp_gt_u32 vcc, 64, v1
    s_nop 1
    v_cndmask_b32 v20, v7, v20, vcc
    s_add_u32 s38, s38, 1179648
    buffer_load_dword v147, v20, s[44:47], s38 offen
    ds_read_b64_tr_b16 a[48:49], v25 offset:144
    ds_read_b64_tr_b16 a[50:51], v25 offset:1104
    s_waitcnt lgkmcnt(15)
    v_mfma_f32_16x16x32_bf16 v[112:115], v[48:51], a[92:95], v[112:115]
    v_mfma_f32_16x16x32_bf16 v[116:119], v[52:55], a[92:95], v[116:119]
    ds_read_b64_tr_b16 a[52:53], v25 offset:160
    ds_read_b64_tr_b16 a[54:55], v25 offset:1120
    s_waitcnt lgkmcnt(15)
    v_mfma_f32_16x16x32_bf16 v[120:123], v[48:51], a[96:99], v[120:123]
    v_mfma_f32_16x16x32_bf16 v[124:127], v[52:55], a[96:99], v[124:127]
    s_cmp_lg_u32 s20, 2
    s_cbranch_scc1 k1_kernel_nocs_21
    v_mfma_f32_16x16x32_bf16 a[0:3], v[32:35], a[88:91], a[0:3]
    v_mfma_f32_16x16x32_bf16 a[4:7], v[32:35], a[92:95], a[4:7]
    v_mfma_f32_16x16x32_bf16 a[8:11], v[32:35], a[96:99], a[8:11]
k1_kernel_nocs_21:
    ds_read_b64_tr_b16 a[56:57], v25 offset:192
    ds_read_b64_tr_b16 a[58:59], v25 offset:1152
    s_waitcnt lgkmcnt(14)
    v_mfma_f32_16x16x32_bf16 v[56:59], a[28:31], v[40:43], v[56:59]
    v_mfma_f32_16x16x32_bf16 v[60:63], a[28:31], v[44:47], v[60:63]
    v_mfma_f32_16x16x32_bf16 a[12:15], v[32:35], v[40:43], a[12:15]
    v_mfma_f32_16x16x32_bf16 a[16:19], v[40:43], v[40:43], a[16:19]
    ds_read_b64_tr_b16 a[60:61], v25 offset:224
    ds_read_b64_tr_b16 a[62:63], v25 offset:1184
    s_waitcnt lgkmcnt(14)
    v_mfma_f32_16x16x32_bf16 v[64:67], a[32:35], v[40:43], v[64:67]
    v_mfma_f32_16x16x32_bf16 v[68:71], a[32:35], v[44:47], v[68:71]
    v_mfma_f32_16x16x32_bf16 a[20:23], v[32:35], v[44:47], a[20:23]
    v_mfma_f32_16x16x32_bf16 a[24:27], v[44:47], v[44:47], a[24:27]
    s_waitcnt vmcnt(6)
    s_barrier
    ds_read_b128 v[48:51], v28 offset:31744
    ds_read_b128 v[52:55], v29 offset:31744
    ds_read_b64_tr_b16 a[64:65], v25 offset:31744
    ds_read_b64_tr_b16 a[66:67], v25 offset:32704
    s_waitcnt lgkmcnt(15)
    v_mfma_f32_16x16x32_bf16 v[72:75], a[36:39], v[40:43], v[72:75]
    v_mfma_f32_16x16x32_bf16 v[76:79], a[36:39], v[44:47], v[76:79]
    s_cmp_lg_u32 s20, 0
    s_cbranch_scc1 k1_kernel_nocs_22
    v_mfma_f32_16x16x32_bf16 a[0:3], v[32:35], a[28:31], a[0:3]
    v_mfma_f32_16x16x32_bf16 a[4:7], v[32:35], a[32:35], a[4:7]
    v_mfma_f32_16x16x32_bf16 a[8:11], v[32:35], a[36:39], a[8:11]
k1_kernel_nocs_22:
    ds_read_b64_tr_b16 a[68:69], v25 offset:31776
    ds_read_b64_tr_b16 a[70:71], v25 offset:32736
    s_waitcnt lgkmcnt(15)
    v_mfma_f32_16x16x32_bf16 v[80:83], v[40:43], a[40:43], v[80:83]
    v_mfma_f32_16x16x32_bf16 v[84:87], v[44:47], a[40:43], v[84:87]
    ds_read_b64_tr_b16 a[72:73], v25 offset:31808
    ds_read_b64_tr_b16 a[74:75], v25 offset:32768
    s_waitcnt lgkmcnt(15)
    v_mfma_f32_16x16x32_bf16 v[88:91], v[40:43], a[44:47], v[88:91]
    v_mfma_f32_16x16x32_bf16 v[92:95], v[44:47], a[44:47], v[92:95]
    ds_read_b64_tr_b16 a[76:77], v25 offset:31824
    ds_read_b64_tr_b16 a[78:79], v25 offset:32784
    s_waitcnt lgkmcnt(15)
    v_mfma_f32_16x16x32_bf16 v[96:99], v[40:43], a[48:51], v[96:99]
    v_mfma_f32_16x16x32_bf16 v[100:103], v[44:47], a[48:51], v[100:103]
    s_cmp_lg_u32 s20, 1
    s_cbranch_scc1 k1_kernel_nocs_23
    v_mfma_f32_16x16x32_bf16 a[0:3], v[32:35], a[40:43], a[0:3]
    v_mfma_f32_16x16x32_bf16 a[4:7], v[32:35], a[44:47], a[4:7]
    v_mfma_f32_16x16x32_bf16 a[8:11], v[32:35], a[48:51], a[8:11]
k1_kernel_nocs_23:
    ds_read_b64_tr_b16 a[80:81], v25 offset:31856
    ds_read_b64_tr_b16 a[82:83], v25 offset:32816
    s_waitcnt lgkmcnt(15)
    v_mfma_f32_16x16x32_bf16 v[104:107], v[40:43], a[52:55], v[104:107]
    v_mfma_f32_16x16x32_bf16 v[108:111], v[44:47], a[52:55], v[108:111]
    ds_read_b64_tr_b16 a[84:85], v25 offset:31888
    ds_read_b64_tr_b16 a[86:87], v25 offset:32848
    s_waitcnt lgkmcnt(15)
    v_mfma_f32_16x16x32_bf16 v[112:115], v[40:43], a[56:59], v[112:115]
    v_mfma_f32_16x16x32_bf16 v[116:119], v[44:47], a[56:59], v[116:119]
    ds_read_b64_tr_b16 a[88:89], v25 offset:31904
    ds_read_b64_tr_b16 a[90:91], v25 offset:32864
    s_waitcnt lgkmcnt(15)
    v_mfma_f32_16x16x32_bf16 v[120:123], v[40:43], a[60:63], v[120:123]
    v_mfma_f32_16x16x32_bf16 v[124:127], v[44:47], a[60:63], v[124:127]
    s_cmp_lg_u32 s20, 2
    s_cbranch_scc1 k1_kernel_nocs_24
    v_mfma_f32_16x16x32_bf16 a[0:3], v[32:35], a[52:55], a[0:3]
    v_mfma_f32_16x16x32_bf16 a[4:7], v[32:35], a[56:59], a[4:7]
    v_mfma_f32_16x16x32_bf16 a[8:11], v[32:35], a[60:63], a[8:11]
k1_kernel_nocs_24:
    ds_read_b64_tr_b16 a[92:93], v25 offset:31936
    ds_read_b64_tr_b16 a[94:95], v25 offset:32896
    s_waitcnt lgkmcnt(14)
    v_mfma_f32_16x16x32_bf16 v[56:59], a[64:67], v[48:51], v[56:59]
    v_mfma_f32_16x16x32_bf16 v[60:63], a[64:67], v[52:55], v[60:63]
    v_mfma_f32_16x16x32_bf16 a[12:15], v[32:35], v[48:51], a[12:15]
    v_mfma_f32_16x16x32_bf16 a[16:19], v[48:51], v[48:51], a[16:19]
    ds_read_b64_tr_b16 a[96:97], v25 offset:31968
    ds_read_b64_tr_b16 a[98:99], v25 offset:32928
    s_waitcnt lgkmcnt(14)
    v_mfma_f32_16x16x32_bf16 v[64:67], a[68:71], v[48:51], v[64:67]
    v_mfma_f32_16x16x32_bf16 v[68:71], a[68:71], v[52:55], v[68:71]
    v_mfma_f32_16x16x32_bf16 a[20:23], v[32:35], v[52:55], a[20:23]
    v_mfma_f32_16x16x32_bf16 a[24:27], v[52:55], v[52:55], a[24:27]
    s_waitcnt vmcnt(2)
    s_barrier
    ds_read_b128 v[40:43], v26 offset:0
    ds_read_b128 v[44:47], v27 offset:0
    ds_read_b64_tr_b16 a[28:29], v24 offset:0
    ds_read_b64_tr_b16 a[30:31], v24 offset:960
    s_waitcnt lgkmcnt(15)
    v_mfma_f32_16x16x32_bf16 v[72:75], a[72:75], v[48:51], v[72:75]
    v_mfma_f32_16x16x32_bf16 v[76:79], a[72:75], v[52:55], v[76:79]
    s_cmp_lg_u32 s20, 0
    s_cbranch_scc1 k1_kernel_nocs_25
    v_mfma_f32_16x16x32_bf16 a[0:3], v[32:35], a[64:67], a[0:3]
    v_mfma_f32_16x16x32_bf16 a[4:7], v[32:35], a[68:71], a[4:7]
    v_mfma_f32_16x16x32_bf16 a[8:11], v[32:35], a[72:75], a[8:11]
k1_kernel_nocs_25:
    ds_read_b64_tr_b16 a[32:33], v24 offset:32
    ds_read_b64_tr_b16 a[34:35], v24 offset:992
    s_waitcnt lgkmcnt(15)
    v_mfma_f32_16x16x32_bf16 v[80:83], v[48:51], a[76:79], v[80:83]
    v_mfma_f32_16x16x32_bf16 v[84:87], v[52:55], a[76:79], v[84:87]
    ds_read_b64_tr_b16 a[36:37], v24 offset:64
    ds_read_b64_tr_b16 a[38:39], v24 offset:1024
    s_waitcnt lgkmcnt(15)
    v_mfma_f32_16x16x32_bf16 v[88:91], v[48:51], a[80:83], v[88:91]
    v_mfma_f32_16x16x32_bf16 v[92:95], v[52:55], a[80:83], v[92:95]
    ds_read_b64_tr_b16 a[40:41], v24 offset:80
    ds_read_b64_tr_b16 a[42:43], v24 offset:1040
    s_waitcnt lgkmcnt(15)
    v_mfma_f32_16x16x32_bf16 v[96:99], v[48:51], a[84:87], v[96:99]
    v_mfma_f32_16x16x32_bf16 v[100:103], v[52:55], a[84:87], v[100:103]
    s_cmp_lg_u32 s20, 1
    s_cbranch_scc1 k1_kernel_nocs_26
    v_mfma_f32_16x16x32_bf16 a[0:3], v[32:35], a[76:79], a[0:3]
    v_mfma_f32_16x16x32_bf16 a[4:7], v[32:35], a[80:83], a[4:7]
    v_mfma_f32_16x16x32_bf16 a[8:11], v[32:35], a[84:87], a[8:11]
k1_kernel_nocs_26:
    ds_read_b64_tr_b16 a[44:45], v24 offset:112
    ds_read_b64_tr_b16 a[46:47], v24 offset:1072
    s_waitcnt lgkmcnt(15)
    v_mfma_f32_16x16x32_bf16 v[104:107], v[48:51], a[88:91], v[104:107]
    v_mfma_f32_16x16x32_bf16 v[108:111], v[52:55], a[88:91], v[108:111]
    ds_read_b64_tr_b16 a[48:49], v24 offset:144
    ds_read_b64_tr_b16 a[50:51], v24 offset:1104
    s_waitcnt lgkmcnt(15)
    v_mfma_f32_16x16x32_bf16 v[112:115], v[48:51], a[92:95], v[112:115]
    v_mfma_f32_16x16x32_bf16 v[116:119], v[52:55], a[92:95], v[116:119]
    ds_read_b64_tr_b16 a[52:53], v24 offset:160
    ds_read_b64_tr_b16 a[54:55], v24 offset:1120
    s_waitcnt lgkmcnt(15)
    v_mfma_f32_16x16x32_bf16 v[120:123], v[48:51], a[96:99], v[120:123]
    v_mfma_f32_16x16x32_bf16 v[124:127], v[52:55], a[96:99], v[124:127]
    s_cmp_lg_u32 s20, 2
    s_cbranch_scc1 k1_kernel_nocs_27
    v_mfma_f32_16x16x32_bf16 a[0:3], v[32:35], a[88:91], a[0:3]
    v_mfma_f32_16x16x32_bf16 a[4:7], v[32:35], a[92:95], a[4:7]
    v_mfma_f32_16x16x32_bf16 a[8:11], v[32:35], a[96:99], a[8:11]
k1_kernel_nocs_27:
    ds_read_b64_tr_b16 a[56:57], v24 offset:192
    ds_read_b64_tr_b16 a[58:59], v24 offset:1152
    s_waitcnt lgkmcnt(14)
    v_mfma_f32_16x16x32_bf16 v[56:59], a[28:31], v[40:43], v[56:59]
    v_mfma_f32_16x16x32_bf16 v[60:63], a[28:31], v[44:47], v[60:63]
    v_mfma_f32_16x16x32_bf16 a[12:15], v[32:35], v[40:43], a[12:15]
    v_mfma_f32_16x16x32_bf16 a[16:19], v[40:43], v[40:43], a[16:19]
    ds_read_b64_tr_b16 a[60:61], v24 offset:224
    ds_read_b64_tr_b16 a[62:63], v24 offset:1184
    s_waitcnt lgkmcnt(14)
    v_mfma_f32_16x16x32_bf16 v[64:67], a[32:35], v[40:43], v[64:67]
    v_mfma_f32_16x16x32_bf16 v[68:71], a[32:35], v[44:47], v[68:71]
    v_mfma_f32_16x16x32_bf16 a[20:23], v[32:35], v[44:47], a[20:23]
    v_mfma_f32_16x16x32_bf16 a[24:27], v[44:47], v[44:47], a[24:27]
    s_waitcnt lgkmcnt(12)
    v_mfma_f32_16x16x32_bf16 v[72:75], a[36:39], v[40:43], v[72:75]
    v_mfma_f32_16x16x32_bf16 v[76:79], a[36:39], v[44:47], v[76:79]
    s_cmp_lg_u32 s20, 0
    s_cbranch_scc1 k1_kernel_nocs_28
    v_mfma_f32_16x16x32_bf16 a[0:3], v[32:35], a[28:31], a[0:3]
    v_mfma_f32_16x16x32_bf16 a[4:7], v[32:35], a[32:35], a[4:7]
    v_mfma_f32_16x16x32_bf16 a[8:11], v[32:35], a[36:39], a[8:11]
k1_kernel_nocs_28:
    s_waitcnt lgkmcnt(10)
    v_mfma_f32_16x16x32_bf16 v[80:83], v[40:43], a[40:43], v[80:83]
    v_mfma_f32_16x16x32_bf16 v[84:87], v[44:47], a[40:43], v[84:87]
    s_waitcnt lgkmcnt(8)
    v_mfma_f32_16x16x32_bf16 v[88:91], v[40:43], a[44:47], v[88:91]
    v_mfma_f32_16x16x32_bf16 v[92:95], v[44:47], a[44:47], v[92:95]
    s_waitcnt lgkmcnt(6)
    v_mfma_f32_16x16x32_bf16 v[96:99], v[40:43], a[48:51], v[96:99]
    v_mfma_f32_16x16x32_bf16 v[100:103], v[44:47], a[48:51], v[100:103]
    s_cmp_lg_u32 s20, 1
    s_cbranch_scc1 k1_kernel_nocs_29
    v_mfma_f32_16x16x32_bf16 a[0:3], v[32:35], a[40:43], a[0:3]
    v_mfma_f32_16x16x32_bf16 a[4:7], v[32:35], a[44:47], a[4:7]
    v_mfma_f32_16x16x32_bf16 a[8:11], v[32:35], a[48:51], a[8:11]
k1_kernel_nocs_29:
    s_waitcnt lgkmcnt(4)
    v_mfma_f32_16x16x32_bf16 v[104:107], v[40:43], a[52:55], v[104:107]
    v_mfma_f32_16x16x32_bf16 v[108:111], v[44:47], a[52:55], v[108:111]
    s_waitcnt lgkmcnt(2)
    v_mfma_f32_16x16x32_bf16 v[112:115], v[40:43], a[56:59], v[112:115]
    v_mfma_f32_16x16x32_bf16 v[116:119], v[44:47], a[56:59], v[116:119]
    s_waitcnt lgkmcnt(0)
    v_mfma_f32_16x16x32_bf16 v[120:123], v[40:43], a[60:63], v[120:123]
    v_mfma_f32_16x16x32_bf16 v[124:127], v[44:47], a[60:63], v[124:127]
    s_cmp_lg_u32 s20, 2
    s_cbranch_scc1 k1_kernel_nocs_30
    v_mfma_f32_16x16x32_bf16 a[0:3], v[32:35], a[52:55], a[0:3]
    v_mfma_f32_16x16x32_bf16 a[4:7], v[32:35], a[56:59], a[4:7]
    v_mfma_f32_16x16x32_bf16 a[8:11], v[32:35], a[60:63], a[8:11]
k1_kernel_nocs_30:
    s_cmp_lg_u32 s26, 0
    s_cbranch_scc1 k1_kernel_nopoll0_31
    buffer_load_dword v10, v12, s[76:79], s29 offen offset:64 sc0 sc1
k1_kernel_nopoll0_31:
    s_add_u32 s48, s4, 0x2a00000
    s_addc_u32 s49, s5, 0
    s_mov_b32 s50, 0xa2000
    s_mov_b32 s51, 0x20000
    buffer_store_dwordx4 v[128:131], v146, s[48:51], 0 offen sc1
    s_cmp_eq_u32 s20, 3
    s_cbranch_scc1 k1_kernel_nocsadd_32
    s_mul_i32 s38, s20, 192
    s_add_u32 s38, s38, 149504
    v_lshl_add_u32 v8, v3, 2, s38
    s_mov_b64 exec, s[30:31]
    ds_add_f32 v8, a0 offset:0
    ds_add_f32 v8, a4 offset:64
    ds_add_f32 v8, a8 offset:128
    s_mov_b64 exec, -1
k1_kernel_nocsadd_32:
    v_cmp_eq_u32 s[44:45], 1, v5
    v_cmp_eq_u32 s[46:47], 2, v5
    v_cmp_eq_u32 s[48:49], 3, v5
    v_accvgpr_read_b32 v36, a12
    v_accvgpr_read_b32 v16, a16
    v_accvgpr_read_b32 v17, a17
    v_accvgpr_read_b32 v18, a18
    v_accvgpr_read_b32 v19, a19
    v_cndmask_b32 v16, v16, v17, s[44:45]
    v_cndmask_b32 v16, v16, v18, s[46:47]
    v_cndmask_b32 v37, v16, v19, s[48:49]
    v_accvgpr_read_b32 v38, a20
    v_accvgpr_read_b32 v16, a24
    v_accvgpr_read_b32 v17, a25
    v_accvgpr_read_b32 v18, a26
    v_accvgpr_read_b32 v19, a27
    v_cndmask_b32 v16, v16, v17, s[44:45]
    v_cndmask_b32 v16, v16, v18, s[46:47]
    v_cndmask_b32 v39, v16, v19, s[48:49]
    s_mul_i32 s38, s26, 9216
    s_add_u32 s38, s38, 31744
    s_cmp_ge_u32 s26, 6
    s_cselect_b32 s41, 39936, 0
    s_add_u32 s38, s38, s41
    v_add_u32 v8, s38, v6
    s_lshl_b32 s38, s26, 9
    s_add_u32 s38, s38, 145408
    v_lshl_add_u32 v9, v0, 3, s38
    ds_write_b64 v9, v[38:39]
    ds_write_b128 v8, v[60:63] offset:0
    ds_write_b128 v8, v[68:71] offset:1024
    ds_write_b128 v8, v[76:79] offset:2048
    ds_write_b128 v8, v[84:87] offset:3072
    ds_write_b128 v8, v[92:95] offset:4096
    ds_write_b128 v8, v[100:103] offset:5120
    ds_write_b128 v8, v[108:111] offset:6144
    ds_write_b128 v8, v[116:119] offset:7168
    ds_write_b128 v8, v[124:127] offset:8192
    v_lshlrev_b32 v16, 4, v2
    v_add_u32 v16, 149504, v16
    v_lshlrev_b32 v17, 2, v3
    v_add_u32 v17, 149504, v17
    s_xor_b32 s38, s26, 4
    s_mul_i32 s39, s38, 9216
    s_add_u32 s39, s39, 31744
    s_cmp_ge_u32 s38, 6
    s_cselect_b32 s41, 39936, 0
    s_add_u32 s39, s39, s41
    v_add_u32 v8, s39, v6
    s_lshl_b32 s38, s38, 9
    s_add_u32 s38, s38, 145408
    v_lshl_add_u32 v9, v0, 3, s38
    s_waitcnt lgkmcnt(0)
    s_barrier
    ds_read_b64 v[38:39], v9
    ds_read_b128 v[60:63], v8 offset:0
    ds_read_b128 v[68:71], v8 offset:1024
    ds_read_b128 v[76:79], v8 offset:2048
    ds_read_b128 v[84:87], v8 offset:3072
    ds_read_b128 v[92:95], v8 offset:4096
    ds_read_b128 v[100:103], v8 offset:5120
    ds_read_b128 v[108:111], v8 offset:6144
    ds_read_b128 v[116:119], v8 offset:7168
    ds_read_b128 v[124:127], v8 offset:8192
    s_waitcnt lgkmcnt(9)
    v_add_f32 v36, v36, v38
    v_add_f32 v38, v37, v39
    v_lshl_add_u32 v8, v4, 4, v3
    v_lshlrev_b32 v8, 2, v8
    ds_bpermute_b32 v38, v8, v38
    s_waitcnt lgkmcnt(0)
    ds_read_b128 v[128:131], v16 offset:0
    ds_read_b128 v[132:135], v16 offset:64
    ds_read_b128 v[136:139], v16 offset:128
    ds_read_b32 v140, v17 offset:192
    ds_read_b32 v141, v17 offset:256
    ds_read_b32 v142, v17 offset:320
    ds_read_b32 v143, v17 offset:384
    ds_read_b32 v144, v17 offset:448
    ds_read_b32 v145, v17 offset:512
    v_mul_f32 v36, 0x3ae38e39, v36
    v_mul_f32 v38, 0x3ae38e39, v38
    v_fma_f32 v38, -v36, v36, v38
    v_max_f32 v38, 0, v38
    v_cvt_pk_bf16_f32 v39, v36, v38
    v_lshlrev_b32 v36, 16, v39
    v_and_b32 v38, 0xffff0000, v39
    v_add_f32 v38, 0x3727c5ac, v38
    v_cvt_pk_bf16_f32 v39, v38, v38
    v_lshlrev_b32 v38, 16, v39
    v_sqrt_f32 v38, v38
    v_sub_f32 v36, 0, v36
    v_cvt_pk_bf16_f32 v39, v38, v38
    v_lshlrev_b32 v38, 16, v39
    v_rcp_f32 v37, v38
    s_lshl_b32 s38, s26, 7
    s_add_u32 s38, s38, 150144
    v_lshl_add_u32 v8, v3, 3, s38
    s_mov_b64 exec, s[30:31]
    ds_write_b64 v8, v[36:37]
    s_mov_b64 exec, -1
    v_add_f32 v56, v56, v60
    v_add_f32 v57, v57, v61
    v_add_f32 v58, v58, v62
    v_add_f32 v59, v59, v63
    v_add_f32 v64, v64, v68
    v_add_f32 v65, v65, v69
    v_add_f32 v66, v66, v70
    v_add_f32 v67, v67, v71
    v_add_f32 v72, v72, v76
    v_add_f32 v73, v73, v77
    v_add_f32 v74, v74, v78
    v_add_f32 v75, v75, v79
    v_add_f32 v80, v80, v84
    v_add_f32 v81, v81, v85
    v_add_f32 v82, v82, v86
    v_add_f32 v83, v83, v87
    v_add_f32 v88, v88, v92
    v_add_f32 v89, v89, v93
    v_add_f32 v90, v90, v94
    v_add_f32 v91, v91, v95
    v_add_f32 v96, v96, v100
    v_add_f32 v97, v97, v101
    v_add_f32 v98, v98, v102
    v_add_f32 v99, v99, v103
    v_add_f32 v104, v104, v108
    v_add_f32 v105, v105, v109
    v_add_f32 v106, v106, v110
    v_add_f32 v107, v107, v111
    v_add_f32 v112, v112, v116
    v_add_f32 v113, v113, v117
    v_add_f32 v114, v114, v118
    v_add_f32 v115, v115, v119
    v_add_f32 v120, v120, v124
    v_add_f32 v121, v121, v125
    v_add_f32 v122, v122, v126
    v_add_f32 v123, v123, v127
    v_lshl_add_u32 v8, v2, 5, s38
    s_waitcnt lgkmcnt(0)
    ds_read_b128 v[48:51], v8
    ds_read_b128 v[52:55], v8 offset:16
    s_waitcnt lgkmcnt(0)
    v_cmp_eq_u32 s[52:53], 4, v3
    v_fma_f32 v80, v140, v48, v80
    v_fma_f32 v81, v140, v50, v81
    v_fma_f32 v82, v140, v52, v82
    v_fma_f32 v83, v140, v54, v83
    v_mul_f32 v80, v80, v49
    v_mul_f32 v81, v81, v51
    v_mul_f32 v82, v82, v53
    v_mul_f32 v83, v83, v55
    v_min_f32 v20, 0, v80
    v_min_f32 v21, 0, v81
    v_min_f32 v22, 0, v82
    v_min_f32 v23, 0, v83
    v_mul_f32 v20, 0x3fb8aa3b, v20
    v_mul_f32 v21, 0x3fb8aa3b, v21
    v_mul_f32 v22, 0x3fb8aa3b, v22
    v_mul_f32 v23, 0x3fb8aa3b, v23
    v_exp_f32 v20, v20
    v_exp_f32 v21, v21
    v_exp_f32 v22, v22
    v_exp_f32 v23, v23
    v_max_f32 v80, 0, v80
    v_max_f32 v81, 0, v81
    v_max_f32 v82, 0, v82
    v_max_f32 v83, 0, v83
    v_add_f32 v80, v80, v20
    v_add_f32 v81, v81, v21
    v_add_f32 v82, v82, v22
    v_add_f32 v83, v83, v23
    v_add_f32 v80, 0x358637bd, v80
    v_add_f32 v81, 0x358637bd, v81
    v_add_f32 v82, 0x358637bd, v82
    v_add_f32 v83, 0x358637bd, v83
    v_cvt_pk_bf16_f32 v60, v80, v81
    v_cvt_pk_bf16_f32 v61, v82, v83
    v_fma_f32 v88, v141, v48, v88
    v_fma_f32 v89, v141, v50, v89
    v_fma_f32 v90, v141, v52, v90
    v_fma_f32 v91, v141, v54, v91
    v_mul_f32 v88, v88, v49
    v_mul_f32 v89, v89, v51
    v_mul_f32 v90, v90, v53
    v_mul_f32 v91, v91, v55
    v_min_f32 v20, 0, v88
    v_min_f32 v21, 0, v89
    v_min_f32 v22, 0, v90
    v_min_f32 v23, 0, v91
    v_mul_f32 v20, 0x3fb8aa3b, v20
    v_mul_f32 v21, 0x3fb8aa3b, v21
    v_mul_f32 v22, 0x3fb8aa3b, v22
    v_mul_f32 v23, 0x3fb8aa3b, v23
    v_exp_f32 v20, v20
    v_exp_f32 v21, v21
    v_exp_f32 v22, v22
    v_exp_f32 v23, v23
    v_max_f32 v88, 0, v88
    v_max_f32 v89, 0, v89
    v_max_f32 v90, 0, v90
    v_max_f32 v91, 0, v91
    v_add_f32 v88, v88, v20
    v_add_f32 v89, v89, v21
    v_add_f32 v90, v90, v22
    v_add_f32 v91, v91, v23
    v_add_f32 v88, 0x358637bd, v88
    v_add_f32 v89, 0x358637bd, v89
    v_add_f32 v90, 0x358637bd, v90
    v_add_f32 v91, 0x358637bd, v91
    v_cvt_pk_bf16_f32 v62, v88, v89
    v_cvt_pk_bf16_f32 v63, v90, v91
    v_fma_f32 v96, v142, v48, v96
    v_fma_f32 v97, v142, v50, v97
    v_fma_f32 v98, v142, v52, v98
    v_fma_f32 v99, v142, v54, v99
    v_mul_f32 v96, v96, v49
    v_mul_f32 v97, v97, v51
    v_mul_f32 v98, v98, v53
    v_mul_f32 v99, v99, v55
    v_min_f32 v20, 0, v96
    v_min_f32 v21, 0, v97
    v_min_f32 v22, 0, v98
    v_min_f32 v23, 0, v99
    v_mul_f32 v20, 0x3fb8aa3b, v20
    v_mul_f32 v21, 0x3fb8aa3b, v21
    v_mul_f32 v22, 0x3fb8aa3b, v22
    v_mul_f32 v23, 0x3fb8aa3b, v23
    v_exp_f32 v20, v20
    v_exp_f32 v21, v21
    v_exp_f32 v22, v22
    v_exp_f32 v23, v23
    v_max_f32 v96, 0, v96
    v_max_f32 v97, 0, v97
    v_max_f32 v98, 0, v98
    v_max_f32 v99, 0, v99
    v_add_f32 v96, v96, v20
    v_add_f32 v97, v97, v21
    v_add_f32 v98, v98, v22
    v_add_f32 v99, v99, v23
    v_add_f32 v96, 0x358637bd, v96
    v_add_f32 v97, 0x358637bd, v97
    v_add_f32 v98, 0x358637bd, v98
    v_add_f32 v99, 0x358637bd, v99
    v_cvt_pk_bf16_f32 v68, v96, v97
    v_cvt_pk_bf16_f32 v69, v98, v99
    v_fma_f32 v104, v143, v48, v104
    v_fma_f32 v105, v143, v50, v105
    v_fma_f32 v106, v143, v52, v106
    v_fma_f32 v107, v143, v54, v107
    v_mul_f32 v104, v104, v49
    v_mul_f32 v105, v105, v51
    v_mul_f32 v106, v106, v53
    v_mul_f32 v107, v107, v55
    v_cvt_pk_bf16_f32 v70, v104, v105
    v_cvt_pk_bf16_f32 v71, v106, v107
    v_fma_f32 v112, v144, v48, v112
    v_fma_f32 v113, v144, v50, v113
    v_fma_f32 v114, v144, v52, v114
    v_fma_f32 v115, v144, v54, v115
    v_mul_f32 v112, v112, v49
    v_mul_f32 v113, v113, v51
    v_mul_f32 v114, v114, v53
    v_mul_f32 v115, v115, v55
    v_cvt_pk_bf16_f32 v76, v112, v113
    v_cvt_pk_bf16_f32 v77, v114, v115
    v_fma_f32 v120, v145, v48, v120
    v_fma_f32 v121, v145, v50, v121
    v_fma_f32 v122, v145, v52, v122
    v_fma_f32 v123, v145, v54, v123
    v_mul_f32 v120, v120, v49
    v_mul_f32 v121, v121, v51
    v_mul_f32 v122, v122, v53
    v_mul_f32 v123, v123, v55
    v_cndmask_b32 v120, v120, 1.0, s[52:53]
    v_cndmask_b32 v121, v121, 1.0, s[52:53]
    v_cndmask_b32 v122, v122, 1.0, s[52:53]
    v_cndmask_b32 v123, v123, 1.0, s[52:53]
    v_cvt_pk_bf16_f32 v78, v120, v121
    v_cvt_pk_bf16_f32 v79, v122, v123
    v_mfma_f32_16x16x16_bf16 v[80:83], v[60:61], v[70:71], 0
    v_mfma_f32_16x16x16_bf16 v[84:87], v[60:61], v[76:77], 0
    v_mfma_f32_16x16x16_bf16 v[88:91], v[60:61], v[78:79], 0
    v_mfma_f32_16x16x16_bf16 v[92:95], v[62:63], v[70:71], 0
    v_mfma_f32_16x16x16_bf16 v[96:99], v[62:63], v[76:77], 0
    v_mfma_f32_16x16x16_bf16 v[100:103], v[62:63], v[78:79], 0
    v_mfma_f32_16x16x16_bf16 v[104:107], v[68:69], v[70:71], 0
    v_mfma_f32_16x16x16_bf16 v[108:111], v[68:69], v[76:77], 0
    v_mfma_f32_16x16x16_bf16 v[112:115], v[68:69], v[78:79], 0
    s_and_b32 s43, s26, 3
    s_mul_i32 s43, s43, 7696
    s_mul_i32 s41, s21, 87040
    s_add_u32 s43, s43, s41
    v_mul_u32_u24 v8, 208, v3
    v_lshl_add_u32 v8, v2, 4, v8
    v_add_u32 v8, s43, v8
    v_cmp_gt_u32 vcc, 5, v3
    ds_write_b128 v8, v[80:83] offset:0
    ds_write_b128 v8, v[92:95] offset:64
    ds_write_b128 v8, v[104:107] offset:128
    ds_write_b128 v8, v[84:87] offset:3328
    ds_write_b128 v8, v[96:99] offset:3392
    ds_write_b128 v8, v[108:111] offset:3456
    s_mov_b64 exec, vcc
    ds_write_b128 v8, v[88:91] offset:6656
    ds_write_b128 v8, v[100:103] offset:6720
    ds_write_b128 v8, v[112:115] offset:6784
    s_mov_b64 exec, -1
    v_and_b32 v16, 3, v0
    v_lshrrev_b32 v17, 2, v0
    v_and_b32 v18, 3, v17
    v_lshrrev_b32 v19, 2, v17
    s_and_b32 s27, s26, 3
    s_lshl_b32 s38, s27, 2
    s_and_b32 s39, s24, 3
    s_and_b32 s41, s24, 1
    s_lshl_b32 s41, s41, 1
    s_add_u32 s42, s41, 1
    v_cmp_gt_u32 s[44:45], 2, v16
    v_cmp_gt_u32 s[46:47], 2, v18
    v_cmp_eq_u32 s[48:49], s41, v19
    v_cmp_eq_u32 s[50:51], s42, v19
    v_cmp_eq_u32 s[52:53], 2, v18
    v_cmp_eq_u32 s[54:55], 3, v18
    s_and_b64 s[48:49], s[48:49], s[46:47]
    s_and_b64 s[50:51], s[50:51], s[46:47]
    s_or_b64 s[48:49], s[48:49], s[52:53]
    s_or_b64 s[50:51], s[50:51], s[54:55]
    s_cmp_eq_u32 s27, 0
    s_cselect_b64 s[56:57], -1, 0
    s_cmp_eq_u32 s27, s39
    s_cselect_b64 s[58:59], -1, 0
    v_add_u32 v20, s38, v16
    v_add_u32 v21, 16, v20
    v_add_u32 v22, 32, v16
    v_cmp_le_u32 s[60:61], 18, v21
    v_add_u32 v23, 18, v17
    v_add_u32 v24, 16, v18
    v_cndmask_b32 v24, 36, v24, s[46:47]
    v_add_u32 v25, 34, v18
    v_cndmask_b32 v25, 36, v25, s[46:47]
    v_cndmask_b32 v26, v25, v24, s[48:49]
    s_and_b64 s[62:63], s[56:57], s[44:45]
    s_mov_b64 s[64:65], -1
    s_mov_b64 s[66:67], s[62:63]
    s_mov_b64 s[68:69], s[60:61]
    s_mov_b64 s[70:71], s[58:59]
    s_mov_b64 s[72:73], s[48:49]
    s_and_b64 s[74:75], s[48:49], s[62:63]
    s_and_b64 s[44:45], s[50:51], s[60:61]
    s_or_b64 s[74:75], s[74:75], s[44:45]
    s_and_b64 s[46:47], s[50:51], s[58:59]
    v_and_b32 v27, 255, v1
    v_lshlrev_b32 v27, 2, v27
    s_mul_i32 s38, s24, 7168
    s_add_u32 s39, s38, 4096
    s_cmp_lg_u32 s26, 0
    s_cbranch_scc1 k1_kernel_polldone_34
    s_waitcnt vmcnt(1)
    v_readfirstlane_b32 s41, v10
    s_nop 0
    s_cmp_eq_u32 s41, 1
    s_cbranch_scc1 k1_kernel_polldone_34
    s_cmp_eq_u32 s25, 0
    s_cbranch_scc1 k1_kernel_poll_33
    v_mov_b32 v11, 1
    s_mov_b64 exec, 1
    buffer_atomic_add v11, v12, s[76:79], s29 offen sc0 sc1
    s_mov_b64 exec, -1
    s_waitcnt vmcnt(0)
    v_readfirstlane_b32 s41, v11
    s_nop 0
    s_cmp_lg_u32 s41, 0
    s_cbranch_scc1 k1_kernel_poll_33
    s_mul_i32 s41, s24, 7168
    s_add_u32 s42, s41, 4096
    buffer_store_dwordx4 v[12:15], v6, s[80:83], s41 offen offset:0 sc0 sc1
    buffer_store_dwordx4 v[12:15], v6, s[80:83], s41 offen offset:1024 sc0 sc1
    buffer_store_dwordx4 v[12:15], v6, s[80:83], s41 offen offset:2048 sc0 sc1
    buffer_store_dwordx4 v[12:15], v6, s[80:83], s41 offen offset:3072 sc0 sc1
    buffer_store_dwordx4 v[12:15], v6, s[80:83], s42 offen offset:0 sc0 sc1
    buffer_store_dwordx4 v[12:15], v6, s[80:83], s42 offen offset:1024 sc0 sc1
    buffer_store_dwordx4 v[12:15], v6, s[80:83], s42 offen offset:2048 sc0 sc1
    s_waitcnt vmcnt(0)
    v_mov_b32 v31, 1
    s_mov_b64 exec, 1
    buffer_store_dword v31, v12, s[76:79], s29 offen offset:64 sc0 sc1
    s_mov_b64 exec, -1
k1_kernel_poll_33:
    buffer_load_dword v10, v12, s[76:79], s29 offen offset:64 sc0 sc1
    s_waitcnt vmcnt(0)
    v_readfirstlane_b32 s41, v10
    s_nop 0
    s_cmp_eq_u32 s41, 1
    s_cbranch_scc1 k1_kernel_polldone_34
    s_sleep 2
    s_nop 0
    s_branch k1_kernel_poll_33
k1_kernel_polldone_34:
    s_waitcnt lgkmcnt(0)
    s_barrier
    s_cmp_ge_u32 s26, 4
    s_cbranch_scc1 k1_kernel_half1_35
    v_mul_u32_u24 v80, 52, v17
    v_add_lshl_u32 v80, v80, v20, 2
    v_add_u32 v80, 0, v80
    v_add_u32 v82, 87040, v80
    v_cndmask_b32 v81, v7, v27, s[64:65]
    ds_read_b32 v84, v80 offset:0
    ds_read_b32 v85, v80 offset:7696
    ds_read_b32 v86, v80 offset:15392
    ds_read_b32 v87, v80 offset:23088
    ds_read_b32 v88, v82 offset:0
    ds_read_b32 v89, v82 offset:7696
    ds_read_b32 v90, v82 offset:15392
    ds_read_b32 v91, v82 offset:23088
    s_nop 0
    v_mul_u32_u24 v92, 52, v23
    v_add_lshl_u32 v92, v92, v22, 2
    v_add_u32 v92, 0, v92
    v_add_u32 v94, 87040, v92
    v_cndmask_b32 v93, v7, v27, s[70:71]
    ds_read_b32 v96, v92 offset:0
    ds_read_b32 v97, v92 offset:7696
    ds_read_b32 v98, v92 offset:15392
    ds_read_b32 v99, v92 offset:23088
    ds_read_b32 v100, v94 offset:0
    ds_read_b32 v101, v94 offset:7696
    ds_read_b32 v102, v94 offset:15392
    ds_read_b32 v103, v94 offset:23088
    s_waitcnt lgkmcnt(8)
    v_add_f32 v84, v84, v85
    v_add_f32 v86, v86, v87
    v_add_f32 v88, v88, v89
    v_add_f32 v90, v90, v91
    v_add_f32 v84, v84, v86
    v_add_f32 v88, v88, v90
    v_add_f32 v84, v84, v88
    buffer_atomic_add_f32 v84, v81, s[80:83], s38 offen offset:0
    v_mul_u32_u24 v104, 52, v24
    v_add_lshl_u32 v104, v104, v20, 2
    v_add_u32 v104, 0, v104
    v_add_u32 v106, 87040, v104
    v_cndmask_b32 v105, v7, v27, s[72:73]
    ds_read_b32 v108, v104 offset:0
    ds_read_b32 v109, v104 offset:7696
    ds_read_b32 v110, v104 offset:15392
    ds_read_b32 v111, v104 offset:23088
    ds_read_b32 v112, v106 offset:0
    ds_read_b32 v113, v106 offset:7696
    ds_read_b32 v114, v106 offset:15392
    ds_read_b32 v115, v106 offset:23088
    s_waitcnt lgkmcnt(8)
    v_add_f32 v96, v96, v97
    v_add_f32 v98, v98, v99
    v_add_f32 v100, v100, v101
    v_add_f32 v102, v102, v103
    v_add_f32 v96, v96, v98
    v_add_f32 v100, v100, v102
    v_add_f32 v96, v96, v100
    buffer_atomic_add_f32 v96, v93, s[80:83], s38 offen offset:3072
    v_mul_u32_u24 v116, 52, v25
    v_add_lshl_u32 v116, v116, v22, 2
    v_add_u32 v116, 0, v116
    v_add_u32 v118, 87040, v116
    v_cndmask_b32 v117, v7, v27, s[46:47]
    ds_read_b32 v120, v116 offset:0
    ds_read_b32 v121, v116 offset:7696
    ds_read_b32 v122, v116 offset:15392
    ds_read_b32 v123, v116 offset:23088
    ds_read_b32 v124, v118 offset:0
    ds_read_b32 v125, v118 offset:7696
    ds_read_b32 v126, v118 offset:15392
    ds_read_b32 v127, v118 offset:23088
    s_waitcnt lgkmcnt(8)
    v_add_f32 v108, v108, v109
    v_add_f32 v110, v110, v111
    v_add_f32 v112, v112, v113
    v_add_f32 v114, v114, v115
    v_add_f32 v108, v108, v110
    v_add_f32 v112, v112, v114
    v_add_f32 v108, v108, v112
    buffer_atomic_add_f32 v108, v105, s[80:83], s39 offen offset:0
    s_waitcnt lgkmcnt(0)
    v_add_f32 v120, v120, v121
    v_add_f32 v122, v122, v123
    v_add_f32 v124, v124, v125
    v_add_f32 v126, v126, v127
    v_add_f32 v120, v120, v122
    v_add_f32 v124, v124, v126
    v_add_f32 v120, v120, v124
    buffer_atomic_add_f32 v120, v117, s[80:83], s39 offen offset:2048
    s_branch k1_kernel_fin_36
k1_kernel_half1_35:
    v_mul_u32_u24 v80, 52, v23
    v_add_lshl_u32 v80, v80, v21, 2
    v_add_u32 v80, 0, v80
    v_add_u32 v82, 87040, v80
    v_cndmask_b32 v81, v7, v27, s[68:69]
    ds_read_b32 v84, v80 offset:0
    ds_read_b32 v85, v80 offset:7696
    ds_read_b32 v86, v80 offset:15392
    ds_read_b32 v87, v80 offset:23088
    ds_read_b32 v88, v82 offset:0
    ds_read_b32 v89, v82 offset:7696
    ds_read_b32 v90, v82 offset:15392
    ds_read_b32 v91, v82 offset:23088
    s_nop 0
    v_mul_u32_u24 v92, 52, v17
    v_add_lshl_u32 v92, v92, v21, 2
    v_add_u32 v92, 0, v92
    v_add_u32 v94, 87040, v92
    v_cndmask_b32 v93, v7, v27, s[66:67]
    ds_read_b32 v96, v92 offset:0
    ds_read_b32 v97, v92 offset:7696
    ds_read_b32 v98, v92 offset:15392
    ds_read_b32 v99, v92 offset:23088
    ds_read_b32 v100, v94 offset:0
    ds_read_b32 v101, v94 offset:7696
    ds_read_b32 v102, v94 offset:15392
    ds_read_b32 v103, v94 offset:23088
    s_waitcnt lgkmcnt(8)
    v_add_f32 v84, v84, v85
    v_add_f32 v86, v86, v87
    v_add_f32 v88, v88, v89
    v_add_f32 v90, v90, v91
    v_add_f32 v84, v84, v86
    v_add_f32 v88, v88, v90
    v_add_f32 v84, v84, v88
    buffer_atomic_add_f32 v84, v81, s[80:83], s38 offen offset:2048
    v_mul_u32_u24 v104, 52, v26
    v_add_lshl_u32 v104, v104, v21, 2
    v_add_u32 v104, 0, v104
    v_add_u32 v106, 87040, v104
    v_cndmask_b32 v105, v7, v27, s[74:75]
    ds_read_b32 v108, v104 offset:0
    ds_read_b32 v109, v104 offset:7696
    ds_read_b32 v110, v104 offset:15392
    ds_read_b32 v111, v104 offset:23088
    ds_read_b32 v112, v106 offset:0
    ds_read_b32 v113, v106 offset:7696
    ds_read_b32 v114, v106 offset:15392
    ds_read_b32 v115, v106 offset:23088
    s_waitcnt lgkmcnt(8)
    v_add_f32 v96, v96, v97
    v_add_f32 v98, v98, v99
    v_add_f32 v100, v100, v101
    v_add_f32 v102, v102, v103
    v_add_f32 v96, v96, v98
    v_add_f32 v100, v100, v102
    v_add_f32 v96, v96, v100
    buffer_atomic_add_f32 v96, v93, s[80:83], s38 offen offset:1024
    s_waitcnt lgkmcnt(0)
    v_add_f32 v108, v108, v109
    v_add_f32 v110, v110, v111
    v_add_f32 v112, v112, v113
    v_add_f32 v114, v114, v115
    v_add_f32 v108, v108, v110
    v_add_f32 v112, v112, v114
    v_add_f32 v108, v108, v112
    buffer_atomic_add_f32 v108, v105, s[80:83], s39 offen offset:1024
k1_kernel_fin_36:
    s_add_u32 s64, s4, 0x40000
    s_addc_u32 s65, s5, 0
    s_mov_b32 s66, 0x200000
    s_mov_b32 s67, 0x20000
    s_add_u32 s68, s4, 0x240000
    s_addc_u32 s69, s5, 0
    s_mov_b32 s70, 0x40000
    s_mov_b32 s71, 0x20000
    s_lshl_b32 s38, s25, 3
    s_lshl_b32 s39, s20, 1
    s_add_u32 s38, s38, s39
    s_add_u32 s38, s38, s21
    s_lshl_b32 s38, s38, 4
    s_add_u32 s38, s38, s24
    s_lshl_b32 s39, s38, 7
    s_lshl_b32 s38, s38, 10
    v_lshlrev_b32 v9, 3, v3
    v_cndmask_b32 v9, v7, v9, s[30:31]
    v_fma_f32 v56, v128, v36, v56
    v_fma_f32 v57, v129, v36, v57
    v_fma_f32 v58, v130, v36, v58
    v_fma_f32 v59, v131, v36, v59
    v_mul_f32 v56, v56, v37
    v_mul_f32 v57, v57, v37
    v_mul_f32 v58, v58, v37
    v_mul_f32 v59, v59, v37
    v_min_f32 v20, 0, v56
    v_min_f32 v21, 0, v57
    v_min_f32 v22, 0, v58
    v_min_f32 v23, 0, v59
    v_mul_f32 v20, 0x3fb8aa3b, v20
    v_mul_f32 v21, 0x3fb8aa3b, v21
    v_mul_f32 v22, 0x3fb8aa3b, v22
    v_mul_f32 v23, 0x3fb8aa3b, v23
    v_exp_f32 v20, v20
    v_exp_f32 v21, v21
    v_exp_f32 v22, v22
    v_exp_f32 v23, v23
    v_max_f32 v56, 0, v56
    v_max_f32 v57, 0, v57
    v_max_f32 v58, 0, v58
    v_max_f32 v59, 0, v59
    v_add_f32 v56, v56, v20
    v_add_f32 v57, v57, v21
    v_add_f32 v58, v58, v22
    v_add_f32 v59, v59, v23
    v_add_f32 v56, 0x358637bd, v56
    v_add_f32 v57, 0x358637bd, v57
    v_add_f32 v58, 0x358637bd, v58
    v_add_f32 v59, 0x358637bd, v59
    v_cvt_pk_bf16_f32 v40, v56, v57
    v_cvt_pk_bf16_f32 v41, v58, v59
    v_fma_f32 v64, v132, v36, v64
    v_fma_f32 v65, v133, v36, v65
    v_fma_f32 v66, v134, v36, v66
    v_fma_f32 v67, v135, v36, v67
    v_mul_f32 v64, v64, v37
    v_mul_f32 v65, v65, v37
    v_mul_f32 v66, v66, v37
    v_mul_f32 v67, v67, v37
    v_min_f32 v20, 0, v64
    v_min_f32 v21, 0, v65
    v_min_f32 v22, 0, v66
    v_min_f32 v23, 0, v67
    v_mul_f32 v20, 0x3fb8aa3b, v20
    v_mul_f32 v21, 0x3fb8aa3b, v21
    v_mul_f32 v22, 0x3fb8aa3b, v22
    v_mul_f32 v23, 0x3fb8aa3b, v23
    v_exp_f32 v20, v20
    v_exp_f32 v21, v21
    v_exp_f32 v22, v22
    v_exp_f32 v23, v23
    v_max_f32 v64, 0, v64
    v_max_f32 v65, 0, v65
    v_max_f32 v66, 0, v66
    v_max_f32 v67, 0, v67
    v_add_f32 v64, v64, v20
    v_add_f32 v65, v65, v21
    v_add_f32 v66, v66, v22
    v_add_f32 v67, v67, v23
    v_add_f32 v64, 0x358637bd, v64
    v_add_f32 v65, 0x358637bd, v65
    v_add_f32 v66, 0x358637bd, v66
    v_add_f32 v67, 0x358637bd, v67
    v_cvt_pk_bf16_f32 v42, v64, v65
    v_cvt_pk_bf16_f32 v43, v66, v67
    v_fma_f32 v72, v136, v36, v72
    v_fma_f32 v73, v137, v36, v73
    v_fma_f32 v74, v138, v36, v74
    v_fma_f32 v75, v139, v36, v75
    v_mul_f32 v72, v72, v37
    v_mul_f32 v73, v73, v37
    v_mul_f32 v74, v74, v37
    v_mul_f32 v75, v75, v37
    v_min_f32 v20, 0, v72
    v_min_f32 v21, 0, v73
    v_min_f32 v22, 0, v74
    v_min_f32 v23, 0, v75
    v_mul_f32 v20, 0x3fb8aa3b, v20
    v_mul_f32 v21, 0x3fb8aa3b, v21
    v_mul_f32 v22, 0x3fb8aa3b, v22
    v_mul_f32 v23, 0x3fb8aa3b, v23
    v_exp_f32 v20, v20
    v_exp_f32 v21, v21
    v_exp_f32 v22, v22
    v_exp_f32 v23, v23
    v_max_f32 v72, 0, v72
    v_max_f32 v73, 0, v73
    v_max_f32 v74, 0, v74
    v_max_f32 v75, 0, v75
    v_add_f32 v72, v72, v20
    v_add_f32 v73, v73, v21
    v_add_f32 v74, v74, v22
    v_add_f32 v75, v75, v23
    v_add_f32 v72, 0x358637bd, v72
    v_add_f32 v73, 0x358637bd, v73
    v_add_f32 v74, 0x358637bd, v74
    v_add_f32 v75, 0x358637bd, v75
    v_cvt_pk_bf16_f32 v44, v72, v73
    v_cvt_pk_bf16_f32 v45, v74, v75
    buffer_store_dwordx4 v[40:43], v6, s[64:67], s38 offen sc1
    buffer_store_dwordx2 v[44:45], v9, s[68:71], s39 offen sc1
k1_kernel_end:
    s_endpgm
.globl k2_kernel
.p2align 8
.type k2_kernel,@function
k2_kernel:
    s_cmp_ge_u32 s2, 256
    s_cbranch_scc1 k2_kernel_end
    s_getpc_b64 s[16:17]
k2_kernel_pc:
    v_lshlrev_b32 v198, 7, v0
    v_min_u32 v198, k2_kernel_end-k2_kernel_pc, v198
    global_load_dword v199, v198, s[16:17]
    s_load_dwordx2 s[4:5], s[0:1], 72
    s_load_dwordx2 s[6:7], s[0:1], 0
    s_load_dwordx2 s[8:9], s[0:1], 16
    s_load_dwordx4 s[12:15], s[0:1], 32
    s_lshr_b32 s21, s2, 3
    s_and_b32 s24, s21, 7
    s_and_b32 s25, s2, 7
    s_lshl_b32 s25, s25, 2
    s_lshr_b32 s20, s2, 6
    s_add_u32 s25, s25, s20
    s_bfe_u32 s22, s2, 0x10002
    s_and_b32 s23, s2, 3
    v_lshrrev_b32 v1, 6, v0
    v_and_b32 v0, 63, v0
    v_readfirstlane_b32 s26, v1
    v_lshrrev_b32 v1, 4, v0
    v_and_b32 v2, 15, v0
    v_bfe_u32 v3, v0, 2, 2
    v_and_b32 v4, 3, v0
    v_lshlrev_b32 v5, 4, v0
    v_mov_b32 v6, 0x7f000000
    v_mov_b32 v7, 138240
    v_mov_b32 v8, 0
    ds_write_b32 v7, v8
    s_waitcnt lgkmcnt(0)
    s_barrier
    s_cmp_ge_u32 s26, 4
    s_cbranch_scc1 k2_kernel_prep_1
    v_cmp_eq_u32 s[30:31], 0, v1
    v_lshlrev_b32 v17, 3, v2
    s_nop 0
    v_cndmask_b32 v16, v6, v17, s[30:31]
    v_lshlrev_b32 v8, 3, v0
    v_and_b32 v17, 1, v1
    v_cmp_eq_u32 s[42:43], 1, v17
    s_mov_b32 s27, 0x1c71c71d
    v_cmp_eq_u32 vcc, 0, v1
    s_nop 1
    v_cndmask_b32 v20, v6, v5, vcc
    v_cmp_eq_u32 vcc, 1, v1
    s_nop 1
    v_cndmask_b32 v21, v6, v5, vcc
    v_cmp_eq_u32 vcc, 2, v1
    s_nop 1
    v_cndmask_b32 v22, v6, v5, vcc
    v_cmp_eq_u32 vcc, 3, v1
    s_nop 1
    v_cndmask_b32 v23, v6, v5, vcc
    v_add_u32 v40, 0, v0
    v_mul_hi_u32 v41, v40, s27
    v_mul_u32_u24 v42, 9, v41
    v_sub_u32 v42, v40, v42
    v_mul_u32_u24 v41, 1152, v41
    v_lshl_add_u32 v17, v42, 4, v41
    v_add_u32 v40, 64, v0
    v_mul_hi_u32 v41, v40, s27
    v_mul_u32_u24 v42, 9, v41
    v_sub_u32 v42, v40, v42
    v_mul_u32_u24 v41, 1152, v41
    v_lshl_add_u32 v18, v42, 4, v41
    v_add_u32 v40, 128, v0
    v_mul_hi_u32 v41, v40, s27
    v_mul_u32_u24 v42, 9, v41
    v_sub_u32 v42, v40, v42
    v_mul_u32_u24 v41, 1152, v41
    v_lshl_add_u32 v19, v42, 4, v41
    s_mul_i32 s27, s26, 20736
    v_lshl_add_u32 v40, v1, 2, v3
    v_mul_u32_u24 v40, 144, v40
    v_lshl_add_u32 v40, v4, 3, v40
    v_add_u32 v35, s27, v40
    v_mul_u32_u24 v40, 18, v1
    v_and_b32 v41, 1, v3
    v_lshrrev_b32 v42, 1, v3
    v_mul_u32_u24 v42, 72, v42
    v_add3_u32 v40, v40, v41, v42
    v_add_u32 v40, 16, v40
    v_mul_u32_u24 v40, 144, v40
    v_lshl_add_u32 v40, v4, 3, v40
    v_add_u32 v36, s27, v40
    v_cmp_gt_u32 s[44:45], 32, v0
    s_mul_i32 s53, s26, 2304
    s_add_u32 s53, s53, 129024
    v_mul_u32_u24 v40, 144, v2
    v_lshl_add_u32 v40, v1, 3, v40
    v_add_u32 v37, s53, v40
    s_waitcnt lgkmcnt(0)
    s_add_u32 s64, s4, 0x3100000
    s_addc_u32 s65, s5, 0
    s_mov_b32 s66, 0x1c000
    s_mov_b32 s67, 0x20000
    s_add_u32 s68, s4, 0x40000
    s_addc_u32 s69, s5, 0
    s_mov_b32 s70, 0x200000
    s_mov_b32 s71, 0x20000
    s_add_u32 s72, s4, 0x240000
    s_addc_u32 s73, s5, 0
    s_mov_b32 s74, 0x40000
    s_mov_b32 s75, 0x20000
    s_add_u32 s76, s4, 0x2a00000
    s_addc_u32 s77, s5, 0
    s_mov_b32 s78, 0xa2000
    s_mov_b32 s79, 0x20000
    s_mov_b32 s80, s6
    s_mov_b32 s81, s7
    s_mov_b32 s82, 0x240000
    s_mov_b32 s83, 0x20000
    s_mul_i32 s54, s26, 28672
    s_lshl_b32 s28, s25, 6
    s_lshl_b32 s29, s26, 2
    s_add_u32 s28, s28, s29
    s_lshl_b32 s55, s28, 10
    s_lshl_b32 s56, s28, 7
    s_lshl_b32 s57, s24, 2
    s_add_u32 s57, s57, s26
    s_mul_i32 s57, s57, 20736
    s_lshl_b32 s28, s25, 6
    s_lshl_b32 s29, s26, 4
    s_add_u32 s28, s28, s29
    s_mul_i32 s28, s28, 1152
    s_mul_i32 s29, s24, 144
    s_add_u32 s48, s28, s29
    s_add_u32 s61, s54, 0
    buffer_load_dwordx4 v[48:51], v5, s[64:67], s61 offen
    s_add_u32 s62, s54, 1024
    buffer_load_dwordx4 v[52:55], v20, s[64:67], s62 offen
    s_add_u32 s63, s54, 2048
    buffer_load_dwordx4 v[56:59], v5, s[64:67], s63 offen
    s_add_u32 s60, s54, 3072
    buffer_load_dwordx4 v[60:63], v20, s[64:67], s60 offen
    s_add_u32 s61, s54, 4096
    buffer_load_dwordx4 v[64:67], v5, s[64:67], s61 offen
    s_add_u32 s62, s54, 5120
    buffer_load_dwordx4 v[68:71], v5, s[64:67], s62 offen
    s_add_u32 s63, s54, 6144
    buffer_load_dwordx4 v[72:75], v20, s[64:67], s63 offen
    s_add_u32 s60, s56, 0
    buffer_load_dwordx2 v[168:169], v8, s[72:75], s60 offen
    s_add_u32 s61, s56, 2048
    buffer_load_dwordx2 v[170:171], v8, s[72:75], s61 offen
    s_add_u32 s62, s56, 4096
    buffer_load_dwordx2 v[172:173], v8, s[72:75], s62 offen
    s_add_u32 s63, s56, 6144
    buffer_load_dwordx2 v[174:175], v8, s[72:75], s63 offen
    s_add_u32 s60, s55, 0
    buffer_load_dwordx4 v[104:107], v5, s[68:71], s60 offen
    s_add_u32 s61, s55, 16384
    buffer_load_dwordx4 v[108:111], v5, s[68:71], s61 offen
    s_add_u32 s62, s55, 32768
    buffer_load_dwordx4 v[112:115], v5, s[68:71], s62 offen
    s_add_u32 s63, s55, 49152
    buffer_load_dwordx4 v[116:119], v5, s[68:71], s63 offen
    s_add_u32 s60, s54, 7168
    buffer_load_dwordx4 v[76:79], v5, s[64:67], s60 offen
    s_add_u32 s61, s54, 8192
    buffer_load_dwordx4 v[80:83], v20, s[64:67], s61 offen
    s_add_u32 s62, s54, 9216
    buffer_load_dwordx4 v[84:87], v5, s[64:67], s62 offen
    s_add_u32 s63, s54, 10240
    buffer_load_dwordx4 v[88:91], v21, s[64:67], s63 offen
    s_add_u32 s60, s54, 11264
    buffer_load_dwordx4 v[92:95], v5, s[64:67], s60 offen
    s_add_u32 s61, s54, 12288
    buffer_load_dwordx4 v[96:99], v5, s[64:67], s61 offen
    s_add_u32 s62, s54, 13312
    buffer_load_dwordx4 v[100:103], v21, s[64:67], s62 offen
    s_add_u32 s63, s55, 1024
    buffer_load_dwordx4 v[120:123], v5, s[68:71], s63 offen
    s_add_u32 s60, s55, 17408
    buffer_load_dwordx4 v[124:127], v5, s[68:71], s60 offen
    s_add_u32 s61, s55, 33792
    buffer_load_dwordx4 v[128:131], v5, s[68:71], s61 offen
    s_add_u32 s62, s55, 50176
    buffer_load_dwordx4 v[132:135], v5, s[68:71], s62 offen
    s_waitcnt vmcnt(19)
    v_cvt_pk_bf16_f32 v48, v48, v49
    v_cvt_pk_bf16_f32 v49, v50, v51
    v_cvt_pk_bf16_f32 v50, v52, v53
    v_cvt_pk_bf16_f32 v51, v54, v55
    v_cvt_pk_bf16_f32 v54, v56, v57
    v_cvt_pk_bf16_f32 v55, v58, v59
    v_mov_b32 v52, 0
    v_mov_b32 v53, 0
    s_add_u32 s63, s54, 14336
    buffer_load_dwordx4 a[0:3], v5, s[64:67], s63 offen
    v_cvt_pk_bf16_f32 v56, v60, v61
    v_cvt_pk_bf16_f32 v57, v62, v63
    v_cvt_pk_bf16_f32 v60, v64, v65
    v_cvt_pk_bf16_f32 v61, v66, v67
    v_cvt_pk_bf16_f32 v62, v68, v69
    v_cvt_pk_bf16_f32 v63, v70, v71
    v_cvt_pk_bf16_f32 v64, v72, v73
    v_cvt_pk_bf16_f32 v65, v74, v75
    s_add_u32 s60, s54, 15360
    buffer_load_dwordx4 a[4:7], v20, s[64:67], s60 offen
    s_waitcnt vmcnt(13)
    v_mfma_f32_16x16x32_bf16 v[184:187], v[60:63], v[104:107], 0
    v_mfma_f32_16x16x32_bf16 v[180:183], v[52:55], v[104:107], 0
    v_mfma_f32_16x16x32_bf16 v[176:179], v[48:51], v[104:107], 0
    v_mfma_f32_16x16x16_bf16 v[184:187], v[64:65], v[168:169], v[184:187]
    v_mfma_f32_16x16x16_bf16 v[180:183], v[56:57], v[168:169], v[180:183]
    s_add_u32 s61, s54, 16384
    buffer_load_dwordx4 a[8:11], v5, s[64:67], s61 offen
    s_add_u32 s62, s54, 17408
    buffer_load_dwordx4 a[12:15], v22, s[64:67], s62 offen
    v_mfma_f32_16x16x32_bf16 v[196:199], v[60:63], v[108:111], 0
    s_nop 1
    v_add_f32 v26, 0x358637bd, v186
    v_add_f32 v27, 0x358637bd, v187
    v_rcp_f32 v26, v26
    v_rcp_f32 v27, v27
    v_mfma_f32_16x16x32_bf16 v[192:195], v[52:55], v[108:111], 0
    v_mul_f32 v176, v176, v26
    v_mul_f32 v177, v177, v26
    v_mul_f32 v178, v178, v26
    v_mul_f32 v179, v179, v26
    v_mfma_f32_16x16x32_bf16 v[188:191], v[48:51], v[108:111], 0
    v_cndmask_b32 v28, v26, v27, s[42:43]
    v_mul_f32 v180, v180, v27
    v_mul_f32 v181, v181, v27
    v_mul_f32 v182, v182, v27
    v_mfma_f32_16x16x16_bf16 v[196:199], v[64:65], v[170:171], v[196:199]
    v_mul_f32 v183, v183, v27
    v_mul_f32 v9, v184, v28
    v_mul_f32 v10, v185, v28
    v_cvt_pk_bf16_f32 v104, v176, v177
    v_mfma_f32_16x16x16_bf16 v[192:195], v[56:57], v[170:171], v[192:195]
    v_cvt_pk_bf16_f32 v105, v178, v179
    v_cvt_pk_bf16_f32 v106, v180, v181
    v_cvt_pk_bf16_f32 v107, v182, v183
    s_add_u32 s63, s54, 18432
    buffer_load_dwordx4 a[16:19], v5, s[64:67], s63 offen
    s_add_u32 s60, s54, 19456
    buffer_load_dwordx4 a[20:23], v5, s[64:67], s60 offen
    s_add_u32 s61, s54, 20480
    buffer_load_dwordx4 a[24:27], v22, s[64:67], s61 offen
    s_add_u32 s62, s55, 2048
    buffer_load_dwordx4 v[136:139], v5, s[68:71], s62 offen
    s_add_u32 s63, s55, 18432
    buffer_load_dwordx4 v[140:143], v5, s[68:71], s63 offen
    v_mfma_f32_16x16x32_bf16 v[184:187], v[60:63], v[112:115], 0
    v_add_f32 v26, 0x358637bd, v198
    v_add_f32 v27, 0x358637bd, v199
    v_rcp_f32 v26, v26
    v_rcp_f32 v27, v27
    v_mfma_f32_16x16x32_bf16 v[180:183], v[52:55], v[112:115], 0
    v_mul_f32 v188, v188, v26
    v_mul_f32 v189, v189, v26
    v_mul_f32 v190, v190, v26
    v_mul_f32 v191, v191, v26
    v_mfma_f32_16x16x32_bf16 v[176:179], v[48:51], v[112:115], 0
    v_cndmask_b32 v28, v26, v27, s[42:43]
    v_mul_f32 v192, v192, v27
    v_mul_f32 v193, v193, v27
    v_mul_f32 v194, v194, v27
    v_mfma_f32_16x16x16_bf16 v[184:187], v[64:65], v[172:173], v[184:187]
    v_mul_f32 v195, v195, v27
    v_mul_f32 v13, v196, v28
    v_mul_f32 v14, v197, v28
    v_cvt_pk_bf16_f32 v108, v188, v189
    v_mfma_f32_16x16x16_bf16 v[180:183], v[56:57], v[172:173], v[180:183]
    v_cvt_pk_bf16_f32 v109, v190, v191
    v_cvt_pk_bf16_f32 v110, v192, v193
    v_cvt_pk_bf16_f32 v111, v194, v195
    s_add_u32 s60, s55, 34816
    buffer_load_dwordx4 v[144:147], v5, s[68:71], s60 offen
    s_add_u32 s61, s55, 51200
    buffer_load_dwordx4 v[148:151], v5, s[68:71], s61 offen
    s_add_u32 s62, s54, 21504
    buffer_load_dwordx4 a[28:31], v5, s[64:67], s62 offen
    s_add_u32 s63, s54, 22528
    buffer_load_dwordx4 a[32:35], v20, s[64:67], s63 offen
    s_add_u32 s60, s54, 23552
    buffer_load_dwordx4 a[36:39], v5, s[64:67], s60 offen
    v_mfma_f32_16x16x32_bf16 v[196:199], v[60:63], v[116:119], 0
    v_add_f32 v26, 0x358637bd, v186
    v_add_f32 v27, 0x358637bd, v187
    v_rcp_f32 v26, v26
    v_rcp_f32 v27, v27
    v_mfma_f32_16x16x32_bf16 v[192:195], v[52:55], v[116:119], 0
    v_mul_f32 v176, v176, v26
    v_mul_f32 v177, v177, v26
    v_mul_f32 v178, v178, v26
    v_mul_f32 v179, v179, v26
    v_mfma_f32_16x16x32_bf16 v[188:191], v[48:51], v[116:119], 0
    v_cndmask_b32 v28, v26, v27, s[42:43]
    v_mul_f32 v180, v180, v27
    v_mul_f32 v181, v181, v27
    v_mul_f32 v182, v182, v27
    v_mfma_f32_16x16x16_bf16 v[196:199], v[64:65], v[174:175], v[196:199]
    v_mul_f32 v183, v183, v27
    v_mul_f32 v39, v184, v28
    v_mul_f32 v40, v185, v28
    v_cvt_pk_bf16_f32 v112, v176, v177
    v_mfma_f32_16x16x16_bf16 v[192:195], v[56:57], v[174:175], v[192:195]
    v_cvt_pk_bf16_f32 v113, v178, v179
    v_cvt_pk_bf16_f32 v114, v180, v181
    v_cvt_pk_bf16_f32 v115, v182, v183
    s_add_u32 s61, s54, 24576
    buffer_load_dwordx4 a[40:43], v23, s[64:67], s61 offen
    s_add_u32 s62, s54, 25600
    buffer_load_dwordx4 a[44:47], v5, s[64:67], s62 offen
    s_add_u32 s63, s54, 26624
    buffer_load_dwordx4 a[48:51], v5, s[64:67], s63 offen
    s_waitcnt vmcnt(21)
    v_cvt_pk_bf16_f32 v76, v76, v77
    v_cvt_pk_bf16_f32 v77, v78, v79
    v_cvt_pk_bf16_f32 v78, v80, v81
    v_cvt_pk_bf16_f32 v79, v82, v83
    v_cvt_pk_bf16_f32 v82, v84, v85
    v_cvt_pk_bf16_f32 v83, v86, v87
    v_mov_b32 v80, 0
    v_mov_b32 v81, 0
    s_add_u32 s60, s54, 27648
    buffer_load_dwordx4 a[52:55], v23, s[64:67], s60 offen
    v_cvt_pk_bf16_f32 v84, v88, v89
    v_cvt_pk_bf16_f32 v85, v90, v91
    v_cvt_pk_bf16_f32 v88, v92, v93
    v_cvt_pk_bf16_f32 v89, v94, v95
    v_cvt_pk_bf16_f32 v90, v96, v97
    v_cvt_pk_bf16_f32 v91, v98, v99
    v_cvt_pk_bf16_f32 v92, v100, v101
    v_cvt_pk_bf16_f32 v93, v102, v103
    s_add_u32 s61, s55, 3072
    buffer_load_dwordx4 v[152:155], v5, s[68:71], s61 offen
    s_waitcnt vmcnt(19)
    s_add_u32 s62, s55, 19456
    buffer_load_dwordx4 v[156:159], v5, s[68:71], s62 offen
    s_add_u32 s63, s55, 35840
    buffer_load_dwordx4 v[160:163], v5, s[68:71], s63 offen
    v_mfma_f32_16x16x32_bf16 v[184:187], v[88:91], v[120:123], 0
    v_add_f32 v26, 0x358637bd, v198
    v_add_f32 v27, 0x358637bd, v199
    v_rcp_f32 v26, v26
    v_rcp_f32 v27, v27
    v_mfma_f32_16x16x32_bf16 v[180:183], v[80:83], v[120:123], 0
    v_mul_f32 v188, v188, v26
    v_mul_f32 v189, v189, v26
    v_mul_f32 v190, v190, v26
    v_mul_f32 v191, v191, v26
    v_mfma_f32_16x16x32_bf16 v[176:179], v[76:79], v[120:123], 0
    v_cndmask_b32 v28, v26, v27, s[42:43]
    v_mul_f32 v192, v192, v27
    v_mul_f32 v193, v193, v27
    v_mul_f32 v194, v194, v27
    v_mfma_f32_16x16x16_bf16 v[184:187], v[92:93], v[168:169], v[184:187]
    v_mul_f32 v195, v195, v27
    v_mul_f32 v43, v196, v28
    v_mul_f32 v44, v197, v28
    v_cvt_pk_bf16_f32 v116, v188, v189
    v_mfma_f32_16x16x16_bf16 v[180:183], v[84:85], v[168:169], v[180:183]
    v_cvt_pk_bf16_f32 v117, v190, v191
    v_cvt_pk_bf16_f32 v118, v192, v193
    v_cvt_pk_bf16_f32 v119, v194, v195
    s_add_u32 s60, s55, 52224
    buffer_load_dwordx4 v[164:167], v5, s[68:71], s60 offen
    s_add_u32 s61, s57, 0
    s_add_u32 m0, s27, 0
    s_nop 0
    buffer_load_dwordx4 v5, s[76:79], s61 offen lds
    s_add_u32 s62, s57, 1024
    s_add_u32 m0, s27, 1024
    s_nop 0
    buffer_load_dwordx4 v5, s[76:79], s62 offen lds
    s_add_u32 s63, s57, 2048
    s_add_u32 m0, s27, 2048
    s_nop 0
    buffer_load_dwordx4 v5, s[76:79], s63 offen lds
    s_add_u32 s60, s57, 3072
    s_add_u32 m0, s27, 3072
    s_nop 0
    buffer_load_dwordx4 v5, s[76:79], s60 offen lds
    v_mfma_f32_16x16x32_bf16 v[196:199], v[88:91], v[124:127], 0
    v_add_f32 v26, 0x358637bd, v186
    v_add_f32 v27, 0x358637bd, v187
    v_rcp_f32 v26, v26
    v_rcp_f32 v27, v27
    v_mfma_f32_16x16x32_bf16 v[192:195], v[80:83], v[124:127], 0
    v_mul_f32 v176, v176, v26
    v_mul_f32 v177, v177, v26
    v_mul_f32 v178, v178, v26
    v_mul_f32 v179, v179, v26
    v_mfma_f32_16x16x32_bf16 v[188:191], v[76:79], v[124:127], 0
    v_cndmask_b32 v28, v26, v27, s[42:43]
    v_mul_f32 v180, v180, v27
    v_mul_f32 v181, v181, v27
    v_mul_f32 v182, v182, v27
    v_mfma_f32_16x16x16_bf16 v[196:199], v[92:93], v[170:171], v[196:199]
    v_mul_f32 v183, v183, v27
    v_fmac_f32 v9, v184, v28
    v_fmac_f32 v10, v185, v28
    v_cvt_pk_bf16_f32 v120, v176, v177
    v_mfma_f32_16x16x16_bf16 v[192:195], v[84:85], v[170:171], v[192:195]
    v_cvt_pk_bf16_f32 v121, v178, v179
    v_cvt_pk_bf16_f32 v122, v180, v181
    v_cvt_pk_bf16_f32 v123, v182, v183
    s_add_u32 s61, s57, 4096
    s_add_u32 m0, s27, 4096
    s_nop 0
    buffer_load_dwordx4 v5, s[76:79], s61 offen lds
    s_add_u32 s62, s57, 5120
    s_add_u32 m0, s27, 5120
    s_nop 0
    buffer_load_dwordx4 v5, s[76:79], s62 offen lds
    s_add_u32 s63, s57, 6144
    s_add_u32 m0, s27, 6144
    s_nop 0
    buffer_load_dwordx4 v5, s[76:79], s63 offen lds
    s_add_u32 s60, s57, 7168
    s_add_u32 m0, s27, 7168
    s_nop 0
    buffer_load_dwordx4 v5, s[76:79], s60 offen lds
    s_add_u32 s61, s57, 8192
    s_add_u32 m0, s27, 8192
    s_nop 0
    buffer_load_dwordx4 v5, s[76:79], s61 offen lds
    v_mfma_f32_16x16x32_bf16 v[184:187], v[88:91], v[128:131], 0
    v_add_f32 v26, 0x358637bd, v198
    v_add_f32 v27, 0x358637bd, v199
    v_rcp_f32 v26, v26
    v_rcp_f32 v27, v27
    v_mfma_f32_16x16x32_bf16 v[180:183], v[80:83], v[128:131], 0
    v_mul_f32 v188, v188, v26
    v_mul_f32 v189, v189, v26
    v_mul_f32 v190, v190, v26
    v_mul_f32 v191, v191, v26
    v_mfma_f32_16x16x32_bf16 v[176:179], v[76:79], v[128:131], 0
    v_cndmask_b32 v28, v26, v27, s[42:43]
    v_mul_f32 v192, v192, v27
    v_mul_f32 v193, v193, v27
    v_mul_f32 v194, v194, v27
    v_mfma_f32_16x16x16_bf16 v[184:187], v[92:93], v[172:173], v[184:187]
    v_mul_f32 v195, v195, v27
    v_fmac_f32 v13, v196, v28
    v_fmac_f32 v14, v197, v28
    v_cvt_pk_bf16_f32 v124, v188, v189
    v_mfma_f32_16x16x16_bf16 v[180:183], v[84:85], v[172:173], v[180:183]
    v_cvt_pk_bf16_f32 v125, v190, v191
    v_cvt_pk_bf16_f32 v126, v192, v193
    v_cvt_pk_bf16_f32 v127, v194, v195
    s_add_u32 s62, s57, 9216
    s_add_u32 m0, s27, 9216
    s_nop 0
    buffer_load_dwordx4 v5, s[76:79], s62 offen lds
    s_add_u32 s63, s57, 10240
    s_add_u32 m0, s27, 10240
    s_nop 0
    buffer_load_dwordx4 v5, s[76:79], s63 offen lds
    s_add_u32 s60, s57, 11264
    s_add_u32 m0, s27, 11264
    s_nop 0
    buffer_load_dwordx4 v5, s[76:79], s60 offen lds
    s_add_u32 s61, s57, 12288
    s_add_u32 m0, s27, 12288
    s_nop 0
    buffer_load_dwordx4 v5, s[76:79], s61 offen lds
    s_add_u32 s62, s57, 13312
    s_add_u32 m0, s27, 13312
    s_nop 0
    buffer_load_dwordx4 v5, s[76:79], s62 offen lds
    v_mfma_f32_16x16x32_bf16 v[196:199], v[88:91], v[132:135], 0
    v_add_f32 v26, 0x358637bd, v186
    v_add_f32 v27, 0x358637bd, v187
    v_rcp_f32 v26, v26
    v_rcp_f32 v27, v27
    v_mfma_f32_16x16x32_bf16 v[192:195], v[80:83], v[132:135], 0
    v_mul_f32 v176, v176, v26
    v_mul_f32 v177, v177, v26
    v_mul_f32 v178, v178, v26
    v_mul_f32 v179, v179, v26
    v_mfma_f32_16x16x32_bf16 v[188:191], v[76:79], v[132:135], 0
    v_cndmask_b32 v28, v26, v27, s[42:43]
    v_mul_f32 v180, v180, v27
    v_mul_f32 v181, v181, v27
    v_mul_f32 v182, v182, v27
    v_mfma_f32_16x16x16_bf16 v[196:199], v[92:93], v[174:175], v[196:199]
    v_mul_f32 v183, v183, v27
    v_fmac_f32 v39, v184, v28
    v_fmac_f32 v40, v185, v28
    v_cvt_pk_bf16_f32 v128, v176, v177
    v_mfma_f32_16x16x16_bf16 v[192:195], v[84:85], v[174:175], v[192:195]
    v_cvt_pk_bf16_f32 v129, v178, v179
    v_cvt_pk_bf16_f32 v130, v180, v181
    v_cvt_pk_bf16_f32 v131, v182, v183
    s_add_u32 s63, s57, 14336
    s_add_u32 m0, s27, 14336
    s_nop 0
    buffer_load_dwordx4 v5, s[76:79], s63 offen lds
    s_add_u32 s60, s57, 15360
    s_add_u32 m0, s27, 15360
    s_nop 0
    buffer_load_dwordx4 v5, s[76:79], s60 offen lds
    s_waitcnt vmcnt(31)
    v_accvgpr_read_b32 v48, a0
    v_accvgpr_read_b32 v49, a1
    v_accvgpr_read_b32 v50, a2
    v_accvgpr_read_b32 v51, a3
    v_accvgpr_read_b32 v52, a4
    v_accvgpr_read_b32 v53, a5
    v_accvgpr_read_b32 v54, a6
    v_accvgpr_read_b32 v55, a7
    v_accvgpr_read_b32 v56, a8
    v_accvgpr_read_b32 v57, a9
    v_accvgpr_read_b32 v58, a10
    v_accvgpr_read_b32 v59, a11
    v_accvgpr_read_b32 v60, a12
    v_accvgpr_read_b32 v61, a13
    v_accvgpr_read_b32 v62, a14
    v_accvgpr_read_b32 v63, a15
    v_accvgpr_read_b32 v64, a16
    v_accvgpr_read_b32 v65, a17
    v_accvgpr_read_b32 v66, a18
    v_accvgpr_read_b32 v67, a19
    v_accvgpr_read_b32 v68, a20
    v_accvgpr_read_b32 v69, a21
    v_accvgpr_read_b32 v70, a22
    v_accvgpr_read_b32 v71, a23
    v_accvgpr_read_b32 v72, a24
    v_accvgpr_read_b32 v73, a25
    v_accvgpr_read_b32 v74, a26
    v_accvgpr_read_b32 v75, a27
    v_cvt_pk_bf16_f32 v48, v48, v49
    v_cvt_pk_bf16_f32 v49, v50, v51
    v_cvt_pk_bf16_f32 v50, v52, v53
    v_cvt_pk_bf16_f32 v51, v54, v55
    v_cvt_pk_bf16_f32 v54, v56, v57
    v_cvt_pk_bf16_f32 v55, v58, v59
    v_mov_b32 v52, 0
    v_mov_b32 v53, 0
    s_add_u32 s61, s57, 16384
    s_add_u32 m0, s27, 16384
    s_nop 0
    buffer_load_dwordx4 v5, s[76:79], s61 offen lds
    v_cvt_pk_bf16_f32 v56, v60, v61
    v_cvt_pk_bf16_f32 v57, v62, v63
    v_cvt_pk_bf16_f32 v60, v64, v65
    v_cvt_pk_bf16_f32 v61, v66, v67
    v_cvt_pk_bf16_f32 v62, v68, v69
    v_cvt_pk_bf16_f32 v63, v70, v71
    v_cvt_pk_bf16_f32 v64, v72, v73
    v_cvt_pk_bf16_f32 v65, v74, v75
    s_add_u32 s62, s57, 17408
    s_add_u32 m0, s27, 17408
    s_nop 0
    buffer_load_dwordx4 v5, s[76:79], s62 offen lds
    s_waitcnt vmcnt(29)
    s_add_u32 s63, s57, 18432
    s_add_u32 m0, s27, 18432
    s_nop 0
    buffer_load_dwordx4 v5, s[76:79], s63 offen lds
    s_add_u32 s60, s57, 19456
    s_add_u32 m0, s27, 19456
    s_nop 0
    buffer_load_dwordx4 v5, s[76:79], s60 offen lds
    v_mfma_f32_16x16x32_bf16 v[184:187], v[60:63], v[136:139], 0
    v_add_f32 v26, 0x358637bd, v198
    v_add_f32 v27, 0x358637bd, v199
    v_rcp_f32 v26, v26
    v_rcp_f32 v27, v27
    v_mfma_f32_16x16x32_bf16 v[180:183], v[52:55], v[136:139], 0
    v_mul_f32 v188, v188, v26
    v_mul_f32 v189, v189, v26
    v_mul_f32 v190, v190, v26
    v_mul_f32 v191, v191, v26
    v_mfma_f32_16x16x32_bf16 v[176:179], v[48:51], v[136:139], 0
    v_cndmask_b32 v28, v26, v27, s[42:43]
    v_mul_f32 v192, v192, v27
    v_mul_f32 v193, v193, v27
    v_mul_f32 v194, v194, v27
    v_mfma_f32_16x16x16_bf16 v[184:187], v[64:65], v[168:169], v[184:187]
    v_mul_f32 v195, v195, v27
    v_fmac_f32 v43, v196, v28
    v_fmac_f32 v44, v197, v28
    v_cvt_pk_bf16_f32 v132, v188, v189
    v_mfma_f32_16x16x16_bf16 v[180:183], v[56:57], v[168:169], v[180:183]
    v_cvt_pk_bf16_f32 v133, v190, v191
    v_cvt_pk_bf16_f32 v134, v192, v193
    v_cvt_pk_bf16_f32 v135, v194, v195
    s_add_u32 s61, s57, 20480
    s_add_u32 m0, s27, 20480
    s_mov_b64 exec, 0xffff
    buffer_load_dwordx4 v5, s[76:79], s61 offen lds
    s_mov_b64 exec, -1
    s_add_u32 m0, s53, 0
    s_nop 0
    buffer_load_dwordx4 v17, s[80:83], s48 offen lds
    s_add_u32 m0, s53, 1024
    s_nop 0
    buffer_load_dwordx4 v18, s[80:83], s48 offen lds
    s_add_u32 m0, s53, 2048
    s_mov_b64 exec, 0xffff
    buffer_load_dwordx4 v19, s[80:83], s48 offen lds
    s_mov_b64 exec, -1
    v_mfma_f32_16x16x32_bf16 v[196:199], v[60:63], v[140:143], 0
    v_add_f32 v26, 0x358637bd, v186
    v_add_f32 v27, 0x358637bd, v187
    v_rcp_f32 v26, v26
    v_rcp_f32 v27, v27
    v_mfma_f32_16x16x32_bf16 v[192:195], v[52:55], v[140:143], 0
    v_mul_f32 v176, v176, v26
    v_mul_f32 v177, v177, v26
    v_mul_f32 v178, v178, v26
    v_mul_f32 v179, v179, v26
    v_mfma_f32_16x16x32_bf16 v[188:191], v[48:51], v[140:143], 0
    v_cndmask_b32 v28, v26, v27, s[42:43]
    v_mul_f32 v180, v180, v27
    v_mul_f32 v181, v181, v27
    v_mul_f32 v182, v182, v27
    v_mfma_f32_16x16x16_bf16 v[196:199], v[64:65], v[170:171], v[196:199]
    v_mul_f32 v183, v183, v27
    v_mul_f32 v11, v184, v28
    v_mul_f32 v12, v185, v28
    v_cvt_pk_bf16_f32 v136, v176, v177
    v_mfma_f32_16x16x16_bf16 v[192:195], v[56:57], v[170:171], v[192:195]
    v_cvt_pk_bf16_f32 v137, v178, v179
    v_cvt_pk_bf16_f32 v138, v180, v181
    v_cvt_pk_bf16_f32 v139, v182, v183
    v_mfma_f32_16x16x32_bf16 v[184:187], v[60:63], v[144:147], 0
    v_add_f32 v26, 0x358637bd, v198
    v_add_f32 v27, 0x358637bd, v199
    v_rcp_f32 v26, v26
    v_rcp_f32 v27, v27
    v_mfma_f32_16x16x32_bf16 v[180:183], v[52:55], v[144:147], 0
    v_mul_f32 v188, v188, v26
    v_mul_f32 v189, v189, v26
    v_mul_f32 v190, v190, v26
    v_mul_f32 v191, v191, v26
    v_mfma_f32_16x16x32_bf16 v[176:179], v[48:51], v[144:147], 0
    v_cndmask_b32 v28, v26, v27, s[42:43]
    v_mul_f32 v192, v192, v27
    v_mul_f32 v193, v193, v27
    v_mul_f32 v194, v194, v27
    v_mfma_f32_16x16x16_bf16 v[184:187], v[64:65], v[172:173], v[184:187]
    v_mul_f32 v195, v195, v27
    v_mul_f32 v15, v196, v28
    v_mul_f32 v38, v197, v28
    v_cvt_pk_bf16_f32 v140, v188, v189
    v_mfma_f32_16x16x16_bf16 v[180:183], v[56:57], v[172:173], v[180:183]
    v_cvt_pk_bf16_f32 v141, v190, v191
    v_cvt_pk_bf16_f32 v142, v192, v193
    v_cvt_pk_bf16_f32 v143, v194, v195
    v_mfma_f32_16x16x32_bf16 v[196:199], v[60:63], v[148:151], 0
    v_add_f32 v26, 0x358637bd, v186
    v_add_f32 v27, 0x358637bd, v187
    v_rcp_f32 v26, v26
    v_rcp_f32 v27, v27
    v_mfma_f32_16x16x32_bf16 v[192:195], v[52:55], v[148:151], 0
    v_mul_f32 v176, v176, v26
    v_mul_f32 v177, v177, v26
    v_mul_f32 v178, v178, v26
    v_mul_f32 v179, v179, v26
    v_mfma_f32_16x16x32_bf16 v[188:191], v[48:51], v[148:151], 0
    v_cndmask_b32 v28, v26, v27, s[42:43]
    v_mul_f32 v180, v180, v27
    v_mul_f32 v181, v181, v27
    v_mul_f32 v182, v182, v27
    v_mfma_f32_16x16x16_bf16 v[196:199], v[64:65], v[174:175], v[196:199]
    v_mul_f32 v183, v183, v27
    v_mul_f32 v41, v184, v28
    v_mul_f32 v42, v185, v28
    v_cvt_pk_bf16_f32 v144, v176, v177
    v_mfma_f32_16x16x16_bf16 v[192:195], v[56:57], v[174:175], v[192:195]
    v_cvt_pk_bf16_f32 v145, v178, v179
    v_cvt_pk_bf16_f32 v146, v180, v181
    v_cvt_pk_bf16_f32 v147, v182, v183
    s_waitcnt vmcnt(28)
    v_accvgpr_read_b32 v76, a28
    v_accvgpr_read_b32 v77, a29
    v_accvgpr_read_b32 v78, a30
    v_accvgpr_read_b32 v79, a31
    v_accvgpr_read_b32 v80, a32
    v_accvgpr_read_b32 v81, a33
    v_accvgpr_read_b32 v82, a34
    v_accvgpr_read_b32 v83, a35
    v_accvgpr_read_b32 v84, a36
    v_accvgpr_read_b32 v85, a37
    v_accvgpr_read_b32 v86, a38
    v_accvgpr_read_b32 v87, a39
    v_accvgpr_read_b32 v88, a40
    v_accvgpr_read_b32 v89, a41
    v_accvgpr_read_b32 v90, a42
    v_accvgpr_read_b32 v91, a43
    v_accvgpr_read_b32 v92, a44
    v_accvgpr_read_b32 v93, a45
    v_accvgpr_read_b32 v94, a46
    v_accvgpr_read_b32 v95, a47
    v_accvgpr_read_b32 v96, a48
    v_accvgpr_read_b32 v97, a49
    v_accvgpr_read_b32 v98, a50
    v_accvgpr_read_b32 v99, a51
    v_accvgpr_read_b32 v100, a52
    v_accvgpr_read_b32 v101, a53
    v_accvgpr_read_b32 v102, a54
    v_accvgpr_read_b32 v103, a55
    v_cvt_pk_bf16_f32 v76, v76, v77
    v_cvt_pk_bf16_f32 v77, v78, v79
    v_cvt_pk_bf16_f32 v78, v80, v81
    v_cvt_pk_bf16_f32 v79, v82, v83
    v_cvt_pk_bf16_f32 v82, v84, v85
    v_cvt_pk_bf16_f32 v83, v86, v87
    v_mov_b32 v80, 0
    v_mov_b32 v81, 0
    v_cvt_pk_bf16_f32 v84, v88, v89
    v_cvt_pk_bf16_f32 v85, v90, v91
    v_cvt_pk_bf16_f32 v88, v92, v93
    v_cvt_pk_bf16_f32 v89, v94, v95
    v_cvt_pk_bf16_f32 v90, v96, v97
    v_cvt_pk_bf16_f32 v91, v98, v99
    v_cvt_pk_bf16_f32 v92, v100, v101
    v_cvt_pk_bf16_f32 v93, v102, v103
    s_waitcnt vmcnt(24)
    v_mfma_f32_16x16x32_bf16 v[184:187], v[88:91], v[152:155], 0
    v_add_f32 v26, 0x358637bd, v198
    v_add_f32 v27, 0x358637bd, v199
    v_rcp_f32 v26, v26
    v_rcp_f32 v27, v27
    v_mfma_f32_16x16x32_bf16 v[180:183], v[80:83], v[152:155], 0
    v_mul_f32 v188, v188, v26
    v_mul_f32 v189, v189, v26
    v_mul_f32 v190, v190, v26
    v_mul_f32 v191, v191, v26
    v_mfma_f32_16x16x32_bf16 v[176:179], v[76:79], v[152:155], 0
    v_cndmask_b32 v28, v26, v27, s[42:43]
    v_mul_f32 v192, v192, v27
    v_mul_f32 v193, v193, v27
    v_mul_f32 v194, v194, v27
    v_mfma_f32_16x16x16_bf16 v[184:187], v[92:93], v[168:169], v[184:187]
    v_mul_f32 v195, v195, v27
    v_mul_f32 v45, v196, v28
    v_mul_f32 v46, v197, v28
    v_cvt_pk_bf16_f32 v148, v188, v189
    v_mfma_f32_16x16x16_bf16 v[180:183], v[84:85], v[168:169], v[180:183]
    v_cvt_pk_bf16_f32 v149, v190, v191
    v_cvt_pk_bf16_f32 v150, v192, v193
    v_cvt_pk_bf16_f32 v151, v194, v195
    v_mfma_f32_16x16x32_bf16 v[196:199], v[88:91], v[156:159], 0
    v_add_f32 v26, 0x358637bd, v186
    v_add_f32 v27, 0x358637bd, v187
    v_rcp_f32 v26, v26
    v_rcp_f32 v27, v27
    v_mfma_f32_16x16x32_bf16 v[192:195], v[80:83], v[156:159], 0
    v_mul_f32 v176, v176, v26
    v_mul_f32 v177, v177, v26
    v_mul_f32 v178, v178, v26
    v_mul_f32 v179, v179, v26
    v_mfma_f32_16x16x32_bf16 v[188:191], v[76:79], v[156:159], 0
    v_cndmask_b32 v28, v26, v27, s[42:43]
    v_mul_f32 v180, v180, v27
    v_mul_f32 v181, v181, v27
    v_mul_f32 v182, v182, v27
    v_mfma_f32_16x16x16_bf16 v[196:199], v[92:93], v[170:171], v[196:199]
    v_mul_f32 v183, v183, v27
    v_fmac_f32 v11, v184, v28
    v_fmac_f32 v12, v185, v28
    v_cvt_pk_bf16_f32 v152, v176, v177
    v_mfma_f32_16x16x16_bf16 v[192:195], v[84:85], v[170:171], v[192:195]
    v_cvt_pk_bf16_f32 v153, v178, v179
    v_cvt_pk_bf16_f32 v154, v180, v181
    v_cvt_pk_bf16_f32 v155, v182, v183
    v_mfma_f32_16x16x32_bf16 v[184:187], v[88:91], v[160:163], 0
    v_add_f32 v26, 0x358637bd, v198
    v_add_f32 v27, 0x358637bd, v199
    v_rcp_f32 v26, v26
    v_rcp_f32 v27, v27
    v_mfma_f32_16x16x32_bf16 v[180:183], v[80:83], v[160:163], 0
    v_mul_f32 v188, v188, v26
    v_mul_f32 v189, v189, v26
    v_mul_f32 v190, v190, v26
    v_mul_f32 v191, v191, v26
    v_mfma_f32_16x16x32_bf16 v[176:179], v[76:79], v[160:163], 0
    v_cndmask_b32 v28, v26, v27, s[42:43]
    v_mul_f32 v192, v192, v27
    v_mul_f32 v193, v193, v27
    v_mul_f32 v194, v194, v27
    v_mfma_f32_16x16x16_bf16 v[184:187], v[92:93], v[172:173], v[184:187]
    v_mul_f32 v195, v195, v27
    v_fmac_f32 v15, v196, v28
    v_fmac_f32 v38, v197, v28
    v_cvt_pk_bf16_f32 v156, v188, v189
    v_mfma_f32_16x16x16_bf16 v[180:183], v[84:85], v[172:173], v[180:183]
    v_cvt_pk_bf16_f32 v157, v190, v191
    v_cvt_pk_bf16_f32 v158, v192, v193
    v_cvt_pk_bf16_f32 v159, v194, v195
    v_mfma_f32_16x16x32_bf16 v[196:199], v[88:91], v[164:167], 0
    v_add_f32 v26, 0x358637bd, v186
    v_add_f32 v27, 0x358637bd, v187
    v_rcp_f32 v26, v26
    v_rcp_f32 v27, v27
    v_mfma_f32_16x16x32_bf16 v[192:195], v[80:83], v[164:167], 0
    v_mul_f32 v176, v176, v26
    v_mul_f32 v177, v177, v26
    v_mul_f32 v178, v178, v26
    v_mul_f32 v179, v179, v26
    v_mfma_f32_16x16x32_bf16 v[188:191], v[76:79], v[164:167], 0
    v_cndmask_b32 v28, v26, v27, s[42:43]
    v_mul_f32 v180, v180, v27
    v_mul_f32 v181, v181, v27
    v_mul_f32 v182, v182, v27
    v_mfma_f32_16x16x16_bf16 v[196:199], v[92:93], v[174:175], v[196:199]
    v_mul_f32 v183, v183, v27
    v_fmac_f32 v41, v184, v28
    v_fmac_f32 v42, v185, v28
    v_cvt_pk_bf16_f32 v160, v176, v177
    v_mfma_f32_16x16x16_bf16 v[192:195], v[84:85], v[174:175], v[192:195]
    v_cvt_pk_bf16_f32 v161, v178, v179
    v_cvt_pk_bf16_f32 v162, v180, v181
    v_cvt_pk_bf16_f32 v163, v182, v183
    v_add_f32 v26, 0x358637bd, v198
    v_add_f32 v27, 0x358637bd, v199
    v_rcp_f32 v26, v26
    v_rcp_f32 v27, v27
    v_mul_f32 v188, v188, v26
    v_mul_f32 v189, v189, v26
    v_mul_f32 v190, v190, v26
    v_mul_f32 v191, v191, v26
    v_cndmask_b32 v28, v26, v27, s[42:43]
    v_mul_f32 v192, v192, v27
    v_mul_f32 v193, v193, v27
    v_mul_f32 v194, v194, v27
    v_mul_f32 v195, v195, v27
    v_fmac_f32 v45, v196, v28
    v_fmac_f32 v46, v197, v28
    v_cvt_pk_bf16_f32 v164, v188, v189
    v_cvt_pk_bf16_f32 v165, v190, v191
    v_cvt_pk_bf16_f32 v166, v192, v193
    v_cvt_pk_bf16_f32 v167, v194, v195
    v_cvt_pk_bf16_f32 v168, v9, v10
    v_cvt_pk_bf16_f32 v169, v11, v12
    v_cvt_pk_bf16_f32 v170, v13, v14
    v_cvt_pk_bf16_f32 v171, v15, v38
    v_cvt_pk_bf16_f32 v172, v39, v40
    v_cvt_pk_bf16_f32 v173, v41, v42
    v_cvt_pk_bf16_f32 v174, v43, v44
    v_cvt_pk_bf16_f32 v175, v45, v46
    s_waitcnt vmcnt(3)
    ds_read_b64_tr_b16 a[0:1], v35 offset:0
    ds_read_b64_tr_b16 a[2:3], v35 offset:2592
    ds_read_b64_tr_b16 a[4:5], v35 offset:5184
    ds_read_b64_tr_b16 a[6:7], v35 offset:7776
    ds_read_b64_tr_b16 a[8:9], v35 offset:10368
    ds_read_b64_tr_b16 a[10:11], v35 offset:12960
    ds_read_b64_tr_b16 a[12:13], v35 offset:15552
    ds_read_b64_tr_b16 a[14:15], v35 offset:18144
    ds_read_b64_tr_b16 a[16:17], v36 offset:0
    ds_read_b64_tr_b16 a[20:21], v35 offset:32
    ds_read_b64_tr_b16 a[22:23], v35 offset:2624
    ds_read_b64_tr_b16 a[24:25], v35 offset:5216
    ds_read_b64_tr_b16 a[26:27], v35 offset:7808
    s_waitcnt lgkmcnt(11)
    v_mfma_f32_16x16x32_bf16 v[48:51], a[0:3], v[104:107], 0
    v_mfma_f32_16x16x32_bf16 v[52:55], a[0:3], v[108:111], 0
    v_mfma_f32_16x16x32_bf16 v[56:59], a[0:3], v[112:115], 0
    v_mfma_f32_16x16x32_bf16 v[60:63], a[0:3], v[116:119], 0
    ds_read_b64_tr_b16 a[28:29], v35 offset:10400
    ds_read_b64_tr_b16 a[30:31], v35 offset:12992
    s_waitcnt lgkmcnt(11)
    v_mfma_f32_16x16x32_bf16 v[48:51], a[4:7], v[120:123], v[48:51]
    v_mfma_f32_16x16x32_bf16 v[52:55], a[4:7], v[124:127], v[52:55]
    v_mfma_f32_16x16x32_bf16 v[56:59], a[4:7], v[128:131], v[56:59]
    v_mfma_f32_16x16x32_bf16 v[60:63], a[4:7], v[132:135], v[60:63]
    ds_read_b64_tr_b16 a[32:33], v35 offset:15584
    ds_read_b64_tr_b16 a[34:35], v35 offset:18176
    s_waitcnt lgkmcnt(11)
    v_mfma_f32_16x16x32_bf16 v[48:51], a[8:11], v[136:139], v[48:51]
    v_mfma_f32_16x16x32_bf16 v[52:55], a[8:11], v[140:143], v[52:55]
    v_mfma_f32_16x16x32_bf16 v[56:59], a[8:11], v[144:147], v[56:59]
    v_mfma_f32_16x16x32_bf16 v[60:63], a[8:11], v[148:151], v[60:63]
    ds_read_b64_tr_b16 a[36:37], v36 offset:32
    s_waitcnt lgkmcnt(10)
    v_mfma_f32_16x16x32_bf16 v[48:51], a[12:15], v[152:155], v[48:51]
    v_mfma_f32_16x16x32_bf16 v[52:55], a[12:15], v[156:159], v[52:55]
    v_mfma_f32_16x16x32_bf16 v[56:59], a[12:15], v[160:163], v[56:59]
    v_mfma_f32_16x16x32_bf16 v[60:63], a[12:15], v[164:167], v[60:63]
    ds_read_b64_tr_b16 a[40:41], v35 offset:64
    ds_read_b64_tr_b16 a[42:43], v35 offset:2656
    s_waitcnt lgkmcnt(11)
    v_mfma_f32_16x16x16_bf16 v[48:51], a[16:17], v[168:169], v[48:51]
    v_mfma_f32_16x16x16_bf16 v[52:55], a[16:17], v[170:171], v[52:55]
    v_mfma_f32_16x16x16_bf16 v[56:59], a[16:17], v[172:173], v[56:59]
    v_mfma_f32_16x16x16_bf16 v[60:63], a[16:17], v[174:175], v[60:63]
    ds_read_b64_tr_b16 a[44:45], v35 offset:5248
    ds_read_b64_tr_b16 a[46:47], v35 offset:7840
    s_waitcnt lgkmcnt(11)
    v_mfma_f32_16x16x32_bf16 v[64:67], a[20:23], v[104:107], 0
    v_mfma_f32_16x16x32_bf16 v[68:71], a[20:23], v[108:111], 0
    v_mfma_f32_16x16x32_bf16 v[72:75], a[20:23], v[112:115], 0
    v_mfma_f32_16x16x32_bf16 v[76:79], a[20:23], v[116:119], 0
    ds_read_b64_tr_b16 a[0:1], v35 offset:10432
    ds_read_b64_tr_b16 a[2:3], v35 offset:13024
    s_waitcnt lgkmcnt(11)
    v_mfma_f32_16x16x32_bf16 v[64:67], a[24:27], v[120:123], v[64:67]
    v_mfma_f32_16x16x32_bf16 v[68:71], a[24:27], v[124:127], v[68:71]
    v_mfma_f32_16x16x32_bf16 v[72:75], a[24:27], v[128:131], v[72:75]
    v_mfma_f32_16x16x32_bf16 v[76:79], a[24:27], v[132:135], v[76:79]
    ds_read_b64_tr_b16 a[4:5], v35 offset:15616
    ds_read_b64_tr_b16 a[6:7], v35 offset:18208
    s_waitcnt lgkmcnt(11)
    v_mfma_f32_16x16x32_bf16 v[64:67], a[28:31], v[136:139], v[64:67]
    v_mfma_f32_16x16x32_bf16 v[68:71], a[28:31], v[140:143], v[68:71]
    v_mfma_f32_16x16x32_bf16 v[72:75], a[28:31], v[144:147], v[72:75]
    v_mfma_f32_16x16x32_bf16 v[76:79], a[28:31], v[148:151], v[76:79]
    ds_read_b64_tr_b16 a[8:9], v36 offset:64
    s_waitcnt lgkmcnt(10)
    v_mfma_f32_16x16x32_bf16 v[64:67], a[32:35], v[152:155], v[64:67]
    v_mfma_f32_16x16x32_bf16 v[68:71], a[32:35], v[156:159], v[68:71]
    v_mfma_f32_16x16x32_bf16 v[72:75], a[32:35], v[160:163], v[72:75]
    v_mfma_f32_16x16x32_bf16 v[76:79], a[32:35], v[164:167], v[76:79]
    ds_read_b64_tr_b16 a[12:13], v35 offset:96
    ds_read_b64_tr_b16 a[14:15], v35 offset:2688
    s_waitcnt lgkmcnt(11)
    v_mfma_f32_16x16x16_bf16 v[64:67], a[36:37], v[168:169], v[64:67]
    v_mfma_f32_16x16x16_bf16 v[68:71], a[36:37], v[170:171], v[68:71]
    v_mfma_f32_16x16x16_bf16 v[72:75], a[36:37], v[172:173], v[72:75]
    v_mfma_f32_16x16x16_bf16 v[76:79], a[36:37], v[174:175], v[76:79]
    ds_read_b64_tr_b16 a[16:17], v35 offset:5280
    ds_read_b64_tr_b16 a[18:19], v35 offset:7872
    s_waitcnt lgkmcnt(11)
    v_mfma_f32_16x16x32_bf16 v[80:83], a[40:43], v[104:107], 0
    v_mfma_f32_16x16x32_bf16 v[84:87], a[40:43], v[108:111], 0
    v_mfma_f32_16x16x32_bf16 v[88:91], a[40:43], v[112:115], 0
    v_mfma_f32_16x16x32_bf16 v[92:95], a[40:43], v[116:119], 0
    ds_read_b64_tr_b16 a[20:21], v35 offset:10464
    ds_read_b64_tr_b16 a[22:23], v35 offset:13056
    s_waitcnt lgkmcnt(11)
    v_mfma_f32_16x16x32_bf16 v[80:83], a[44:47], v[120:123], v[80:83]
    v_mfma_f32_16x16x32_bf16 v[84:87], a[44:47], v[124:127], v[84:87]
    v_mfma_f32_16x16x32_bf16 v[88:91], a[44:47], v[128:131], v[88:91]
    v_mfma_f32_16x16x32_bf16 v[92:95], a[44:47], v[132:135], v[92:95]
    ds_read_b64_tr_b16 a[24:25], v35 offset:15648
    ds_read_b64_tr_b16 a[26:27], v35 offset:18240
    s_waitcnt lgkmcnt(11)
    v_mfma_f32_16x16x32_bf16 v[80:83], a[0:3], v[136:139], v[80:83]
    v_mfma_f32_16x16x32_bf16 v[84:87], a[0:3], v[140:143], v[84:87]
    v_mfma_f32_16x16x32_bf16 v[88:91], a[0:3], v[144:147], v[88:91]
    v_mfma_f32_16x16x32_bf16 v[92:95], a[0:3], v[148:151], v[92:95]
    ds_read_b64_tr_b16 a[28:29], v36 offset:96
    s_waitcnt lgkmcnt(10)
    v_mfma_f32_16x16x32_bf16 v[80:83], a[4:7], v[152:155], v[80:83]
    v_mfma_f32_16x16x32_bf16 v[84:87], a[4:7], v[156:159], v[84:87]
    v_mfma_f32_16x16x32_bf16 v[88:91], a[4:7], v[160:163], v[88:91]
    v_mfma_f32_16x16x32_bf16 v[92:95], a[4:7], v[164:167], v[92:95]
    ds_read_b64_tr_b16 a[32:33], v35 offset:128
    ds_read_b64_tr_b16 a[34:35], v35 offset:2720
    s_waitcnt lgkmcnt(11)
    v_mfma_f32_16x16x16_bf16 v[80:83], a[8:9], v[168:169], v[80:83]
    v_mfma_f32_16x16x16_bf16 v[84:87], a[8:9], v[170:171], v[84:87]
    v_mfma_f32_16x16x16_bf16 v[88:91], a[8:9], v[172:173], v[88:91]
    v_mfma_f32_16x16x16_bf16 v[92:95], a[8:9], v[174:175], v[92:95]
    ds_read_b64_tr_b16 a[36:37], v35 offset:5312
    ds_read_b64_tr_b16 a[38:39], v35 offset:7904
    s_waitcnt lgkmcnt(11)
    v_mfma_f32_16x16x32_bf16 v[96:99], a[12:15], v[104:107], 0
    v_mfma_f32_16x16x32_bf16 v[100:103], a[12:15], v[108:111], 0
    v_mfma_f32_16x16x32_bf16 v[176:179], a[12:15], v[112:115], 0
    v_mfma_f32_16x16x32_bf16 v[180:183], a[12:15], v[116:119], 0
    ds_read_b64_tr_b16 a[40:41], v35 offset:10496
    ds_read_b64_tr_b16 a[42:43], v35 offset:13088
    s_waitcnt lgkmcnt(11)
    v_mfma_f32_16x16x32_bf16 v[96:99], a[16:19], v[120:123], v[96:99]
    v_mfma_f32_16x16x32_bf16 v[100:103], a[16:19], v[124:127], v[100:103]
    v_mfma_f32_16x16x32_bf16 v[176:179], a[16:19], v[128:131], v[176:179]
    v_mfma_f32_16x16x32_bf16 v[180:183], a[16:19], v[132:135], v[180:183]
    ds_read_b64_tr_b16 a[44:45], v35 offset:15680
    ds_read_b64_tr_b16 a[46:47], v35 offset:18272
    s_waitcnt lgkmcnt(11)
    v_mfma_f32_16x16x32_bf16 v[96:99], a[20:23], v[136:139], v[96:99]
    v_mfma_f32_16x16x32_bf16 v[100:103], a[20:23], v[140:143], v[100:103]
    v_mfma_f32_16x16x32_bf16 v[176:179], a[20:23], v[144:147], v[176:179]
    v_mfma_f32_16x16x32_bf16 v[180:183], a[20:23], v[148:151], v[180:183]
    ds_read_b64_tr_b16 a[0:1], v36 offset:128
    s_waitcnt lgkmcnt(10)
    v_mfma_f32_16x16x32_bf16 v[96:99], a[24:27], v[152:155], v[96:99]
    v_mfma_f32_16x16x32_bf16 v[100:103], a[24:27], v[156:159], v[100:103]
    v_mfma_f32_16x16x32_bf16 v[176:179], a[24:27], v[160:163], v[176:179]
    v_mfma_f32_16x16x32_bf16 v[180:183], a[24:27], v[164:167], v[180:183]
    s_waitcnt lgkmcnt(9)
    v_mfma_f32_16x16x16_bf16 v[96:99], a[28:29], v[168:169], v[96:99]
    v_mfma_f32_16x16x16_bf16 v[100:103], a[28:29], v[170:171], v[100:103]
    v_mfma_f32_16x16x16_bf16 v[176:179], a[28:29], v[172:173], v[176:179]
    v_mfma_f32_16x16x16_bf16 v[180:183], a[28:29], v[174:175], v[180:183]
    s_waitcnt lgkmcnt(7)
    v_mfma_f32_16x16x32_bf16 v[184:187], a[32:35], v[104:107], 0
    v_mfma_f32_16x16x32_bf16 v[188:191], a[32:35], v[108:111], 0
    v_mfma_f32_16x16x32_bf16 v[192:195], a[32:35], v[112:115], 0
    v_mfma_f32_16x16x32_bf16 v[196:199], a[32:35], v[116:119], 0
    s_waitcnt lgkmcnt(5)
    v_mfma_f32_16x16x32_bf16 v[184:187], a[36:39], v[120:123], v[184:187]
    v_mfma_f32_16x16x32_bf16 v[188:191], a[36:39], v[124:127], v[188:191]
    v_mfma_f32_16x16x32_bf16 v[192:195], a[36:39], v[128:131], v[192:195]
    v_mfma_f32_16x16x32_bf16 v[196:199], a[36:39], v[132:135], v[196:199]
    s_waitcnt lgkmcnt(3)
    v_mfma_f32_16x16x32_bf16 v[184:187], a[40:43], v[136:139], v[184:187]
    v_mfma_f32_16x16x32_bf16 v[188:191], a[40:43], v[140:143], v[188:191]
    v_mfma_f32_16x16x32_bf16 v[192:195], a[40:43], v[144:147], v[192:195]
    v_mfma_f32_16x16x32_bf16 v[196:199], a[40:43], v[148:151], v[196:199]
    s_waitcnt lgkmcnt(1)
    v_mfma_f32_16x16x32_bf16 v[184:187], a[44:47], v[152:155], v[184:187]
    v_mfma_f32_16x16x32_bf16 v[188:191], a[44:47], v[156:159], v[188:191]
    v_mfma_f32_16x16x32_bf16 v[192:195], a[44:47], v[160:163], v[192:195]
    v_mfma_f32_16x16x32_bf16 v[196:199], a[44:47], v[164:167], v[196:199]
    s_waitcnt lgkmcnt(0)
    v_mfma_f32_16x16x16_bf16 v[184:187], a[0:1], v[168:169], v[184:187]
    v_mfma_f32_16x16x16_bf16 v[188:191], a[0:1], v[170:171], v[188:191]
    v_mfma_f32_16x16x16_bf16 v[192:195], a[0:1], v[172:173], v[192:195]
    v_mfma_f32_16x16x16_bf16 v[196:199], a[0:1], v[174:175], v[196:199]
    s_cmp_eq_u32 s26, 0
    s_cbranch_scc1 k2_kernel_skipw_3
    s_sub_u32 s28, 3, s26
    s_and_b32 s28, s28, 3
    s_mul_i32 s28, s28, 5120
    s_add_u32 s28, s28, s27
    v_add_u32 v28, s28, v5
    ds_write_b128 v28, v[48:51] offset:0
    ds_write_b128 v28, v[64:67] offset:1024
    ds_write_b128 v28, v[80:83] offset:2048
    ds_write_b128 v28, v[96:99] offset:3072
    ds_write_b128 v28, v[184:187] offset:4096
    s_branch k2_kernel_next_4
k2_kernel_skipw_3:
    v_mov_b32 v104, v48
    v_mov_b32 v105, v49
    v_mov_b32 v106, v50
    v_mov_b32 v107, v51
    v_mov_b32 v108, v64
    v_mov_b32 v109, v65
    v_mov_b32 v110, v66
    v_mov_b32 v111, v67
    v_mov_b32 v112, v80
    v_mov_b32 v113, v81
    v_mov_b32 v114, v82
    v_mov_b32 v115, v83
    v_mov_b32 v116, v96
    v_mov_b32 v117, v97
    v_mov_b32 v118, v98
    v_mov_b32 v119, v99
    v_mov_b32 v120, v184
    v_mov_b32 v121, v185
    v_mov_b32 v122, v186
    v_mov_b32 v123, v187
k2_kernel_next_4:
    s_cmp_eq_u32 s26, 1
    s_cbranch_scc1 k2_kernel_skipw_5
    s_sub_u32 s28, 4, s26
    s_and_b32 s28, s28, 3
    s_mul_i32 s28, s28, 5120
    s_add_u32 s28, s28, s27
    v_add_u32 v28, s28, v5
    ds_write_b128 v28, v[52:55] offset:0
    ds_write_b128 v28, v[68:71] offset:1024
    ds_write_b128 v28, v[84:87] offset:2048
    ds_write_b128 v28, v[100:103] offset:3072
    ds_write_b128 v28, v[188:191] offset:4096
    s_branch k2_kernel_next_6
k2_kernel_skipw_5:
    v_mov_b32 v104, v52
    v_mov_b32 v105, v53
    v_mov_b32 v106, v54
    v_mov_b32 v107, v55
    v_mov_b32 v108, v68
    v_mov_b32 v109, v69
    v_mov_b32 v110, v70
    v_mov_b32 v111, v71
    v_mov_b32 v112, v84
    v_mov_b32 v113, v85
    v_mov_b32 v114, v86
    v_mov_b32 v115, v87
    v_mov_b32 v116, v100
    v_mov_b32 v117, v101
    v_mov_b32 v118, v102
    v_mov_b32 v119, v103
    v_mov_b32 v120, v188
    v_mov_b32 v121, v189
    v_mov_b32 v122, v190
    v_mov_b32 v123, v191
k2_kernel_next_6:
    s_cmp_eq_u32 s26, 2
    s_cbranch_scc1 k2_kernel_skipw_7
    s_sub_u32 s28, 5, s26
    s_and_b32 s28, s28, 3
    s_mul_i32 s28, s28, 5120
    s_add_u32 s28, s28, s27
    v_add_u32 v28, s28, v5
    ds_write_b128 v28, v[56:59] offset:0
    ds_write_b128 v28, v[72:75] offset:1024
    ds_write_b128 v28, v[88:91] offset:2048
    ds_write_b128 v28, v[176:179] offset:3072
    ds_write_b128 v28, v[192:195] offset:4096
    s_branch k2_kernel_next_8
k2_kernel_skipw_7:
    v_mov_b32 v104, v56
    v_mov_b32 v105, v57
    v_mov_b32 v106, v58
    v_mov_b32 v107, v59
    v_mov_b32 v108, v72
    v_mov_b32 v109, v73
    v_mov_b32 v110, v74
    v_mov_b32 v111, v75
    v_mov_b32 v112, v88
    v_mov_b32 v113, v89
    v_mov_b32 v114, v90
    v_mov_b32 v115, v91
    v_mov_b32 v116, v176
    v_mov_b32 v117, v177
    v_mov_b32 v118, v178
    v_mov_b32 v119, v179
    v_mov_b32 v120, v192
    v_mov_b32 v121, v193
    v_mov_b32 v122, v194
    v_mov_b32 v123, v195
k2_kernel_next_8:
    s_cmp_eq_u32 s26, 3
    s_cbranch_scc1 k2_kernel_skipw_9
    s_sub_u32 s28, 6, s26
    s_and_b32 s28, s28, 3
    s_mul_i32 s28, s28, 5120
    s_add_u32 s28, s28, s27
    v_add_u32 v28, s28, v5
    ds_write_b128 v28, v[60:63] offset:0
    ds_write_b128 v28, v[76:79] offset:1024
    ds_write_b128 v28, v[92:95] offset:2048
    ds_write_b128 v28, v[180:183] offset:3072
    ds_write_b128 v28, v[196:199] offset:4096
    s_branch k2_kernel_next_10
k2_kernel_skipw_9:
    v_mov_b32 v104, v60
    v_mov_b32 v105, v61
    v_mov_b32 v106, v62
    v_mov_b32 v107, v63
    v_mov_b32 v108, v76
    v_mov_b32 v109, v77
    v_mov_b32 v110, v78
    v_mov_b32 v111, v79
    v_mov_b32 v112, v92
    v_mov_b32 v113, v93
    v_mov_b32 v114, v94
    v_mov_b32 v115, v95
    v_mov_b32 v116, v180
    v_mov_b32 v117, v181
    v_mov_b32 v118, v182
    v_mov_b32 v119, v183
    v_mov_b32 v120, v196
    v_mov_b32 v121, v197
    v_mov_b32 v122, v198
    v_mov_b32 v123, v199
k2_kernel_next_10:
    s_waitcnt vmcnt(0)
    s_waitcnt lgkmcnt(0)
    v_mov_b32 v28, 1
    s_mov_b64 exec, 1
    ds_add_u32 v7, v28
    s_mov_b64 exec, -1
k2_kernel_spin_11:
    ds_read_b32 v28, v7
    s_waitcnt lgkmcnt(0)
    v_readfirstlane_b32 s28, v28
    s_nop 0
    s_cmp_lt_u32 s28, 4
    s_nop 0
    s_cbranch_scc1 k2_kernel_spin_11
    ds_read_b64 v[18:19], v37 offset:0
    ds_read_b64 v[20:21], v37 offset:32
    ds_read_b64 v[22:23], v37 offset:64
    ds_read_b64 v[24:25], v37 offset:96
    ds_read_b64 v[26:27], v37 offset:128
    s_add_u32 s28, s26, 1
    s_and_b32 s28, s28, 3
    s_mul_i32 s28, s28, 20736
    v_add_u32 v29, s28, v5
    ds_read_b128 v[124:127], v29 offset:10240
    ds_read_b128 v[128:131], v29 offset:11264
    ds_read_b128 v[132:135], v29 offset:12288
    ds_read_b128 v[136:139], v29 offset:13312
    ds_read_b128 v[140:143], v29 offset:14336
    s_add_u32 s28, s26, 2
    s_and_b32 s28, s28, 3
    s_mul_i32 s28, s28, 20736
    v_add_u32 v30, s28, v5
    ds_read_b128 v[144:147], v30 offset:5120
    ds_read_b128 v[148:151], v30 offset:6144
    ds_read_b128 v[152:155], v30 offset:7168
    ds_read_b128 v[156:159], v30 offset:8192
    ds_read_b128 v[160:163], v30 offset:9216
    s_add_u32 s28, s26, 3
    s_and_b32 s28, s28, 3
    s_mul_i32 s28, s28, 20736
    v_add_u32 v31, s28, v5
    ds_read_b128 v[164:167], v31 offset:0
    ds_read_b128 v[168:171], v31 offset:1024
    ds_read_b128 v[172:175], v31 offset:2048
    ds_read_b128 v[176:179], v31 offset:3072
    ds_read_b128 v[180:183], v31 offset:4096
    s_add_u32 s64, s4, 0x3200000
    s_addc_u32 s65, s5, 0
    s_mov_b32 s66, 0x280000
    s_mov_b32 s67, 0x20000
    s_add_u32 s68, s4, 0x4c0000
    s_addc_u32 s69, s5, 0
    s_mov_b32 s70, 0x240000
    s_mov_b32 s71, 0x20000
    s_add_u32 s72, s4, 0x20000
    s_addc_u32 s73, s5, 0
    s_mov_b32 s74, 0x20000
    s_mov_b32 s75, 0x20000
    s_lshl_b32 s28, s25, 3
    s_add_u32 s28, s28, s24
    s_lshl_b32 s28, s28, 2
    s_add_u32 s28, s28, s26
    s_mul_i32 s48, s28, 2560
    s_mul_i32 s28, s24, 72
    v_lshl_add_u32 v44, v1, 2, s28
    v_lshrrev_b32 v45, 4, v44
    v_bfe_u32 v46, v44, 3, 1
    v_bfe_u32 v47, v44, 2, 1
    v_lshlrev_b32 v45, 6, v45
    v_lshl_add_u32 v45, v46, 5, v45
    s_and_b32 s28, s26, 1
    s_lshl_b32 s28, s28, 4
    v_add3_u32 v45, v45, v2, s28
    v_lshlrev_b32 v45, 4, v45
    v_lshl_add_u32 v32, v47, 3, v45
    v_cndmask_b32 v33, v6, v32, s[44:45]
    s_lshl_b32 s28, s25, 1
    s_lshr_b32 s29, s26, 1
    s_add_u32 s28, s28, s29
    s_mul_i32 s49, s28, 36864
    s_add_u32 s50, s49, 4096
    v_mov_b32 v34, 0
    v_mov_b32 v39, 0
    v_mov_b32 v44, 0x3f803f80
    s_waitcnt lgkmcnt(10)
    v_add_f32 v104, v104, v124
    v_add_f32 v105, v105, v125
    v_add_f32 v106, v106, v126
    v_add_f32 v107, v107, v127
    v_add_f32 v108, v108, v128
    v_add_f32 v109, v109, v129
    v_add_f32 v110, v110, v130
    v_add_f32 v111, v111, v131
    v_add_f32 v112, v112, v132
    v_add_f32 v113, v113, v133
    v_add_f32 v114, v114, v134
    v_add_f32 v115, v115, v135
    v_add_f32 v116, v116, v136
    v_add_f32 v117, v117, v137
    v_add_f32 v118, v118, v138
    v_add_f32 v119, v119, v139
    v_add_f32 v120, v120, v140
    v_add_f32 v121, v121, v141
    v_add_f32 v122, v122, v142
    v_add_f32 v123, v123, v143
    s_waitcnt lgkmcnt(5)
    v_add_f32 v104, v104, v144
    v_add_f32 v105, v105, v145
    v_add_f32 v106, v106, v146
    v_add_f32 v107, v107, v147
    v_add_f32 v108, v108, v148
    v_add_f32 v109, v109, v149
    v_add_f32 v110, v110, v150
    v_add_f32 v111, v111, v151
    v_add_f32 v112, v112, v152
    v_add_f32 v113, v113, v153
    v_add_f32 v114, v114, v154
    v_add_f32 v115, v115, v155
    v_add_f32 v116, v116, v156
    v_add_f32 v117, v117, v157
    v_add_f32 v118, v118, v158
    v_add_f32 v119, v119, v159
    v_add_f32 v120, v120, v160
    v_add_f32 v121, v121, v161
    v_add_f32 v122, v122, v162
    v_add_f32 v123, v123, v163
    s_waitcnt lgkmcnt(0)
    v_add_f32 v104, v104, v164
    v_add_f32 v105, v105, v165
    v_add_f32 v106, v106, v166
    v_add_f32 v107, v107, v167
    v_add_f32 v108, v108, v168
    v_add_f32 v109, v109, v169
    v_add_f32 v110, v110, v170
    v_add_f32 v111, v111, v171
    v_add_f32 v112, v112, v172
    v_add_f32 v113, v113, v173
    v_add_f32 v114, v114, v174
    v_add_f32 v115, v115, v175
    v_add_f32 v116, v116, v176
    v_add_f32 v117, v117, v177
    v_add_f32 v118, v118, v178
    v_add_f32 v119, v119, v179
    v_add_f32 v120, v120, v180
    v_add_f32 v121, v121, v181
    v_add_f32 v122, v122, v182
    v_add_f32 v123, v123, v183
    v_cvt_pk_bf16_f32 v40, v104, v105
    v_cvt_pk_bf16_f32 v41, v106, v107
    v_lshlrev_b32 v104, 16, v40
    v_and_b32 v105, 0xffff0000, v40
    v_lshlrev_b32 v106, 16, v41
    v_and_b32 v107, 0xffff0000, v41
    v_lshlrev_b32 v40, 16, v18
    v_and_b32 v41, 0xffff0000, v18
    v_lshlrev_b32 v42, 16, v19
    v_and_b32 v43, 0xffff0000, v19
    v_add_f32 v104, v104, v40
    v_add_f32 v105, v105, v41
    v_add_f32 v106, v106, v42
    v_add_f32 v107, v107, v43
    v_cvt_pk_bf16_f32 v18, v104, v105
    v_cvt_pk_bf16_f32 v19, v106, v107
    buffer_store_dwordx2 v[18:19], v32, s[68:71], s49 offen offset:0 sc1
    v_dot2_f32_bf16 v34, v18, v44, v34
    v_dot2_f32_bf16 v39, v18, v18, v39
    v_dot2_f32_bf16 v34, v19, v44, v34
    v_dot2_f32_bf16 v39, v19, v19, v39
    v_cvt_pk_bf16_f32 v40, v108, v109
    v_cvt_pk_bf16_f32 v41, v110, v111
    v_lshlrev_b32 v108, 16, v40
    v_and_b32 v109, 0xffff0000, v40
    v_lshlrev_b32 v110, 16, v41
    v_and_b32 v111, 0xffff0000, v41
    v_lshlrev_b32 v40, 16, v20
    v_and_b32 v41, 0xffff0000, v20
    v_lshlrev_b32 v42, 16, v21
    v_and_b32 v43, 0xffff0000, v21
    v_add_f32 v108, v108, v40
    v_add_f32 v109, v109, v41
    v_add_f32 v110, v110, v42
    v_add_f32 v111, v111, v43
    v_cvt_pk_bf16_f32 v20, v108, v109
    v_cvt_pk_bf16_f32 v21, v110, v111
    buffer_store_dwordx2 v[20:21], v32, s[68:71], s49 offen offset:1024 sc1
    v_dot2_f32_bf16 v34, v20, v44, v34
    v_dot2_f32_bf16 v39, v20, v20, v39
    v_dot2_f32_bf16 v34, v21, v44, v34
    v_dot2_f32_bf16 v39, v21, v21, v39
    v_cvt_pk_bf16_f32 v40, v112, v113
    v_cvt_pk_bf16_f32 v41, v114, v115
    v_lshlrev_b32 v112, 16, v40
    v_and_b32 v113, 0xffff0000, v40
    v_lshlrev_b32 v114, 16, v41
    v_and_b32 v115, 0xffff0000, v41
    v_lshlrev_b32 v40, 16, v22
    v_and_b32 v41, 0xffff0000, v22
    v_lshlrev_b32 v42, 16, v23
    v_and_b32 v43, 0xffff0000, v23
    v_add_f32 v112, v112, v40
    v_add_f32 v113, v113, v41
    v_add_f32 v114, v114, v42
    v_add_f32 v115, v115, v43
    v_cvt_pk_bf16_f32 v22, v112, v113
    v_cvt_pk_bf16_f32 v23, v114, v115
    buffer_store_dwordx2 v[22:23], v32, s[68:71], s49 offen offset:2048 sc1
    v_dot2_f32_bf16 v34, v22, v44, v34
    v_dot2_f32_bf16 v39, v22, v22, v39
    v_dot2_f32_bf16 v34, v23, v44, v34
    v_dot2_f32_bf16 v39, v23, v23, v39
    v_cvt_pk_bf16_f32 v40, v116, v117
    v_cvt_pk_bf16_f32 v41, v118, v119
    v_lshlrev_b32 v116, 16, v40
    v_and_b32 v117, 0xffff0000, v40
    v_lshlrev_b32 v118, 16, v41
    v_and_b32 v119, 0xffff0000, v41
    v_lshlrev_b32 v40, 16, v24
    v_and_b32 v41, 0xffff0000, v24
    v_lshlrev_b32 v42, 16, v25
    v_and_b32 v43, 0xffff0000, v25
    v_add_f32 v116, v116, v40
    v_add_f32 v117, v117, v41
    v_add_f32 v118, v118, v42
    v_add_f32 v119, v119, v43
    v_cvt_pk_bf16_f32 v24, v116, v117
    v_cvt_pk_bf16_f32 v25, v118, v119
    buffer_store_dwordx2 v[24:25], v32, s[68:71], s49 offen offset:3072 sc1
    v_dot2_f32_bf16 v34, v24, v44, v34
    v_dot2_f32_bf16 v39, v24, v24, v39
    v_dot2_f32_bf16 v34, v25, v44, v34
    v_dot2_f32_bf16 v39, v25, v25, v39
    v_cvt_pk_bf16_f32 v40, v120, v121
    v_cvt_pk_bf16_f32 v41, v122, v123
    v_lshlrev_b32 v120, 16, v40
    v_and_b32 v121, 0xffff0000, v40
    v_lshlrev_b32 v122, 16, v41
    v_and_b32 v123, 0xffff0000, v41
    v_lshlrev_b32 v40, 16, v26
    v_and_b32 v41, 0xffff0000, v26
    v_lshlrev_b32 v42, 16, v27
    v_and_b32 v43, 0xffff0000, v27
    v_add_f32 v120, v120, v40
    v_add_f32 v121, v121, v41
    v_add_f32 v122, v122, v42
    v_add_f32 v123, v123, v43
    v_cvt_pk_bf16_f32 v26, v120, v121
    v_cvt_pk_bf16_f32 v27, v122, v123
    buffer_store_dwordx2 v[26:27], v33, s[68:71], s50 offen offset:0 sc1
    v_cndmask_b32 v40, 0, v26, s[44:45]
    v_cndmask_b32 v41, 0, v27, s[44:45]
    v_dot2_f32_bf16 v34, v40, v44, v34
    v_dot2_f32_bf16 v39, v40, v40, v39
    v_dot2_f32_bf16 v34, v41, v44, v34
    v_dot2_f32_bf16 v39, v41, v41, v39
    v_xor_b32 v40, 16, v0
    v_lshlrev_b32 v40, 2, v40
    ds_bpermute_b32 v41, v40, v34
    ds_bpermute_b32 v42, v40, v39
    s_waitcnt lgkmcnt(0)
    v_add_f32 v34, v34, v41
    v_add_f32 v39, v39, v42
    v_xor_b32 v40, 32, v0
    v_lshlrev_b32 v40, 2, v40
    ds_bpermute_b32 v41, v40, v34
    ds_bpermute_b32 v42, v40, v39
    s_waitcnt lgkmcnt(0)
    v_add_f32 v34, v34, v41
    v_add_f32 v39, v39, v42
    v_mov_b32 v35, v39
    s_lshl_b32 s28, s24, 14
    s_lshl_b32 s29, s25, 9
    s_add_u32 s28, s28, s29
    s_lshl_b32 s29, s26, 7
    s_add_u32 s28, s28, s29
    buffer_store_dwordx2 v[34:35], v16, s[72:75], s28 offen sc1
    s_endpgm
k2_kernel_prep_1:
    s_sub_u32 s27, s26, 4
    s_mov_b32 s28, 0xe38e38f
    v_add_u32 v40, 0, v0
    v_mul_hi_u32 v41, v40, s28
    v_mul_u32_u24 v42, 18, v41
    v_sub_u32 v42, v40, v42
    v_mul_u32_u24 v41, 9216, v41
    v_lshl_add_u32 v17, v42, 4, v41
    v_add_u32 v40, 64, v0
    v_mul_hi_u32 v41, v40, s28
    v_mul_u32_u24 v42, 18, v41
    v_sub_u32 v42, v40, v42
    v_mul_u32_u24 v41, 9216, v41
    v_lshl_add_u32 v18, v42, 4, v41
    v_add_u32 v40, 128, v0
    v_mul_hi_u32 v41, v40, s28
    v_mul_u32_u24 v42, 18, v41
    v_sub_u32 v42, v40, v42
    v_mul_u32_u24 v41, 9216, v41
    v_lshl_add_u32 v19, v42, 4, v41
    v_add_u32 v40, 192, v0
    v_mul_hi_u32 v41, v40, s28
    v_mul_u32_u24 v42, 18, v41
    v_sub_u32 v42, v40, v42
    v_mul_u32_u24 v41, 9216, v41
    v_lshl_add_u32 v20, v42, 4, v41
    v_add_u32 v40, 256, v0
    v_mul_hi_u32 v41, v40, s28
    v_mul_u32_u24 v42, 18, v41
    v_sub_u32 v42, v40, v42
    v_mul_u32_u24 v41, 9216, v41
    v_lshl_add_u32 v21, v42, 4, v41
    v_add_u32 v40, 320, v0
    v_mul_hi_u32 v41, v40, s28
    v_mul_u32_u24 v42, 18, v41
    v_sub_u32 v42, v40, v42
    v_mul_u32_u24 v41, 9216, v41
    v_lshl_add_u32 v22, v42, 4, v41
    v_add_u32 v40, 384, v0
    v_mul_hi_u32 v41, v40, s28
    v_mul_u32_u24 v42, 18, v41
    v_sub_u32 v42, v40, v42
    v_mul_u32_u24 v41, 9216, v41
    v_lshl_add_u32 v23, v42, 4, v41
    v_add_u32 v40, 448, v0
    v_mul_hi_u32 v41, v40, s28
    v_mul_u32_u24 v42, 18, v41
    v_sub_u32 v42, v40, v42
    v_mul_u32_u24 v41, 9216, v41
    v_lshl_add_u32 v24, v42, 4, v41
    v_add_u32 v40, 512, v0
    v_mul_hi_u32 v41, v40, s28
    v_mul_u32_u24 v42, 18, v41
    v_sub_u32 v42, v40, v42
    v_mul_u32_u24 v41, 9216, v41
    v_lshl_add_u32 v25, v42, 4, v41
    s_waitcnt lgkmcnt(0)
    s_cmp_eq_u32 s22, 0
    s_cselect_b32 s84, s12, s14
    s_cselect_b32 s85, s13, s15
    s_mov_b32 s86, 0x510000
    s_mov_b32 s87, 0x20000
    s_add_u32 s64, s4, 0x700000
    s_addc_u32 s65, s5, 0
    s_mov_b32 s66, 0xa20000
    s_mov_b32 s67, 0x20000
    s_add_u32 s68, s4, 0x10000
    s_addc_u32 s69, s5, 0
    s_mov_b32 s70, 0x9000
    s_mov_b32 s71, 0x20000
    s_mul_i32 s58, s23, 144
    s_lshl_b32 s29, s27, 5
    s_add_u32 s58, s58, s29
    s_mul_i32 s58, s58, 9216
    s_mul_i32 s29, s21, 288
    s_add_u32 s58, s58, s29
    s_mul_i32 s59, s27, 9216
    s_add_u32 s59, s59, 84992
    s_add_u32 m0, s59, 0
    s_nop 0
    buffer_load_dwordx4 v17, s[84:87], s58 offen lds
    s_add_u32 m0, s59, 1024
    s_nop 0
    buffer_load_dwordx4 v18, s[84:87], s58 offen lds
    s_add_u32 m0, s59, 2048
    s_nop 0
    buffer_load_dwordx4 v19, s[84:87], s58 offen lds
    s_add_u32 m0, s59, 3072
    s_nop 0
    buffer_load_dwordx4 v20, s[84:87], s58 offen lds
    s_add_u32 m0, s59, 4096
    s_nop 0
    buffer_load_dwordx4 v21, s[84:87], s58 offen lds
    s_add_u32 m0, s59, 5120
    s_nop 0
    buffer_load_dwordx4 v22, s[84:87], s58 offen lds
    s_add_u32 m0, s59, 6144
    s_nop 0
    buffer_load_dwordx4 v23, s[84:87], s58 offen lds
    s_add_u32 m0, s59, 7168
    s_nop 0
    buffer_load_dwordx4 v24, s[84:87], s58 offen lds
    s_add_u32 m0, s59, 8192
    s_nop 0
    buffer_load_dwordx4 v25, s[84:87], s58 offen lds
    s_cmp_lg_u32 s27, 3
    s_cbranch_scc1 k2_kernel_noextra_12
    s_add_u32 s60, s58, 294912
    s_add_u32 m0, s59, 9216
    s_nop 0
    buffer_load_dwordx4 v17, s[84:87], s60 offen lds
    s_add_u32 m0, s59, 10240
    s_nop 0
    buffer_load_dwordx4 v18, s[84:87], s60 offen lds
    s_add_u32 m0, s59, 11264
    s_nop 0
    buffer_load_dwordx4 v19, s[84:87], s60 offen lds
    s_add_u32 m0, s59, 12288
    s_nop 0
    buffer_load_dwordx4 v20, s[84:87], s60 offen lds
    s_add_u32 m0, s59, 13312
    s_mov_b32 exec_hi, 0
    buffer_load_dwordx4 v21, s[84:87], s60 offen lds
    s_mov_b64 exec, -1
k2_kernel_noextra_12:
    v_lshrrev_b32 v40, 1, v1
    v_and_b32 v41, 1, v1
    v_lshl_add_u32 v42, v41, 3, v3
    v_mul_u32_u24 v42, 288, v42
    v_lshl_add_u32 v42, v4, 3, v42
    v_add_u32 v42, s59, v42
    v_lshl_add_u32 v44, v40, 5, v42
    s_lshl_b32 s28, s22, 4
    v_lshl_add_u32 v43, v41, 5, v2
    v_add_u32 v43, s28, v43
    v_lshlrev_b32 v43, 4, v43
    v_mul_u32_u24 v46, 36864, v40
    v_add_u32 v46, v46, v43
    v_cmp_eq_u32 vcc, 0, v40
    s_nop 1
    v_cndmask_b32 v45, v6, v43, vcc
    s_mul_i32 s28, s21, 324
    s_mul_i32 s29, s23, 9
    s_add_u32 s28, s28, s29
    s_lshl_b32 s29, s27, 1
    s_add_u32 s28, s28, s29
    s_lshl_b32 s51, s28, 10
    v_mov_b32 v10, 0x3f803f80
    v_cmp_eq_u32 s[46:47], v40, v2
    s_nop 1
    v_cndmask_b32 v48, 0, v10, s[46:47]
    v_cndmask_b32 v49, 0, v10, s[46:47]
    v_cndmask_b32 v50, 0, v10, s[46:47]
    v_cndmask_b32 v51, 0, v10, s[46:47]
    s_waitcnt vmcnt(0)
    ds_read_b64_tr_b16 v[72:73], v44 offset:0
    ds_read_b64_tr_b16 v[74:75], v44 offset:1152
    ds_read_b64_tr_b16 v[76:77], v44 offset:64
    ds_read_b64_tr_b16 v[78:79], v44 offset:1216
    ds_read_b64_tr_b16 v[80:81], v44 offset:128
    ds_read_b64_tr_b16 v[82:83], v44 offset:1280
    ds_read_b64_tr_b16 v[84:85], v44 offset:192
    ds_read_b64_tr_b16 v[86:87], v44 offset:1344
    ds_read_b64_tr_b16 v[88:89], v42 offset:256
    ds_read_b64_tr_b16 v[90:91], v42 offset:1408
    s_waitcnt lgkmcnt(8)
    s_add_u32 s60, s51, 0
    buffer_store_dwordx4 v[72:75], v46, s[64:67], s60 offen sc1
    v_mfma_f32_16x16x32_bf16 v[52:55], v[72:75], v[48:51], 0
    s_waitcnt lgkmcnt(6)
    s_add_u32 s61, s51, 73728
    buffer_store_dwordx4 v[76:79], v46, s[64:67], s61 offen sc1
    v_mfma_f32_16x16x32_bf16 v[56:59], v[76:79], v[48:51], 0
    s_waitcnt lgkmcnt(4)
    s_add_u32 s60, s51, 147456
    buffer_store_dwordx4 v[80:83], v46, s[64:67], s60 offen sc1
    v_mfma_f32_16x16x32_bf16 v[60:63], v[80:83], v[48:51], 0
    s_waitcnt lgkmcnt(2)
    s_add_u32 s61, s51, 221184
    buffer_store_dwordx4 v[84:87], v46, s[64:67], s61 offen sc1
    v_mfma_f32_16x16x32_bf16 v[64:67], v[84:87], v[48:51], 0
    s_waitcnt lgkmcnt(0)
    s_add_u32 s60, s51, 294912
    buffer_store_dwordx4 v[88:91], v45, s[64:67], s60 offen sc1
    v_mfma_f32_16x16x32_bf16 v[68:71], v[88:91], v[48:51], 0
    ds_read_b64_tr_b16 v[92:93], v44 offset:4608
    ds_read_b64_tr_b16 v[94:95], v44 offset:5760
    ds_read_b64_tr_b16 v[96:97], v44 offset:4672
    ds_read_b64_tr_b16 v[98:99], v44 offset:5824
    ds_read_b64_tr_b16 v[100:101], v44 offset:4736
    ds_read_b64_tr_b16 v[102:103], v44 offset:5888
    ds_read_b64_tr_b16 v[104:105], v44 offset:4800
    ds_read_b64_tr_b16 v[106:107], v44 offset:5952
    ds_read_b64_tr_b16 v[108:109], v42 offset:4864
    ds_read_b64_tr_b16 v[110:111], v42 offset:6016
    s_waitcnt lgkmcnt(8)
    s_add_u32 s60, s51, 1024
    buffer_store_dwordx4 v[92:95], v46, s[64:67], s60 offen sc1
    v_mfma_f32_16x16x32_bf16 v[52:55], v[92:95], v[48:51], v[52:55]
    s_waitcnt lgkmcnt(6)
    s_add_u32 s61, s51, 74752
    buffer_store_dwordx4 v[96:99], v46, s[64:67], s61 offen sc1
    v_mfma_f32_16x16x32_bf16 v[56:59], v[96:99], v[48:51], v[56:59]
    s_waitcnt lgkmcnt(4)
    s_add_u32 s60, s51, 148480
    buffer_store_dwordx4 v[100:103], v46, s[64:67], s60 offen sc1
    v_mfma_f32_16x16x32_bf16 v[60:63], v[100:103], v[48:51], v[60:63]
    s_waitcnt lgkmcnt(2)
    s_add_u32 s61, s51, 222208
    buffer_store_dwordx4 v[104:107], v46, s[64:67], s61 offen sc1
    v_mfma_f32_16x16x32_bf16 v[64:67], v[104:107], v[48:51], v[64:67]
    s_waitcnt lgkmcnt(0)
    s_add_u32 s60, s51, 295936
    buffer_store_dwordx4 v[108:111], v45, s[64:67], s60 offen sc1
    v_mfma_f32_16x16x32_bf16 v[68:71], v[108:111], v[48:51], v[68:71]
    s_cmp_lg_u32 s27, 3
    s_cbranch_scc1 k2_kernel_noextra2_13
    ds_read_b64_tr_b16 v[112:113], v44 offset:9216
    ds_read_b64_tr_b16 v[114:115], v44 offset:10368
    ds_read_b64_tr_b16 v[116:117], v44 offset:9280
    ds_read_b64_tr_b16 v[118:119], v44 offset:10432
    ds_read_b64_tr_b16 v[120:121], v44 offset:9344
    ds_read_b64_tr_b16 v[122:123], v44 offset:10496
    ds_read_b64_tr_b16 v[124:125], v44 offset:9408
    ds_read_b64_tr_b16 v[126:127], v44 offset:10560
    ds_read_b64_tr_b16 v[128:129], v42 offset:9472
    ds_read_b64_tr_b16 v[130:131], v42 offset:10624
    s_waitcnt lgkmcnt(8)
    s_add_u32 s60, s51, 2048
    buffer_store_dwordx4 v[112:115], v46, s[64:67], s60 offen sc1
    v_mfma_f32_16x16x32_bf16 v[52:55], v[112:115], v[48:51], v[52:55]
    s_waitcnt lgkmcnt(6)
    s_add_u32 s61, s51, 75776
    buffer_store_dwordx4 v[116:119], v46, s[64:67], s61 offen sc1
    v_mfma_f32_16x16x32_bf16 v[56:59], v[116:119], v[48:51], v[56:59]
    s_waitcnt lgkmcnt(4)
    s_add_u32 s60, s51, 149504
    buffer_store_dwordx4 v[120:123], v46, s[64:67], s60 offen sc1
    v_mfma_f32_16x16x32_bf16 v[60:63], v[120:123], v[48:51], v[60:63]
    s_waitcnt lgkmcnt(2)
    s_add_u32 s61, s51, 223232
    buffer_store_dwordx4 v[124:127], v46, s[64:67], s61 offen sc1
    v_mfma_f32_16x16x32_bf16 v[64:67], v[124:127], v[48:51], v[64:67]
    s_waitcnt lgkmcnt(0)
    s_add_u32 s60, s51, 296960
    buffer_store_dwordx4 v[128:131], v45, s[64:67], s60 offen sc1
    v_mfma_f32_16x16x32_bf16 v[68:71], v[128:131], v[48:51], v[68:71]
k2_kernel_noextra2_13:
    s_mul_i32 s28, s27, 1152
    s_add_u32 s28, s28, 138304
    v_lshlrev_b32 v9, 4, v40
    v_lshl_add_u32 v9, v41, 5, v9
    v_lshl_add_u32 v9, v2, 6, v9
    v_add_u32 v9, s28, v9
    v_cmp_gt_u32 vcc, 2, v2
    s_nop 0
    s_and_saveexec_b64 s[30:31], vcc
    ds_write_b128 v9, v[52:55] offset:0
    ds_write_b128 v9, v[56:59] offset:128
    ds_write_b128 v9, v[60:63] offset:256
    ds_write_b128 v9, v[64:67] offset:384
    ds_write_b128 v9, v[68:71] offset:512
    s_mov_b64 exec, s[30:31]
    v_lshl_add_u32 v10, v0, 2, s28
    s_waitcnt lgkmcnt(0)
    ds_read_b32 v12, v10 offset:0
    ds_read_b32 v13, v10 offset:256
    ds_read_b32 v14, v10 offset:512
    v_bfe_u32 v9, v0, 3, 1
    v_and_b32 v11, 7, v0
    v_lshl_add_u32 v9, v9, 4, v11
    s_lshl_b32 s29, s22, 3
    v_add_u32 v9, s29, v9
    v_lshl_add_u32 v9, v1, 5, v9
    v_lshlrev_b32 v9, 2, v9
    v_cmp_gt_u32 vcc, 16, v0
    s_nop 1
    v_cndmask_b32 v11, v6, v9, vcc
    s_mul_i32 s28, s21, 1152
    s_waitcnt lgkmcnt(0)
    buffer_atomic_add_f32 v12, v9, s[68:71], s28 offen offset:0
    buffer_atomic_add_f32 v13, v9, s[68:71], s28 offen offset:512
    buffer_atomic_add_f32 v14, v11, s[68:71], s28 offen offset:1024
    s_load_dwordx2 s[72:73], s[0:1], 48
    s_lshl_b32 s29, s27, 6
    v_add_u32 v9, s29, v0
    v_cmp_gt_u32 vcc, 162, v9
    v_lshlrev_b32 v9, 7, v9
    s_nop 0
    v_cndmask_b32 v9, v6, v9, vcc
    s_mul_i32 s28, s2, 20736
    s_waitcnt lgkmcnt(0)
    s_mov_b32 s74, 0x510000
    s_mov_b32 s75, 0x20000
    buffer_load_dword v11, v9, s[72:75], s28 offen
k2_kernel_end:
    s_endpgm
.globl k3_kernel
.p2align 8
.type k3_kernel,@function
k3_kernel:
    s_cmp_ge_u32 s2, 256
    s_cbranch_scc1 k3_kernel_end
    s_getpc_b64 s[6:7]
k3_kernel_pc:
    v_lshlrev_b32 v238, 7, v0
    v_min_u32 v238, k3_kernel_end-k3_kernel_pc, v238
    global_load_dword v239, v238, s[6:7]
    s_load_dwordx2 s[4:5], s[0:1], 72
    s_load_dwordx2 s[36:37], s[0:1], 48
    s_and_b32 s20, s2, 7
    s_lshr_b32 s21, s2, 3
    s_and_b32 s21, s21, 3
    s_lshl_b32 s21, s21, 3
    s_add_u32 s24, s20, s21
    s_lshr_b32 s25, s2, 5
    v_lshrrev_b32 v1, 6, v0
    v_and_b32 v0, 63, v0
    v_readfirstlane_b32 s26, v1
    v_lshlrev_b32 v1, 4, v0
    v_add_u32 v11, 0, v1
    v_add_u32 v12, 36864, v1
    v_add_u32 v13, 73728, v1
    v_add_u32 v14, 110592, v1
    v_bfe_u32 v16, v0, 4, 1
    v_lshrrev_b32 v17, 5, v0
    v_and_b32 v18, 15, v0
    v_mul_u32_u24 v16, 147456, v16
    v_lshl_add_u32 v16, v17, 8, v16
    v_lshl_add_u32 v2, v18, 4, v16
    v_lshlrev_b32 v16, 6, v17
    v_add_u32 v10, 147456, v16
    v_and_b32 v16, 31, v0
    v_lshlrev_b32 v15, 3, v16
    s_mov_b32 s27, 0x1c71c71d
    v_add_u32 v16, 0, v0
    v_mul_hi_u32 v17, v16, s27
    v_mul_u32_u24 v18, 9, v17
    v_sub_u32 v18, v16, v18
    v_mul_u32_u24 v17, 1152, v17
    v_lshl_add_u32 v240, v18, 4, v17
    v_add_u32 v16, 64, v0
    v_mul_hi_u32 v17, v16, s27
    v_mul_u32_u24 v18, 9, v17
    v_sub_u32 v18, v16, v18
    v_mul_u32_u24 v17, 1152, v17
    v_lshl_add_u32 v241, v18, 4, v17
    v_add_u32 v16, 128, v0
    v_mul_hi_u32 v17, v16, s27
    v_mul_u32_u24 v18, 9, v17
    v_sub_u32 v18, v16, v18
    v_mul_u32_u24 v17, 1152, v17
    v_lshl_add_u32 v242, v18, 4, v17
    v_add_u32 v16, 192, v0
    v_mul_hi_u32 v17, v16, s27
    v_mul_u32_u24 v18, 9, v17
    v_sub_u32 v18, v16, v18
    v_mul_u32_u24 v17, 1152, v17
    v_lshl_add_u32 v243, v18, 4, v17
    v_add_u32 v16, 256, v0
    v_mul_hi_u32 v17, v16, s27
    v_mul_u32_u24 v18, 9, v17
    v_sub_u32 v18, v16, v18
    v_mul_u32_u24 v17, 1152, v17
    v_lshl_add_u32 v244, v18, 4, v17
    v_add_u32 v16, 320, v0
    v_mul_hi_u32 v17, v16, s27
    v_mul_u32_u24 v18, 9, v17
    v_sub_u32 v18, v16, v18
    v_mul_u32_u24 v17, 1152, v17
    v_lshl_add_u32 v245, v18, 4, v17
    v_lshrrev_b32 v16, 2, v0
    v_mul_u32_u24 v16, 144, v16
    v_and_b32 v17, 3, v0
    v_lshl_add_u32 v16, v17, 3, v16
    v_add_u32 v246, 36864, v16
    v_bfe_u32 v16, v0, 4, 1
    v_lshrrev_b32 v17, 5, v0
    v_and_b32 v18, 15, v0
    s_and_b32 s27, s25, 1
    s_lshl_b32 s27, s27, 3
    v_add_u32 v20, s27, v18
    v_and_b32 v19, 15, v20
    v_lshrrev_b32 v20, 4, v20
    v_lshl_add_u32 v19, v16, 4, v19
    v_lshlrev_b32 v19, 4, v19
    v_lshl_add_u32 v19, v17, 3, v19
    v_lshl_add_u32 v247, v20, 10, v19
    v_mov_b32 v16, 0x7f000000
    v_cmp_gt_u32 vcc, 8, v18
    s_nop 1
    v_cndmask_b32 v248, v16, v247, vcc
    s_waitcnt lgkmcnt(0)
    s_add_u32 s8, s4, 0x4c0000
    s_addc_u32 s9, s5, 0
    s_mov_b32 s10, 0x240000
    s_mov_b32 s11, 0x20000
    s_add_u32 s12, s4, 0x700000
    s_addc_u32 s13, s5, 0
    s_mov_b32 s14, 0xa20000
    s_mov_b32 s15, 0x20000
    s_add_u32 s16, s4, 0x1200000
    s_addc_u32 s17, s5, 0
    s_mov_b32 s18, 0x1200000
    s_mov_b32 s19, 0x20000
    s_add_u32 s40, s4, 0x20000
    s_addc_u32 s41, s5, 0
    s_mov_b32 s42, 0x20000
    s_mov_b32 s43, 0x20000
    s_add_u32 s44, s4, 0x10000
    s_addc_u32 s45, s5, 0
    s_mov_b32 s46, 0x9000
    s_mov_b32 s47, 0x20000
    s_mov_b32 s80, s36
    s_mov_b32 s81, s37
    s_mov_b32 s82, 0x510000
    s_mov_b32 s83, 0x20000
    s_add_u32 s84, s4, 0x2400000
    s_addc_u32 s85, s5, 0
    s_mov_b32 s86, 0x510000
    s_mov_b32 s87, 0x20000
    s_lshl_b32 s28, s25, 3
    s_lshl_b32 s29, s26, 1
    s_add_u32 s28, s28, s29
    s_mul_i32 s30, s28, 36864
    s_mul_i32 s31, s24, 331776
    s_lshl_b32 s29, s26, 10
    s_add_u32 s31, s31, s29
    s_mov_b32 s32, s29
    s_lshl_b32 s28, s25, 4
    s_lshl_b32 s33, s26, 2
    s_add_u32 s28, s28, s33
    s_mul_i32 s33, s28, 147456
    s_mul_i32 s28, s24, 4608
    s_add_u32 s33, s33, s28
    s_lshl_b32 s34, s25, 11
    s_lshl_b32 s28, s26, 9
    s_add_u32 s34, s34, s28
    s_mul_i32 s35, s24, 1152
    s_add_u32 s35, s35, s32
    s_cmp_ge_u32 s26, 2
    s_cbranch_scc1 k3_kernel_nocs_1
    s_add_u32 m0, s32, 147456
    s_nop 0
    buffer_load_dwordx4 v1, s[44:47], s35 offen lds
k3_kernel_nocs_1:
    s_add_u32 s48, s30, 0
    buffer_load_dwordx4 a[0:3], v1, s[8:11], s48 offen
    s_add_u32 s49, s30, 36864
    buffer_load_dwordx4 a[4:7], v1, s[8:11], s49 offen
    s_add_u32 s50, s31, 0
    s_add_u32 m0, s32, 0
    s_nop 0
    buffer_load_dwordx4 v1, s[12:15], s50 offen lds
    s_add_u32 s51, s30, 1024
    buffer_load_dwordx4 a[8:11], v1, s[8:11], s51 offen
    s_add_u32 s48, s30, 37888
    buffer_load_dwordx4 a[12:15], v1, s[8:11], s48 offen
    s_add_u32 s49, s31, 36864
    s_add_u32 m0, s32, 36864
    s_nop 0
    buffer_load_dwordx4 v1, s[12:15], s49 offen lds
    s_add_u32 s50, s30, 2048
    buffer_load_dwordx4 a[16:19], v1, s[8:11], s50 offen
    s_add_u32 s51, s30, 38912
    buffer_load_dwordx4 a[20:23], v1, s[8:11], s51 offen
    s_add_u32 s48, s31, 73728
    s_add_u32 m0, s32, 73728
    s_nop 0
    buffer_load_dwordx4 v1, s[12:15], s48 offen lds
    s_add_u32 s49, s30, 3072
    buffer_load_dwordx4 a[24:27], v1, s[8:11], s49 offen
    s_add_u32 s50, s30, 39936
    buffer_load_dwordx4 a[28:31], v1, s[8:11], s50 offen
    s_add_u32 s51, s30, 4096
    buffer_load_dwordx4 a[32:35], v1, s[8:11], s51 offen
    s_add_u32 s48, s30, 40960
    buffer_load_dwordx4 a[36:39], v1, s[8:11], s48 offen
    s_add_u32 s49, s31, 4096
    s_add_u32 m0, s32, 4096
    s_nop 0
    buffer_load_dwordx4 v1, s[12:15], s49 offen lds
    s_add_u32 s50, s30, 5120
    buffer_load_dwordx4 a[40:43], v1, s[8:11], s50 offen
    s_add_u32 s51, s30, 41984
    buffer_load_dwordx4 a[44:47], v1, s[8:11], s51 offen
    s_add_u32 s48, s31, 40960
    s_add_u32 m0, s32, 40960
    s_nop 0
    buffer_load_dwordx4 v1, s[12:15], s48 offen lds
    s_add_u32 s49, s30, 6144
    buffer_load_dwordx4 a[48:51], v1, s[8:11], s49 offen
    s_add_u32 s50, s30, 43008
    buffer_load_dwordx4 a[52:55], v1, s[8:11], s50 offen
    s_add_u32 s51, s31, 77824
    s_add_u32 m0, s32, 77824
    s_nop 0
    buffer_load_dwordx4 v1, s[12:15], s51 offen lds
    s_add_u32 s48, s30, 7168
    buffer_load_dwordx4 a[56:59], v1, s[8:11], s48 offen
    s_add_u32 s49, s30, 44032
    buffer_load_dwordx4 a[60:63], v1, s[8:11], s49 offen
    s_add_u32 s50, s30, 8192
    buffer_load_dwordx4 a[64:67], v1, s[8:11], s50 offen
    s_add_u32 s51, s30, 45056
    buffer_load_dwordx4 a[68:71], v1, s[8:11], s51 offen
    s_add_u32 s48, s31, 8192
    s_add_u32 m0, s32, 8192
    s_nop 0
    buffer_load_dwordx4 v1, s[12:15], s48 offen lds
    s_add_u32 s49, s30, 9216
    buffer_load_dwordx4 a[72:75], v1, s[8:11], s49 offen
    s_add_u32 s50, s30, 46080
    buffer_load_dwordx4 a[76:79], v1, s[8:11], s50 offen
    s_add_u32 s51, s31, 45056
    s_add_u32 m0, s32, 45056
    s_nop 0
    buffer_load_dwordx4 v1, s[12:15], s51 offen lds
    s_add_u32 s48, s30, 10240
    buffer_load_dwordx4 a[80:83], v1, s[8:11], s48 offen
    s_add_u32 s49, s30, 47104
    buffer_load_dwordx4 a[84:87], v1, s[8:11], s49 offen
    s_add_u32 s50, s31, 81920
    s_add_u32 m0, s32, 81920
    s_nop 0
    buffer_load_dwordx4 v1, s[12:15], s50 offen lds
    s_add_u32 s51, s30, 11264
    buffer_load_dwordx4 a[88:91], v1, s[8:11], s51 offen
    s_add_u32 s48, s30, 48128
    buffer_load_dwordx4 a[92:95], v1, s[8:11], s48 offen
    s_add_u32 s49, s30, 12288
    buffer_load_dwordx4 a[96:99], v1, s[8:11], s49 offen
    s_add_u32 s50, s30, 49152
    buffer_load_dwordx4 a[100:103], v1, s[8:11], s50 offen
    s_add_u32 s51, s31, 12288
    s_add_u32 m0, s32, 12288
    s_nop 0
    buffer_load_dwordx4 v1, s[12:15], s51 offen lds
    s_waitcnt vmcnt(27)
    s_barrier
    ds_read_b128 v[176:179], v11 offset:0
    ds_read_b128 v[180:183], v12 offset:0
    ds_read_b128 v[184:187], v13 offset:0
    ds_read_b128 v[188:191], v11 offset:1024
    ds_read_b128 v[192:195], v12 offset:1024
    ds_read_b128 v[196:199], v13 offset:1024
    s_waitcnt lgkmcnt(5)
    v_mfma_f32_32x32x16_bf16 v[48:63], v[176:179], a[0:3], 0
    s_add_u32 s48, s30, 13312
    buffer_load_dwordx4 a[104:107], v1, s[8:11], s48 offen
    v_mfma_f32_32x32x16_bf16 v[64:79], v[176:179], a[4:7], 0
    ds_read_b128 v[200:203], v11 offset:2048
    s_waitcnt lgkmcnt(5)
    v_mfma_f32_32x32x16_bf16 v[80:95], v[180:183], a[0:3], 0
    s_add_u32 s49, s30, 50176
    buffer_load_dwordx4 a[108:111], v1, s[8:11], s49 offen
    v_mfma_f32_32x32x16_bf16 v[96:111], v[180:183], a[4:7], 0
    ds_read_b128 v[204:207], v12 offset:2048
    s_waitcnt lgkmcnt(5)
    v_mfma_f32_32x32x16_bf16 v[112:127], v[184:187], a[0:3], 0
    s_add_u32 s50, s31, 49152
    s_add_u32 m0, s32, 49152
    s_nop 0
    buffer_load_dwordx4 v1, s[12:15], s50 offen lds
    v_mfma_f32_32x32x16_bf16 v[128:143], v[184:187], a[4:7], 0
    ds_read_b128 v[176:179], v13 offset:2048
    s_waitcnt lgkmcnt(5)
    v_mfma_f32_32x32x16_bf16 v[48:63], v[188:191], a[8:11], v[48:63]
    s_add_u32 s51, s30, 14336
    buffer_load_dwordx4 a[112:115], v1, s[8:11], s51 offen
    v_mfma_f32_32x32x16_bf16 v[64:79], v[188:191], a[12:15], v[64:79]
    ds_read_b128 v[180:183], v11 offset:3072
    s_waitcnt lgkmcnt(5)
    v_mfma_f32_32x32x16_bf16 v[80:95], v[192:195], a[8:11], v[80:95]
    s_add_u32 s48, s30, 51200
    buffer_load_dwordx4 a[116:119], v1, s[8:11], s48 offen
    v_mfma_f32_32x32x16_bf16 v[96:111], v[192:195], a[12:15], v[96:111]
    ds_read_b128 v[184:187], v12 offset:3072
    s_waitcnt lgkmcnt(5)
    v_mfma_f32_32x32x16_bf16 v[112:127], v[196:199], a[8:11], v[112:127]
    s_add_u32 s49, s31, 86016
    s_add_u32 m0, s32, 86016
    s_nop 0
    buffer_load_dwordx4 v1, s[12:15], s49 offen lds
    v_mfma_f32_32x32x16_bf16 v[128:143], v[196:199], a[12:15], v[128:143]
    s_waitcnt vmcnt(22)
    s_barrier
    ds_read_b128 v[188:191], v13 offset:3072
    s_waitcnt lgkmcnt(5)
    v_mfma_f32_32x32x16_bf16 v[48:63], v[200:203], a[16:19], v[48:63]
    s_add_u32 s50, s30, 15360
    buffer_load_dwordx4 a[120:123], v1, s[8:11], s50 offen
    v_mfma_f32_32x32x16_bf16 v[64:79], v[200:203], a[20:23], v[64:79]
    ds_read_b128 v[192:195], v11 offset:4096
    s_waitcnt lgkmcnt(5)
    v_mfma_f32_32x32x16_bf16 v[80:95], v[204:207], a[16:19], v[80:95]
    s_add_u32 s51, s30, 52224
    buffer_load_dwordx4 a[124:127], v1, s[8:11], s51 offen
    v_mfma_f32_32x32x16_bf16 v[96:111], v[204:207], a[20:23], v[96:111]
    ds_read_b128 v[196:199], v12 offset:4096
    s_waitcnt lgkmcnt(5)
    v_mfma_f32_32x32x16_bf16 v[112:127], v[176:179], a[16:19], v[112:127]
    s_add_u32 s48, s34, 0
    buffer_load_dwordx2 v[144:145], v15, s[40:43], s48 offen
    v_mfma_f32_32x32x16_bf16 v[128:143], v[176:179], a[20:23], v[128:143]
    ds_read_b128 v[200:203], v13 offset:4096
    s_waitcnt lgkmcnt(5)
    v_mfma_f32_32x32x16_bf16 v[48:63], v[180:183], a[24:27], v[48:63]
    s_add_u32 s49, s34, 16384
    buffer_load_dwordx2 v[146:147], v15, s[40:43], s49 offen
    v_mfma_f32_32x32x16_bf16 v[64:79], v[180:183], a[28:31], v[64:79]
    ds_read_b128 v[204:207], v11 offset:5120
    s_waitcnt lgkmcnt(5)
    v_mfma_f32_32x32x16_bf16 v[80:95], v[184:187], a[24:27], v[80:95]
    s_add_u32 s50, s34, 32768
    buffer_load_dwordx2 v[148:149], v15, s[40:43], s50 offen
    v_mfma_f32_32x32x16_bf16 v[96:111], v[184:187], a[28:31], v[96:111]
    ds_read_b128 v[176:179], v12 offset:5120
    s_waitcnt lgkmcnt(5)
    v_mfma_f32_32x32x16_bf16 v[112:127], v[188:191], a[24:27], v[112:127]
    s_add_u32 s51, s34, 49152
    buffer_load_dwordx2 v[150:151], v15, s[40:43], s51 offen
    v_mfma_f32_32x32x16_bf16 v[128:143], v[188:191], a[28:31], v[128:143]
    ds_read_b128 v[180:183], v13 offset:5120
    s_waitcnt lgkmcnt(5)
    v_mfma_f32_32x32x16_bf16 v[48:63], v[192:195], a[32:35], v[48:63]
    s_add_u32 s48, s34, 65536
    buffer_load_dwordx2 v[152:153], v15, s[40:43], s48 offen
    v_mfma_f32_32x32x16_bf16 v[64:79], v[192:195], a[36:39], v[64:79]
    ds_read_b128 v[184:187], v11 offset:6144
    s_waitcnt lgkmcnt(5)
    v_mfma_f32_32x32x16_bf16 v[80:95], v[196:199], a[32:35], v[80:95]
    s_add_u32 s49, s34, 81920
    buffer_load_dwordx2 v[154:155], v15, s[40:43], s49 offen
    v_mfma_f32_32x32x16_bf16 v[96:111], v[196:199], a[36:39], v[96:111]
    ds_read_b128 v[188:191], v12 offset:6144
    s_waitcnt lgkmcnt(5)
    v_mfma_f32_32x32x16_bf16 v[112:127], v[200:203], a[32:35], v[112:127]
    s_add_u32 s50, s34, 98304
    buffer_load_dwordx2 v[156:157], v15, s[40:43], s50 offen
    v_mfma_f32_32x32x16_bf16 v[128:143], v[200:203], a[36:39], v[128:143]
    ds_read_b128 v[192:195], v13 offset:6144
    s_waitcnt lgkmcnt(5)
    v_mfma_f32_32x32x16_bf16 v[48:63], v[204:207], a[40:43], v[48:63]
    s_add_u32 s51, s34, 114688
    buffer_load_dwordx2 v[158:159], v15, s[40:43], s51 offen
    v_mfma_f32_32x32x16_bf16 v[64:79], v[204:207], a[44:47], v[64:79]
    ds_read_b128 v[196:199], v11 offset:7168
    s_waitcnt lgkmcnt(5)
    v_mfma_f32_32x32x16_bf16 v[80:95], v[176:179], a[40:43], v[80:95]
    s_add_u32 s48, s34, 256
    buffer_load_dwordx2 v[160:161], v15, s[40:43], s48 offen
    v_mfma_f32_32x32x16_bf16 v[96:111], v[176:179], a[44:47], v[96:111]
    ds_read_b128 v[200:203], v12 offset:7168
    s_waitcnt lgkmcnt(5)
    v_mfma_f32_32x32x16_bf16 v[112:127], v[180:183], a[40:43], v[112:127]
    s_add_u32 s49, s34, 16640
    buffer_load_dwordx2 v[162:163], v15, s[40:43], s49 offen
    v_mfma_f32_32x32x16_bf16 v[128:143], v[180:183], a[44:47], v[128:143]
    s_waitcnt vmcnt(23)
    s_barrier
    ds_read_b128 v[204:207], v13 offset:7168
    s_waitcnt lgkmcnt(5)
    v_mfma_f32_32x32x16_bf16 v[48:63], v[184:187], a[48:51], v[48:63]
    s_add_u32 s50, s34, 33024
    buffer_load_dwordx2 v[164:165], v15, s[40:43], s50 offen
    v_mfma_f32_32x32x16_bf16 v[64:79], v[184:187], a[52:55], v[64:79]
    ds_read_b128 v[176:179], v11 offset:8192
    s_waitcnt lgkmcnt(5)
    v_mfma_f32_32x32x16_bf16 v[80:95], v[188:191], a[48:51], v[80:95]
    s_add_u32 s51, s34, 49408
    buffer_load_dwordx2 v[166:167], v15, s[40:43], s51 offen
    v_mfma_f32_32x32x16_bf16 v[96:111], v[188:191], a[52:55], v[96:111]
    ds_read_b128 v[180:183], v12 offset:8192
    s_waitcnt lgkmcnt(5)
    v_mfma_f32_32x32x16_bf16 v[112:127], v[192:195], a[48:51], v[112:127]
    s_add_u32 s48, s34, 65792
    buffer_load_dwordx2 v[168:169], v15, s[40:43], s48 offen
    v_mfma_f32_32x32x16_bf16 v[128:143], v[192:195], a[52:55], v[128:143]
    ds_read_b128 v[184:187], v13 offset:8192
    s_waitcnt lgkmcnt(5)
    v_mfma_f32_32x32x16_bf16 v[48:63], v[196:199], a[56:59], v[48:63]
    s_add_u32 s49, s34, 82176
    buffer_load_dwordx2 v[170:171], v15, s[40:43], s49 offen
    v_mfma_f32_32x32x16_bf16 v[64:79], v[196:199], a[60:63], v[64:79]
    ds_read_b128 v[188:191], v11 offset:9216
    s_waitcnt lgkmcnt(5)
    v_mfma_f32_32x32x16_bf16 v[80:95], v[200:203], a[56:59], v[80:95]
    s_add_u32 s50, s34, 98560
    buffer_load_dwordx2 v[172:173], v15, s[40:43], s50 offen
    v_mfma_f32_32x32x16_bf16 v[96:111], v[200:203], a[60:63], v[96:111]
    ds_read_b128 v[192:195], v12 offset:9216
    s_waitcnt lgkmcnt(5)
    v_mfma_f32_32x32x16_bf16 v[112:127], v[204:207], a[56:59], v[112:127]
    s_add_u32 s51, s34, 114944
    buffer_load_dwordx2 v[174:175], v15, s[40:43], s51 offen
    v_mfma_f32_32x32x16_bf16 v[128:143], v[204:207], a[60:63], v[128:143]
    ds_read_b128 v[196:199], v13 offset:9216
    s_waitcnt lgkmcnt(5)
    v_mfma_f32_32x32x16_bf16 v[48:63], v[176:179], a[64:67], v[48:63]
    s_add_u32 s48, s30, 16384
    buffer_load_dwordx4 a[128:131], v1, s[8:11], s48 offen
    v_mfma_f32_32x32x16_bf16 v[64:79], v[176:179], a[68:71], v[64:79]
    ds_read_b128 v[200:203], v11 offset:10240
    s_waitcnt lgkmcnt(5)
    v_mfma_f32_32x32x16_bf16 v[80:95], v[180:183], a[64:67], v[80:95]
    s_add_u32 s49, s30, 53248
    buffer_load_dwordx4 a[132:135], v1, s[8:11], s49 offen
    v_mfma_f32_32x32x16_bf16 v[96:111], v[180:183], a[68:71], v[96:111]
    ds_read_b128 v[204:207], v12 offset:10240
    s_waitcnt lgkmcnt(5)
    v_mfma_f32_32x32x16_bf16 v[112:127], v[184:187], a[64:67], v[112:127]
    s_add_u32 s50, s31, 16384
    s_add_u32 m0, s32, 16384
    s_nop 0
    buffer_load_dwordx4 v1, s[12:15], s50 offen lds
    v_mfma_f32_32x32x16_bf16 v[128:143], v[184:187], a[68:71], v[128:143]
    ds_read_b128 v[176:179], v13 offset:10240
    s_waitcnt lgkmcnt(5)
    v_mfma_f32_32x32x16_bf16 v[48:63], v[188:191], a[72:75], v[48:63]
    s_add_u32 s51, s30, 17408
    buffer_load_dwordx4 a[136:139], v1, s[8:11], s51 offen
    v_mfma_f32_32x32x16_bf16 v[64:79], v[188:191], a[76:79], v[64:79]
    ds_read_b128 v[180:183], v11 offset:11264
    s_waitcnt lgkmcnt(5)
    v_mfma_f32_32x32x16_bf16 v[80:95], v[192:195], a[72:75], v[80:95]
    s_add_u32 s48, s30, 54272
    buffer_load_dwordx4 a[140:143], v1, s[8:11], s48 offen
    v_mfma_f32_32x32x16_bf16 v[96:111], v[192:195], a[76:79], v[96:111]
    ds_read_b128 v[184:187], v12 offset:11264
    s_waitcnt lgkmcnt(5)
    v_mfma_f32_32x32x16_bf16 v[112:127], v[196:199], a[72:75], v[112:127]
    s_add_u32 s49, s31, 53248
    s_add_u32 m0, s32, 53248
    s_nop 0
    buffer_load_dwordx4 v1, s[12:15], s49 offen lds
    v_mfma_f32_32x32x16_bf16 v[128:143], v[196:199], a[76:79], v[128:143]
    s_waitcnt vmcnt(24)
    s_barrier
    ds_read_b128 v[188:191], v13 offset:11264
    s_waitcnt lgkmcnt(5)
    v_mfma_f32_32x32x16_bf16 v[48:63], v[200:203], a[80:83], v[48:63]
    s_add_u32 s50, s30, 18432
    buffer_load_dwordx4 a[144:147], v1, s[8:11], s50 offen
    v_mfma_f32_32x32x16_bf16 v[64:79], v[200:203], a[84:87], v[64:79]
    ds_read_b128 v[192:195], v11 offset:12288
    s_waitcnt lgkmcnt(5)
    v_mfma_f32_32x32x16_bf16 v[80:95], v[204:207], a[80:83], v[80:95]
    s_add_u32 s51, s30, 55296
    buffer_load_dwordx4 a[148:151], v1, s[8:11], s51 offen
    v_mfma_f32_32x32x16_bf16 v[96:111], v[204:207], a[84:87], v[96:111]
    ds_read_b128 v[196:199], v12 offset:12288
    s_waitcnt lgkmcnt(5)
    v_mfma_f32_32x32x16_bf16 v[112:127], v[176:179], a[80:83], v[112:127]
    s_add_u32 s48, s31, 90112
    s_add_u32 m0, s32, 90112
    s_nop 0
    buffer_load_dwordx4 v1, s[12:15], s48 offen lds
    v_mfma_f32_32x32x16_bf16 v[128:143], v[176:179], a[84:87], v[128:143]
    ds_read_b128 v[200:203], v13 offset:12288
    s_waitcnt lgkmcnt(5)
    v_mfma_f32_32x32x16_bf16 v[48:63], v[180:183], a[88:91], v[48:63]
    s_add_u32 s49, s30, 19456
    buffer_load_dwordx4 a[152:155], v1, s[8:11], s49 offen
    v_mfma_f32_32x32x16_bf16 v[64:79], v[180:183], a[92:95], v[64:79]
    ds_read_b128 v[204:207], v11 offset:13312
    s_waitcnt lgkmcnt(5)
    v_mfma_f32_32x32x16_bf16 v[80:95], v[184:187], a[88:91], v[80:95]
    s_add_u32 s50, s30, 56320
    buffer_load_dwordx4 a[156:159], v1, s[8:11], s50 offen
    v_mfma_f32_32x32x16_bf16 v[96:111], v[184:187], a[92:95], v[96:111]
    ds_read_b128 v[176:179], v12 offset:13312
    s_waitcnt lgkmcnt(5)
    v_mfma_f32_32x32x16_bf16 v[112:127], v[188:191], a[88:91], v[112:127]
    s_add_u32 s51, s30, 20480
    buffer_load_dwordx4 a[160:163], v1, s[8:11], s51 offen
    v_mfma_f32_32x32x16_bf16 v[128:143], v[188:191], a[92:95], v[128:143]
    ds_read_b128 v[180:183], v13 offset:13312
    s_waitcnt lgkmcnt(5)
    v_mfma_f32_32x32x16_bf16 v[48:63], v[192:195], a[96:99], v[48:63]
    s_add_u32 s48, s30, 57344
    buffer_load_dwordx4 a[164:167], v1, s[8:11], s48 offen
    v_mfma_f32_32x32x16_bf16 v[64:79], v[192:195], a[100:103], v[64:79]
    ds_read_b128 v[184:187], v11 offset:14336
    s_waitcnt lgkmcnt(5)
    v_mfma_f32_32x32x16_bf16 v[80:95], v[196:199], a[96:99], v[80:95]
    s_add_u32 s49, s31, 20480
    s_add_u32 m0, s32, 20480
    s_nop 0
    buffer_load_dwordx4 v1, s[12:15], s49 offen lds
    v_mfma_f32_32x32x16_bf16 v[96:111], v[196:199], a[100:103], v[96:111]
    ds_read_b128 v[188:191], v12 offset:14336
    s_waitcnt lgkmcnt(5)
    v_mfma_f32_32x32x16_bf16 v[112:127], v[200:203], a[96:99], v[112:127]
    s_add_u32 s50, s30, 21504
    buffer_load_dwordx4 a[168:171], v1, s[8:11], s50 offen
    v_mfma_f32_32x32x16_bf16 v[128:143], v[200:203], a[100:103], v[128:143]
    ds_read_b128 v[192:195], v13 offset:14336
    s_waitcnt lgkmcnt(5)
    v_mfma_f32_32x32x16_bf16 v[48:63], v[204:207], a[104:107], v[48:63]
    s_add_u32 s51, s30, 58368
    buffer_load_dwordx4 a[172:175], v1, s[8:11], s51 offen
    v_mfma_f32_32x32x16_bf16 v[64:79], v[204:207], a[108:111], v[64:79]
    ds_read_b128 v[196:199], v11 offset:15360
    s_waitcnt lgkmcnt(5)
    v_mfma_f32_32x32x16_bf16 v[80:95], v[176:179], a[104:107], v[80:95]
    s_add_u32 s48, s31, 57344
    s_add_u32 m0, s32, 57344
    s_nop 0
    buffer_load_dwordx4 v1, s[12:15], s48 offen lds
    v_mfma_f32_32x32x16_bf16 v[96:111], v[176:179], a[108:111], v[96:111]
    ds_read_b128 v[200:203], v12 offset:15360
    s_waitcnt lgkmcnt(5)
    v_mfma_f32_32x32x16_bf16 v[112:127], v[180:183], a[104:107], v[112:127]
    s_add_u32 s49, s30, 22528
    buffer_load_dwordx4 a[176:179], v1, s[8:11], s49 offen
    v_mfma_f32_32x32x16_bf16 v[128:143], v[180:183], a[108:111], v[128:143]
    s_waitcnt vmcnt(9)
    s_barrier
    ds_read_b128 v[204:207], v13 offset:15360
    s_waitcnt lgkmcnt(5)
    v_mfma_f32_32x32x16_bf16 v[48:63], v[184:187], a[112:115], v[48:63]
    s_add_u32 s50, s30, 59392
    buffer_load_dwordx4 a[180:183], v1, s[8:11], s50 offen
    v_mfma_f32_32x32x16_bf16 v[64:79], v[184:187], a[116:119], v[64:79]
    ds_read_b128 v[176:179], v11 offset:16384
    s_waitcnt lgkmcnt(5)
    v_mfma_f32_32x32x16_bf16 v[80:95], v[188:191], a[112:115], v[80:95]
    s_add_u32 s51, s31, 94208
    s_add_u32 m0, s32, 94208
    s_nop 0
    buffer_load_dwordx4 v1, s[12:15], s51 offen lds
    v_mfma_f32_32x32x16_bf16 v[96:111], v[188:191], a[116:119], v[96:111]
    ds_read_b128 v[180:183], v12 offset:16384
    s_waitcnt lgkmcnt(5)
    v_mfma_f32_32x32x16_bf16 v[112:127], v[192:195], a[112:115], v[112:127]
    s_add_u32 s48, s30, 23552
    buffer_load_dwordx4 a[184:187], v1, s[8:11], s48 offen
    v_mfma_f32_32x32x16_bf16 v[128:143], v[192:195], a[116:119], v[128:143]
    ds_read_b128 v[184:187], v13 offset:16384
    s_waitcnt lgkmcnt(5)
    v_mfma_f32_32x32x16_bf16 v[48:63], v[196:199], a[120:123], v[48:63]
    s_add_u32 s49, s30, 60416
    buffer_load_dwordx4 a[188:191], v1, s[8:11], s49 offen
    v_mfma_f32_32x32x16_bf16 v[64:79], v[196:199], a[124:127], v[64:79]
    ds_read_b128 v[188:191], v11 offset:17408
    s_waitcnt lgkmcnt(5)
    v_mfma_f32_32x32x16_bf16 v[80:95], v[200:203], a[120:123], v[80:95]
    s_add_u32 s50, s30, 24576
    buffer_load_dwordx4 a[192:195], v1, s[8:11], s50 offen
    v_mfma_f32_32x32x16_bf16 v[96:111], v[200:203], a[124:127], v[96:111]
    ds_read_b128 v[192:195], v12 offset:17408
    s_waitcnt lgkmcnt(5)
    v_mfma_f32_32x32x16_bf16 v[112:127], v[204:207], a[120:123], v[112:127]
    s_add_u32 s51, s30, 61440
    buffer_load_dwordx4 a[196:199], v1, s[8:11], s51 offen
    v_mfma_f32_32x32x16_bf16 v[128:143], v[204:207], a[124:127], v[128:143]
    ds_read_b128 v[196:199], v13 offset:17408
    s_waitcnt lgkmcnt(5)
    v_mfma_f32_32x32x16_bf16 v[48:63], v[176:179], a[128:131], v[48:63]
    s_add_u32 s48, s31, 24576
    s_add_u32 m0, s32, 24576
    s_nop 0
    buffer_load_dwordx4 v1, s[12:15], s48 offen lds
    v_mfma_f32_32x32x16_bf16 v[64:79], v[176:179], a[132:135], v[64:79]
    ds_read_b128 v[200:203], v11 offset:18432
    s_waitcnt lgkmcnt(5)
    v_mfma_f32_32x32x16_bf16 v[80:95], v[180:183], a[128:131], v[80:95]
    s_add_u32 s49, s30, 25600
    buffer_load_dwordx4 a[200:203], v1, s[8:11], s49 offen
    v_mfma_f32_32x32x16_bf16 v[96:111], v[180:183], a[132:135], v[96:111]
    ds_read_b128 v[204:207], v12 offset:18432
    s_waitcnt lgkmcnt(5)
    v_mfma_f32_32x32x16_bf16 v[112:127], v[184:187], a[128:131], v[112:127]
    s_add_u32 s50, s30, 62464
    buffer_load_dwordx4 a[204:207], v1, s[8:11], s50 offen
    v_mfma_f32_32x32x16_bf16 v[128:143], v[184:187], a[132:135], v[128:143]
    ds_read_b128 v[176:179], v13 offset:18432
    s_waitcnt lgkmcnt(5)
    v_mfma_f32_32x32x16_bf16 v[48:63], v[188:191], a[136:139], v[48:63]
    s_add_u32 s51, s31, 61440
    s_add_u32 m0, s32, 61440
    s_nop 0
    buffer_load_dwordx4 v1, s[12:15], s51 offen lds
    v_mfma_f32_32x32x16_bf16 v[64:79], v[188:191], a[140:143], v[64:79]
    ds_read_b128 v[180:183], v11 offset:19456
    s_waitcnt lgkmcnt(5)
    v_mfma_f32_32x32x16_bf16 v[80:95], v[192:195], a[136:139], v[80:95]
    s_add_u32 s48, s30, 26624
    buffer_load_dwordx4 a[208:211], v1, s[8:11], s48 offen
    v_mfma_f32_32x32x16_bf16 v[96:111], v[192:195], a[140:143], v[96:111]
    ds_read_b128 v[184:187], v12 offset:19456
    s_waitcnt lgkmcnt(5)
    v_mfma_f32_32x32x16_bf16 v[112:127], v[196:199], a[136:139], v[112:127]
    s_add_u32 s49, s30, 63488
    buffer_load_dwordx4 a[212:215], v1, s[8:11], s49 offen
    v_mfma_f32_32x32x16_bf16 v[128:143], v[196:199], a[140:143], v[128:143]
    s_waitcnt vmcnt(10)
    s_barrier
    ds_read_b128 v[188:191], v13 offset:19456
    s_waitcnt lgkmcnt(5)
    v_mfma_f32_32x32x16_bf16 v[48:63], v[200:203], a[144:147], v[48:63]
    s_add_u32 s50, s31, 98304
    s_add_u32 m0, s32, 98304
    s_nop 0
    buffer_load_dwordx4 v1, s[12:15], s50 offen lds
    v_mfma_f32_32x32x16_bf16 v[64:79], v[200:203], a[148:151], v[64:79]
    ds_read_b128 v[192:195], v11 offset:20480
    s_waitcnt lgkmcnt(5)
    v_mfma_f32_32x32x16_bf16 v[80:95], v[204:207], a[144:147], v[80:95]
    s_add_u32 s51, s30, 27648
    buffer_load_dwordx4 a[216:219], v1, s[8:11], s51 offen
    v_mfma_f32_32x32x16_bf16 v[96:111], v[204:207], a[148:151], v[96:111]
    ds_read_b128 v[196:199], v12 offset:20480
    s_waitcnt lgkmcnt(5)
    v_mfma_f32_32x32x16_bf16 v[112:127], v[176:179], a[144:147], v[112:127]
    s_add_u32 s48, s30, 64512
    buffer_load_dwordx4 a[220:223], v1, s[8:11], s48 offen
    v_mfma_f32_32x32x16_bf16 v[128:143], v[176:179], a[148:151], v[128:143]
    ds_read_b128 v[200:203], v13 offset:20480
    s_waitcnt lgkmcnt(5)
    v_mfma_f32_32x32x16_bf16 v[48:63], v[180:183], a[152:155], v[48:63]
    s_add_u32 s49, s30, 28672
    buffer_load_dwordx4 a[224:227], v1, s[8:11], s49 offen
    v_mfma_f32_32x32x16_bf16 v[64:79], v[180:183], a[156:159], v[64:79]
    ds_read_b128 v[204:207], v11 offset:21504
    s_waitcnt lgkmcnt(5)
    v_mfma_f32_32x32x16_bf16 v[80:95], v[184:187], a[152:155], v[80:95]
    s_add_u32 s50, s30, 65536
    buffer_load_dwordx4 a[228:231], v1, s[8:11], s50 offen
    v_mfma_f32_32x32x16_bf16 v[96:111], v[184:187], a[156:159], v[96:111]
    ds_read_b128 v[176:179], v12 offset:21504
    s_waitcnt lgkmcnt(5)
    v_mfma_f32_32x32x16_bf16 v[112:127], v[188:191], a[152:155], v[112:127]
    s_add_u32 s51, s31, 28672
    s_add_u32 m0, s32, 28672
    s_nop 0
    buffer_load_dwordx4 v1, s[12:15], s51 offen lds
    v_mfma_f32_32x32x16_bf16 v[128:143], v[188:191], a[156:159], v[128:143]
    ds_read_b128 v[180:183], v13 offset:21504
    s_waitcnt lgkmcnt(5)
    v_mfma_f32_32x32x16_bf16 v[48:63], v[192:195], a[160:163], v[48:63]
    s_add_u32 s48, s30, 29696
    buffer_load_dwordx4 a[232:235], v1, s[8:11], s48 offen
    v_add_f32 v144, v144, v146
    v_mfma_f32_32x32x16_bf16 v[64:79], v[192:195], a[164:167], v[64:79]
    v_add_f32 v145, v145, v147
    v_add_f32 v144, v144, v148
    v_add_f32 v145, v145, v149
    ds_read_b128 v[184:187], v11 offset:22528
    s_waitcnt lgkmcnt(5)
    v_mfma_f32_32x32x16_bf16 v[80:95], v[196:199], a[160:163], v[80:95]
    s_add_u32 s49, s30, 66560
    buffer_load_dwordx4 a[236:239], v1, s[8:11], s49 offen
    v_add_f32 v144, v144, v150
    v_add_f32 v145, v145, v151
    v_mfma_f32_32x32x16_bf16 v[96:111], v[196:199], a[164:167], v[96:111]
    v_add_f32 v144, v144, v152
    v_add_f32 v145, v145, v153
    v_add_f32 v144, v144, v154
    ds_read_b128 v[188:191], v12 offset:22528
    s_waitcnt lgkmcnt(5)
    v_mfma_f32_32x32x16_bf16 v[112:127], v[200:203], a[160:163], v[112:127]
    s_add_u32 s50, s31, 65536
    s_add_u32 m0, s32, 65536
    s_nop 0
    buffer_load_dwordx4 v1, s[12:15], s50 offen lds
    v_add_f32 v145, v145, v155
    v_add_f32 v144, v144, v156
    v_mfma_f32_32x32x16_bf16 v[128:143], v[200:203], a[164:167], v[128:143]
    v_add_f32 v145, v145, v157
    v_add_f32 v144, v144, v158
    v_add_f32 v145, v145, v159
    ds_read_b128 v[192:195], v13 offset:22528
    s_waitcnt lgkmcnt(5)
    v_mfma_f32_32x32x16_bf16 v[48:63], v[204:207], a[168:171], v[48:63]
    s_add_u32 s51, s30, 30720
    buffer_load_dwordx4 a[240:243], v1, s[8:11], s51 offen
    v_mul_f32 v144, 0x3ae38e39, v144
    v_mul_f32 v145, 0x3ae38e39, v145
    v_mfma_f32_32x32x16_bf16 v[64:79], v[204:207], a[172:175], v[64:79]
    v_fma_f32 v145, -v144, v144, v145
    v_max_f32 v145, 0, v145
    v_cvt_pk_bf16_f32 v146, v144, v145
    ds_read_b128 v[196:199], v11 offset:23552
    s_waitcnt lgkmcnt(5)
    v_mfma_f32_32x32x16_bf16 v[80:95], v[176:179], a[168:171], v[80:95]
    s_add_u32 s48, s30, 67584
    buffer_load_dwordx4 a[244:247], v1, s[8:11], s48 offen
    v_lshlrev_b32 v144, 16, v146
    v_and_b32 v145, 0xffff0000, v146
    v_mfma_f32_32x32x16_bf16 v[96:111], v[176:179], a[172:175], v[96:111]
    v_add_f32 v145, 0x3727c5ac, v145
    v_cvt_pk_bf16_f32 v146, v145, v145
    v_lshlrev_b32 v145, 16, v146
    ds_read_b128 v[200:203], v12 offset:23552
    s_waitcnt lgkmcnt(5)
    v_mfma_f32_32x32x16_bf16 v[112:127], v[180:183], a[168:171], v[112:127]
    s_add_u32 s49, s31, 102400
    s_add_u32 m0, s32, 102400
    s_nop 0
    buffer_load_dwordx4 v1, s[12:15], s49 offen lds
    v_sqrt_f32 v145, v145
    v_mfma_f32_32x32x16_bf16 v[128:143], v[180:183], a[172:175], v[128:143]
    v_sub_f32 v4, 0, v144
    v_cvt_pk_bf16_f32 v146, v145, v145
    v_lshlrev_b32 v145, 16, v146
    s_waitcnt vmcnt(11)
    s_barrier
    ds_read_b128 v[204:207], v13 offset:23552
    s_waitcnt lgkmcnt(5)
    v_mfma_f32_32x32x16_bf16 v[48:63], v[184:187], a[176:179], v[48:63]
    s_add_u32 s50, s30, 31744
    buffer_load_dwordx4 a[248:251], v1, s[8:11], s50 offen
    v_mul_f32 v8, v145, v145
    v_mfma_f32_32x32x16_bf16 v[64:79], v[184:187], a[180:183], v[64:79]
    v_rcp_f32 v145, v145
    s_nop 0
    ds_read_b128 v[176:179], v11 offset:24576
    s_waitcnt lgkmcnt(5)
    v_mfma_f32_32x32x16_bf16 v[80:95], v[188:191], a[176:179], v[80:95]
    s_add_u32 s51, s30, 68608
    buffer_load_dwordx4 a[252:255], v1, s[8:11], s51 offen
    v_mul_f32 v6, 0xbfb8aa3b, v145
    v_add_f32 v160, v160, v162
    v_mfma_f32_32x32x16_bf16 v[96:111], v[188:191], a[180:183], v[96:111]
    v_add_f32 v161, v161, v163
    v_add_f32 v160, v160, v164
    v_add_f32 v161, v161, v165
    ds_read_b128 v[180:183], v12 offset:24576
    s_waitcnt lgkmcnt(5)
    v_mfma_f32_32x32x16_bf16 v[112:127], v[192:195], a[176:179], v[112:127]
    s_add_u32 s48, s30, 32768
    buffer_load_dwordx4 v[16:19], v1, s[8:11], s48 offen
    v_add_f32 v160, v160, v166
    v_add_f32 v161, v161, v167
    v_mfma_f32_32x32x16_bf16 v[128:143], v[192:195], a[180:183], v[128:143]
    v_add_f32 v160, v160, v168
    v_add_f32 v161, v161, v169
    v_add_f32 v160, v160, v170
    ds_read_b128 v[184:187], v13 offset:24576
    s_waitcnt lgkmcnt(5)
    v_mfma_f32_32x32x16_bf16 v[48:63], v[196:199], a[184:187], v[48:63]
    s_add_u32 s49, s30, 69632
    buffer_load_dwordx4 v[20:23], v1, s[8:11], s49 offen
    v_add_f32 v161, v161, v171
    v_add_f32 v160, v160, v172
    v_mfma_f32_32x32x16_bf16 v[64:79], v[196:199], a[188:191], v[64:79]
    v_add_f32 v161, v161, v173
    v_add_f32 v160, v160, v174
    v_add_f32 v161, v161, v175
    ds_read_b128 v[188:191], v11 offset:25600
    s_waitcnt lgkmcnt(5)
    v_mfma_f32_32x32x16_bf16 v[80:95], v[200:203], a[184:187], v[80:95]
    s_add_u32 s50, s31, 32768
    s_add_u32 m0, s32, 32768
    s_nop 0
    buffer_load_dwordx4 v1, s[12:15], s50 offen lds
    v_mul_f32 v160, 0x3ae38e39, v160
    v_mul_f32 v161, 0x3ae38e39, v161
    v_mfma_f32_32x32x16_bf16 v[96:111], v[200:203], a[188:191], v[96:111]
    v_fma_f32 v161, -v160, v160, v161
    v_max_f32 v161, 0, v161
    v_cvt_pk_bf16_f32 v162, v160, v161
    ds_read_b128 v[192:195], v12 offset:25600
    s_waitcnt lgkmcnt(5)
    v_mfma_f32_32x32x16_bf16 v[112:127], v[204:207], a[184:187], v[112:127]
    s_add_u32 s51, s30, 33792
    buffer_load_dwordx4 v[24:27], v1, s[8:11], s51 offen
    v_lshlrev_b32 v160, 16, v162
    v_and_b32 v161, 0xffff0000, v162
    v_mfma_f32_32x32x16_bf16 v[128:143], v[204:207], a[188:191], v[128:143]
    v_add_f32 v161, 0x3727c5ac, v161
    v_cvt_pk_bf16_f32 v162, v161, v161
    v_lshlrev_b32 v161, 16, v162
    ds_read_b128 v[196:199], v13 offset:25600
    s_waitcnt lgkmcnt(5)
    v_mfma_f32_32x32x16_bf16 v[48:63], v[176:179], a[192:195], v[48:63]
    s_add_u32 s48, s30, 70656
    buffer_load_dwordx4 v[28:31], v1, s[8:11], s48 offen
    v_sqrt_f32 v161, v161
    v_mfma_f32_32x32x16_bf16 v[64:79], v[176:179], a[196:199], v[64:79]
    v_sub_f32 v5, 0, v160
    v_cvt_pk_bf16_f32 v162, v161, v161
    v_lshlrev_b32 v161, 16, v162
    ds_read_b128 v[200:203], v11 offset:26624
    s_waitcnt lgkmcnt(5)
    v_mfma_f32_32x32x16_bf16 v[80:95], v[180:183], a[192:195], v[80:95]
    s_add_u32 s49, s31, 69632
    s_add_u32 m0, s32, 69632
    s_nop 0
    buffer_load_dwordx4 v1, s[12:15], s49 offen lds
    v_mul_f32 v9, v161, v161
    v_mfma_f32_32x32x16_bf16 v[96:111], v[180:183], a[196:199], v[96:111]
    v_rcp_f32 v161, v161
    s_nop 0
    ds_read_b128 v[204:207], v12 offset:26624
    s_waitcnt lgkmcnt(5)
    v_mfma_f32_32x32x16_bf16 v[112:127], v[184:187], a[192:195], v[112:127]
    s_add_u32 s50, s30, 34816
    buffer_load_dwordx4 v[32:35], v1, s[8:11], s50 offen
    v_mul_f32 v7, 0xbfb8aa3b, v161
    v_mfma_f32_32x32x16_bf16 v[128:143], v[184:187], a[196:199], v[128:143]
    ds_read_b128 v[176:179], v13 offset:26624
    s_waitcnt lgkmcnt(5)
    v_mfma_f32_32x32x16_bf16 v[48:63], v[188:191], a[200:203], v[48:63]
    s_add_u32 s51, s30, 71680
    buffer_load_dwordx4 v[36:39], v1, s[8:11], s51 offen
    v_mfma_f32_32x32x16_bf16 v[64:79], v[188:191], a[204:207], v[64:79]
    ds_read_b128 v[180:183], v11 offset:27648
    s_waitcnt lgkmcnt(5)
    v_mfma_f32_32x32x16_bf16 v[80:95], v[192:195], a[200:203], v[80:95]
    s_add_u32 s48, s31, 106496
    s_add_u32 m0, s32, 106496
    s_nop 0
    buffer_load_dwordx4 v1, s[12:15], s48 offen lds
    v_mfma_f32_32x32x16_bf16 v[96:111], v[192:195], a[204:207], v[96:111]
    ds_read_b128 v[184:187], v12 offset:27648
    s_waitcnt lgkmcnt(5)
    v_mfma_f32_32x32x16_bf16 v[112:127], v[196:199], a[200:203], v[112:127]
    s_add_u32 s49, s30, 35840
    buffer_load_dwordx4 v[40:43], v1, s[8:11], s49 offen
    v_mfma_f32_32x32x16_bf16 v[128:143], v[196:199], a[204:207], v[128:143]
    s_waitcnt vmcnt(12)
    s_barrier
    ds_read_b128 v[188:191], v13 offset:27648
    s_waitcnt lgkmcnt(5)
    v_mfma_f32_32x32x16_bf16 v[48:63], v[200:203], a[208:211], v[48:63]
    s_add_u32 s50, s30, 72704
    buffer_load_dwordx4 v[44:47], v1, s[8:11], s50 offen
    v_mfma_f32_32x32x16_bf16 v[64:79], v[200:203], a[212:215], v[64:79]
    ds_read_b128 v[192:195], v11 offset:28672
    s_waitcnt lgkmcnt(5)
    v_mfma_f32_32x32x16_bf16 v[80:95], v[204:207], a[208:211], v[80:95]
    s_add_u32 s51, s31, 110592
    s_add_u32 m0, s32, 110592
    s_nop 0
    buffer_load_dwordx4 v1, s[12:15], s51 offen lds
    v_mfma_f32_32x32x16_bf16 v[96:111], v[204:207], a[212:215], v[96:111]
    ds_read_b128 v[196:199], v12 offset:28672
    s_waitcnt lgkmcnt(5)
    v_mfma_f32_32x32x16_bf16 v[112:127], v[176:179], a[208:211], v[112:127]
    s_add_u32 s48, s31, 114688
    s_add_u32 m0, s32, 114688
    s_nop 0
    buffer_load_dwordx4 v1, s[12:15], s48 offen lds
    v_mfma_f32_32x32x16_bf16 v[128:143], v[176:179], a[212:215], v[128:143]
    ds_read_b128 v[200:203], v13 offset:28672
    s_waitcnt lgkmcnt(5)
    v_mfma_f32_32x32x16_bf16 v[48:63], v[180:183], a[216:219], v[48:63]
    s_add_u32 s49, s31, 118784
    s_add_u32 m0, s32, 118784
    s_nop 0
    buffer_load_dwordx4 v1, s[12:15], s49 offen lds
    v_mfma_f32_32x32x16_bf16 v[64:79], v[180:183], a[220:223], v[64:79]
    ds_read_b128 v[204:207], v11 offset:29696
    s_waitcnt lgkmcnt(5)
    v_mfma_f32_32x32x16_bf16 v[80:95], v[184:187], a[216:219], v[80:95]
    s_add_u32 s50, s31, 122880
    s_add_u32 m0, s32, 122880
    s_nop 0
    buffer_load_dwordx4 v1, s[12:15], s50 offen lds
    v_mfma_f32_32x32x16_bf16 v[96:111], v[184:187], a[220:223], v[96:111]
    ds_read_b128 v[176:179], v12 offset:29696
    s_waitcnt lgkmcnt(5)
    v_mfma_f32_32x32x16_bf16 v[112:127], v[188:191], a[216:219], v[112:127]
    s_add_u32 s51, s31, 126976
    s_add_u32 m0, s32, 126976
    s_nop 0
    buffer_load_dwordx4 v1, s[12:15], s51 offen lds
    v_mfma_f32_32x32x16_bf16 v[128:143], v[188:191], a[220:223], v[128:143]
    ds_read_b128 v[180:183], v13 offset:29696
    s_waitcnt lgkmcnt(5)
    v_mfma_f32_32x32x16_bf16 v[48:63], v[192:195], a[224:227], v[48:63]
    s_add_u32 s48, s31, 131072
    s_add_u32 m0, s32, 131072
    s_nop 0
    buffer_load_dwordx4 v1, s[12:15], s48 offen lds
    v_mfma_f32_32x32x16_bf16 v[64:79], v[192:195], a[228:231], v[64:79]
    ds_read_b128 v[184:187], v11 offset:30720
    s_waitcnt lgkmcnt(5)
    v_mfma_f32_32x32x16_bf16 v[80:95], v[196:199], a[224:227], v[80:95]
    s_add_u32 s49, s31, 135168
    s_add_u32 m0, s32, 135168
    s_nop 0
    buffer_load_dwordx4 v1, s[12:15], s49 offen lds
    v_mfma_f32_32x32x16_bf16 v[96:111], v[196:199], a[228:231], v[96:111]
    ds_read_b128 v[188:191], v12 offset:30720
    s_waitcnt lgkmcnt(5)
    v_mfma_f32_32x32x16_bf16 v[112:127], v[200:203], a[224:227], v[112:127]
    s_add_u32 s50, s31, 139264
    s_add_u32 m0, s32, 139264
    s_nop 0
    buffer_load_dwordx4 v1, s[12:15], s50 offen lds
    v_mfma_f32_32x32x16_bf16 v[128:143], v[200:203], a[228:231], v[128:143]
    ds_read_b128 v[192:195], v13 offset:30720
    s_waitcnt lgkmcnt(5)
    v_mfma_f32_32x32x16_bf16 v[48:63], v[204:207], a[232:235], v[48:63]
    s_add_u32 s51, s31, 143360
    s_add_u32 m0, s32, 143360
    s_nop 0
    buffer_load_dwordx4 v1, s[12:15], s51 offen lds
    v_mfma_f32_32x32x16_bf16 v[64:79], v[204:207], a[236:239], v[64:79]
    ds_read_b128 v[196:199], v11 offset:31744
    s_waitcnt lgkmcnt(5)
    v_mfma_f32_32x32x16_bf16 v[80:95], v[176:179], a[232:235], v[80:95]
    s_add_u32 s48, s31, 147456
    s_add_u32 m0, s32, 0
    s_nop 0
    buffer_load_dwordx4 v1, s[12:15], s48 offen lds
    v_mfma_f32_32x32x16_bf16 v[96:111], v[176:179], a[236:239], v[96:111]
    ds_read_b128 v[200:203], v12 offset:31744
    s_waitcnt lgkmcnt(5)
    v_mfma_f32_32x32x16_bf16 v[112:127], v[180:183], a[232:235], v[112:127]
    s_add_u32 s49, s31, 151552
    s_add_u32 m0, s32, 4096
    s_nop 0
    buffer_load_dwordx4 v1, s[12:15], s49 offen lds
    v_mfma_f32_32x32x16_bf16 v[128:143], v[180:183], a[236:239], v[128:143]
    s_waitcnt vmcnt(13)
    s_barrier
    ds_read_b128 v[204:207], v13 offset:31744
    s_waitcnt lgkmcnt(5)
    v_mfma_f32_32x32x16_bf16 v[48:63], v[184:187], a[240:243], v[48:63]
    s_add_u32 s50, s31, 155648
    s_add_u32 m0, s32, 8192
    s_nop 0
    buffer_load_dwordx4 v1, s[12:15], s50 offen lds
    v_mfma_f32_32x32x16_bf16 v[64:79], v[184:187], a[244:247], v[64:79]
    ds_read_b128 v[176:179], v11 offset:32768
    s_waitcnt lgkmcnt(5)
    v_mfma_f32_32x32x16_bf16 v[80:95], v[188:191], a[240:243], v[80:95]
    s_add_u32 s51, s31, 159744
    s_add_u32 m0, s32, 12288
    s_nop 0
    buffer_load_dwordx4 v1, s[12:15], s51 offen lds
    v_mfma_f32_32x32x16_bf16 v[96:111], v[188:191], a[244:247], v[96:111]
    ds_read_b128 v[180:183], v12 offset:32768
    s_waitcnt lgkmcnt(5)
    v_mfma_f32_32x32x16_bf16 v[112:127], v[192:195], a[240:243], v[112:127]
    s_add_u32 s48, s31, 163840
    s_add_u32 m0, s32, 16384
    s_nop 0
    buffer_load_dwordx4 v1, s[12:15], s48 offen lds
    v_mfma_f32_32x32x16_bf16 v[128:143], v[192:195], a[244:247], v[128:143]
    ds_read_b128 v[184:187], v13 offset:32768
    s_waitcnt lgkmcnt(5)
    v_mfma_f32_32x32x16_bf16 v[48:63], v[196:199], a[248:251], v[48:63]
    s_add_u32 s49, s31, 167936
    s_add_u32 m0, s32, 20480
    s_nop 0
    buffer_load_dwordx4 v1, s[12:15], s49 offen lds
    v_mfma_f32_32x32x16_bf16 v[64:79], v[196:199], a[252:255], v[64:79]
    ds_read_b128 v[188:191], v11 offset:33792
    s_waitcnt lgkmcnt(5)
    v_mfma_f32_32x32x16_bf16 v[80:95], v[200:203], a[248:251], v[80:95]
    s_add_u32 s50, s31, 172032
    s_add_u32 m0, s32, 24576
    s_nop 0
    buffer_load_dwordx4 v1, s[12:15], s50 offen lds
    v_mfma_f32_32x32x16_bf16 v[96:111], v[200:203], a[252:255], v[96:111]
    ds_read_b128 v[192:195], v12 offset:33792
    s_waitcnt lgkmcnt(5)
    v_mfma_f32_32x32x16_bf16 v[112:127], v[204:207], a[248:251], v[112:127]
    v_mfma_f32_32x32x16_bf16 v[128:143], v[204:207], a[252:255], v[128:143]
    ds_read_b128 v[196:199], v13 offset:33792
    s_waitcnt lgkmcnt(5)
    v_mfma_f32_32x32x16_bf16 v[48:63], v[176:179], v[16:19], v[48:63]
    v_mfma_f32_32x32x16_bf16 v[64:79], v[176:179], v[20:23], v[64:79]
    ds_read_b128 v[200:203], v11 offset:34816
    s_waitcnt lgkmcnt(5)
    v_mfma_f32_32x32x16_bf16 v[80:95], v[180:183], v[16:19], v[80:95]
    v_mfma_f32_32x32x16_bf16 v[96:111], v[180:183], v[20:23], v[96:111]
    ds_read_b128 v[204:207], v12 offset:34816
    s_waitcnt lgkmcnt(5)
    v_mfma_f32_32x32x16_bf16 v[112:127], v[184:187], v[16:19], v[112:127]
    v_mfma_f32_32x32x16_bf16 v[128:143], v[184:187], v[20:23], v[128:143]
    ds_read_b128 v[176:179], v13 offset:34816
    s_waitcnt lgkmcnt(5)
    v_mfma_f32_32x32x16_bf16 v[48:63], v[188:191], v[24:27], v[48:63]
    v_mfma_f32_32x32x16_bf16 v[64:79], v[188:191], v[28:31], v[64:79]
    ds_read_b128 v[180:183], v11 offset:35840
    s_waitcnt lgkmcnt(5)
    v_mfma_f32_32x32x16_bf16 v[80:95], v[192:195], v[24:27], v[80:95]
    v_mfma_f32_32x32x16_bf16 v[96:111], v[192:195], v[28:31], v[96:111]
    ds_read_b128 v[184:187], v12 offset:35840
    s_waitcnt lgkmcnt(5)
    v_mfma_f32_32x32x16_bf16 v[112:127], v[196:199], v[24:27], v[112:127]
    v_mfma_f32_32x32x16_bf16 v[128:143], v[196:199], v[28:31], v[128:143]
    s_waitcnt vmcnt(13)
    s_barrier
    ds_read_b128 v[188:191], v13 offset:35840
    s_waitcnt lgkmcnt(5)
    v_mfma_f32_32x32x16_bf16 v[48:63], v[200:203], v[32:35], v[48:63]
    s_add_u32 s51, s31, 176128
    s_add_u32 m0, s32, 28672
    s_nop 0
    buffer_load_dwordx4 v1, s[12:15], s51 offen lds
    v_mfma_f32_32x32x16_bf16 v[64:79], v[200:203], v[36:39], v[64:79]
    ds_read_b128 v[192:195], v14 offset:0
    s_waitcnt lgkmcnt(5)
    v_mfma_f32_32x32x16_bf16 v[80:95], v[204:207], v[32:35], v[80:95]
    v_mfma_f32_32x32x16_bf16 v[96:111], v[204:207], v[36:39], v[96:111]
    ds_read_b128 v[196:199], v14 offset:1024
    s_waitcnt lgkmcnt(5)
    v_mfma_f32_32x32x16_bf16 v[112:127], v[176:179], v[32:35], v[112:127]
    v_mfma_f32_32x32x16_bf16 v[128:143], v[176:179], v[36:39], v[128:143]
    ds_read_b128 v[200:203], v14 offset:2048
    s_waitcnt lgkmcnt(5)
    v_mfma_f32_32x32x16_bf16 v[48:63], v[180:183], v[40:43], v[48:63]
    v_mfma_f32_32x32x16_bf16 v[64:79], v[180:183], v[44:47], v[64:79]
    ds_read_b128 v[204:207], v14 offset:3072
    s_waitcnt lgkmcnt(5)
    v_mfma_f32_32x32x16_bf16 v[80:95], v[184:187], v[40:43], v[80:95]
    v_mfma_f32_32x32x16_bf16 v[96:111], v[184:187], v[44:47], v[96:111]
    ds_read_b128 v[176:179], v14 offset:4096
    s_waitcnt lgkmcnt(5)
    v_mfma_f32_32x32x16_bf16 v[112:127], v[188:191], v[40:43], v[112:127]
    v_mfma_f32_32x32x16_bf16 v[128:143], v[188:191], v[44:47], v[128:143]
    ds_read_b128 v[180:183], v14 offset:5120
    s_waitcnt lgkmcnt(5)
    v_mfma_f32_32x32x16_bf16 v[144:159], v[192:195], a[0:3], 0
    v_mfma_f32_32x32x16_bf16 v[160:175], v[192:195], a[4:7], 0
    ds_read_b128 v[184:187], v14 offset:6144
    s_waitcnt lgkmcnt(5)
    v_mfma_f32_32x32x16_bf16 v[144:159], v[196:199], a[8:11], v[144:159]
    v_mfma_f32_32x32x16_bf16 v[160:175], v[196:199], a[12:15], v[160:175]
    ds_read_b128 v[188:191], v14 offset:7168
    s_waitcnt lgkmcnt(5)
    v_mfma_f32_32x32x16_bf16 v[144:159], v[200:203], a[16:19], v[144:159]
    ds_read_b128 v[208:211], v10 offset:0
    ds_read_b128 v[212:215], v10 offset:16
    ds_read_b128 v[216:219], v10 offset:32
    ds_read_b128 v[220:223], v10 offset:48
    v_mfma_f32_32x32x16_bf16 v[160:175], v[200:203], a[20:23], v[160:175]
    s_waitcnt lgkmcnt(0)
    v_fmac_f32 v48, v208, v4
    v_fmac_f32 v49, v209, v4
    ds_read_b128 v[192:195], v14 offset:8192
    v_mfma_f32_32x32x16_bf16 v[144:159], v[204:207], a[24:27], v[144:159]
    v_fmac_f32 v50, v210, v4
    v_fmac_f32 v51, v211, v4
    v_mul_f32 v224, v48, v6
    v_mul_f32 v225, v49, v6
    v_mfma_f32_32x32x16_bf16 v[160:175], v[204:207], a[28:31], v[160:175]
    v_mul_f32 v226, v50, v6
    v_mul_f32 v227, v51, v6
    v_fmac_f32 v56, v216, v4
    ds_read_b128 v[196:199], v14 offset:9216
    v_mfma_f32_32x32x16_bf16 v[144:159], v[176:179], a[32:35], v[144:159]
    v_fmac_f32 v57, v217, v4
    v_fmac_f32 v58, v218, v4
    v_fmac_f32 v59, v219, v4
    v_mfma_f32_32x32x16_bf16 v[160:175], v[176:179], a[36:39], v[160:175]
    v_exp_f32 v224, v224
    ds_read_b128 v[200:203], v14 offset:10240
    v_mfma_f32_32x32x16_bf16 v[144:159], v[180:183], a[40:43], v[144:159]
    v_exp_f32 v225, v225
    v_exp_f32 v226, v226
    v_mfma_f32_32x32x16_bf16 v[160:175], v[180:183], a[44:47], v[160:175]
    v_exp_f32 v227, v227
    v_mul_f32 v48, v48, v56
    s_waitcnt vmcnt(9)
    s_barrier
    ds_read_b128 v[204:207], v14 offset:11264
    v_mfma_f32_32x32x16_bf16 v[144:159], v[184:187], a[48:51], v[144:159]
    s_add_u32 s48, s31, 180224
    s_add_u32 m0, s32, 32768
    s_nop 0
    buffer_load_dwordx4 v1, s[12:15], s48 offen lds
    v_mul_f32 v49, v49, v57
    v_mul_f32 v50, v50, v58
    v_mfma_f32_32x32x16_bf16 v[160:175], v[184:187], a[52:55], v[160:175]
    v_mul_f32 v51, v51, v59
    v_fma_f32 v224, v224, v8, v8
    v_fma_f32 v225, v225, v8, v8
    ds_read_b128 v[176:179], v14 offset:12288
    v_mfma_f32_32x32x16_bf16 v[144:159], v[188:191], a[56:59], v[144:159]
    s_add_u32 s49, s31, 184320
    s_add_u32 m0, s32, 36864
    s_nop 0
    buffer_load_dwordx4 v1, s[12:15], s49 offen lds
    v_fma_f32 v226, v226, v8, v8
    v_fma_f32 v227, v227, v8, v8
    v_mfma_f32_32x32x16_bf16 v[160:175], v[188:191], a[60:63], v[160:175]
    v_rcp_f32 v224, v224
    ds_read_b128 v[180:183], v14 offset:13312
    s_waitcnt lgkmcnt(5)
    v_mfma_f32_32x32x16_bf16 v[144:159], v[192:195], a[64:67], v[144:159]
    s_add_u32 s50, s31, 188416
    s_add_u32 m0, s32, 40960
    s_nop 0
    buffer_load_dwordx4 v1, s[12:15], s50 offen lds
    v_rcp_f32 v225, v225
    v_mfma_f32_32x32x16_bf16 v[160:175], v[192:195], a[68:71], v[160:175]
    v_rcp_f32 v226, v226
    ds_read_b128 v[184:187], v14 offset:14336
    s_waitcnt lgkmcnt(5)
    v_mfma_f32_32x32x16_bf16 v[144:159], v[196:199], a[72:75], v[144:159]
    s_add_u32 s51, s31, 192512
    s_add_u32 m0, s32, 45056
    s_nop 0
    buffer_load_dwordx4 v1, s[12:15], s51 offen lds
    v_rcp_f32 v227, v227
    v_mfma_f32_32x32x16_bf16 v[160:175], v[196:199], a[76:79], v[160:175]
    v_mul_f32 v48, v48, v224
    v_mul_f32 v49, v49, v225
    v_mul_f32 v50, v50, v226
    ds_read_b128 v[188:191], v14 offset:15360
    s_waitcnt lgkmcnt(5)
    v_mfma_f32_32x32x16_bf16 v[144:159], v[200:203], a[80:83], v[144:159]
    s_add_u32 s48, s31, 196608
    s_add_u32 m0, s32, 49152
    s_nop 0
    buffer_load_dwordx4 v1, s[12:15], s48 offen lds
    v_mul_f32 v51, v51, v227
    v_fmac_f32 v52, v212, v4
    v_mfma_f32_32x32x16_bf16 v[160:175], v[200:203], a[84:87], v[160:175]
    v_fmac_f32 v53, v213, v4
    v_fmac_f32 v54, v214, v4
    v_fmac_f32 v55, v215, v4
    ds_read_b128 v[192:195], v14 offset:16384
    s_waitcnt lgkmcnt(5)
    v_mfma_f32_32x32x16_bf16 v[144:159], v[204:207], a[88:91], v[144:159]
    s_add_u32 s49, s31, 200704
    s_add_u32 m0, s32, 53248
    s_nop 0
    buffer_load_dwordx4 v1, s[12:15], s49 offen lds
    v_mul_f32 v228, v52, v6
    v_mul_f32 v229, v53, v6
    v_mfma_f32_32x32x16_bf16 v[160:175], v[204:207], a[92:95], v[160:175]
    v_mul_f32 v230, v54, v6
    v_mul_f32 v231, v55, v6
    v_fmac_f32 v60, v220, v4
    ds_read_b128 v[196:199], v14 offset:17408
    s_waitcnt lgkmcnt(5)
    v_mfma_f32_32x32x16_bf16 v[144:159], v[176:179], a[96:99], v[144:159]
    s_add_u32 s50, s31, 204800
    s_add_u32 m0, s32, 57344
    s_nop 0
    buffer_load_dwordx4 v1, s[12:15], s50 offen lds
    v_fmac_f32 v61, v221, v4
    v_fmac_f32 v62, v222, v4
    v_mfma_f32_32x32x16_bf16 v[160:175], v[176:179], a[100:103], v[160:175]
    v_fmac_f32 v63, v223, v4
    v_exp_f32 v228, v228
    ds_read_b128 v[200:203], v14 offset:18432
    s_waitcnt lgkmcnt(5)
    v_mfma_f32_32x32x16_bf16 v[144:159], v[180:183], a[104:107], v[144:159]
    s_add_u32 s51, s31, 208896
    s_add_u32 m0, s32, 61440
    s_nop 0
    buffer_load_dwordx4 v1, s[12:15], s51 offen lds
    v_exp_f32 v229, v229
    v_mfma_f32_32x32x16_bf16 v[160:175], v[180:183], a[108:111], v[160:175]
    v_exp_f32 v230, v230
    ds_read_b128 v[204:207], v14 offset:19456
    s_waitcnt lgkmcnt(5)
    v_mfma_f32_32x32x16_bf16 v[144:159], v[184:187], a[112:115], v[144:159]
    s_add_u32 s48, s31, 212992
    s_add_u32 m0, s32, 65536
    s_nop 0
    buffer_load_dwordx4 v1, s[12:15], s48 offen lds
    v_exp_f32 v231, v231
    v_mfma_f32_32x32x16_bf16 v[160:175], v[184:187], a[116:119], v[160:175]
    v_mul_f32 v52, v52, v60
    v_mul_f32 v53, v53, v61
    v_mul_f32 v54, v54, v62
    ds_read_b128 v[176:179], v14 offset:20480
    s_waitcnt lgkmcnt(5)
    v_mfma_f32_32x32x16_bf16 v[144:159], v[188:191], a[120:123], v[144:159]
    s_add_u32 s49, s31, 217088
    s_add_u32 m0, s32, 69632
    s_nop 0
    buffer_load_dwordx4 v1, s[12:15], s49 offen lds
    v_mul_f32 v55, v55, v63
    v_fma_f32 v228, v228, v8, v8
    v_mfma_f32_32x32x16_bf16 v[160:175], v[188:191], a[124:127], v[160:175]
    v_fma_f32 v229, v229, v8, v8
    v_fma_f32 v230, v230, v8, v8
    v_fma_f32 v231, v231, v8, v8
    ds_read_b128 v[180:183], v14 offset:21504
    s_waitcnt lgkmcnt(5)
    v_mfma_f32_32x32x16_bf16 v[144:159], v[192:195], a[128:131], v[144:159]
    s_add_u32 s50, s31, 221184
    s_add_u32 m0, s32, 73728
    s_nop 0
    buffer_load_dwordx4 v1, s[12:15], s50 offen lds
    v_rcp_f32 v228, v228
    v_mfma_f32_32x32x16_bf16 v[160:175], v[192:195], a[132:135], v[160:175]
    v_rcp_f32 v229, v229
    ds_read_b128 v[184:187], v14 offset:22528
    s_waitcnt lgkmcnt(5)
    v_mfma_f32_32x32x16_bf16 v[144:159], v[196:199], a[136:139], v[144:159]
    s_add_u32 s51, s31, 225280
    s_add_u32 m0, s32, 77824
    s_nop 0
    buffer_load_dwordx4 v1, s[12:15], s51 offen lds
    v_rcp_f32 v230, v230
    v_mfma_f32_32x32x16_bf16 v[160:175], v[196:199], a[140:143], v[160:175]
    v_rcp_f32 v231, v231
    v_mul_f32 v52, v52, v228
    ds_read_b128 v[188:191], v14 offset:23552
    s_waitcnt lgkmcnt(5)
    v_mfma_f32_32x32x16_bf16 v[144:159], v[200:203], a[144:147], v[144:159]
    s_add_u32 s48, s31, 229376
    s_add_u32 m0, s32, 81920
    s_nop 0
    buffer_load_dwordx4 v1, s[12:15], s48 offen lds
    v_mul_f32 v53, v53, v229
    v_mul_f32 v54, v54, v230
    v_mfma_f32_32x32x16_bf16 v[160:175], v[200:203], a[148:151], v[160:175]
    v_mul_f32 v55, v55, v231
    v_cvt_pk_bf16_f32 v232, v48, v49
    v_cvt_pk_bf16_f32 v233, v50, v51
    ds_read_b128 v[192:195], v14 offset:24576
    s_waitcnt lgkmcnt(5)
    v_mfma_f32_32x32x16_bf16 v[144:159], v[204:207], a[152:155], v[144:159]
    s_add_u32 s49, s31, 233472
    s_add_u32 m0, s32, 86016
    s_nop 0
    buffer_load_dwordx4 v1, s[12:15], s49 offen lds
    v_cvt_pk_bf16_f32 v234, v52, v53
    v_cvt_pk_bf16_f32 v235, v54, v55
    v_mfma_f32_32x32x16_bf16 v[160:175], v[204:207], a[156:159], v[160:175]
    s_add_u32 s52, s33, 0
    buffer_store_dwordx4 v[232:235], v2, s[16:19], s52 offen sc1
    v_fmac_f32 v64, v208, v5
    ds_read_b128 v[196:199], v14 offset:25600
    s_waitcnt lgkmcnt(5)
    v_mfma_f32_32x32x16_bf16 v[144:159], v[176:179], a[160:163], v[144:159]
    s_add_u32 s50, s31, 237568
    s_add_u32 m0, s32, 90112
    s_nop 0
    buffer_load_dwordx4 v1, s[12:15], s50 offen lds
    v_fmac_f32 v65, v209, v5
    v_fmac_f32 v66, v210, v5
    v_mfma_f32_32x32x16_bf16 v[160:175], v[176:179], a[164:167], v[160:175]
    v_fmac_f32 v67, v211, v5
    v_mul_f32 v224, v64, v7
    v_mul_f32 v225, v65, v7
    ds_read_b128 v[200:203], v14 offset:26624
    s_waitcnt lgkmcnt(5)
    v_mfma_f32_32x32x16_bf16 v[144:159], v[180:183], a[168:171], v[144:159]
    s_add_u32 s51, s31, 241664
    s_add_u32 m0, s32, 94208
    s_nop 0
    buffer_load_dwordx4 v1, s[12:15], s51 offen lds
    v_mul_f32 v226, v66, v7
    v_mul_f32 v227, v67, v7
    v_mfma_f32_32x32x16_bf16 v[160:175], v[180:183], a[172:175], v[160:175]
    v_fmac_f32 v72, v216, v5
    v_fmac_f32 v73, v217, v5
    v_fmac_f32 v74, v218, v5
    ds_read_b128 v[204:207], v14 offset:27648
    s_waitcnt lgkmcnt(5)
    v_mfma_f32_32x32x16_bf16 v[144:159], v[184:187], a[176:179], v[144:159]
    s_add_u32 s48, s31, 245760
    s_add_u32 m0, s32, 98304
    s_nop 0
    buffer_load_dwordx4 v1, s[12:15], s48 offen lds
    v_fmac_f32 v75, v219, v5
    v_mfma_f32_32x32x16_bf16 v[160:175], v[184:187], a[180:183], v[160:175]
    v_exp_f32 v224, v224
    ds_read_b128 v[176:179], v14 offset:28672
    s_waitcnt lgkmcnt(5)
    v_mfma_f32_32x32x16_bf16 v[144:159], v[188:191], a[184:187], v[144:159]
    s_add_u32 s49, s31, 249856
    s_add_u32 m0, s32, 102400
    s_nop 0
    buffer_load_dwordx4 v1, s[12:15], s49 offen lds
    v_exp_f32 v225, v225
    v_mfma_f32_32x32x16_bf16 v[160:175], v[188:191], a[188:191], v[160:175]
    v_exp_f32 v226, v226
    s_waitcnt vmcnt(24)
    s_barrier
    ds_read_b128 v[180:183], v14 offset:29696
    s_waitcnt lgkmcnt(5)
    v_mfma_f32_32x32x16_bf16 v[144:159], v[192:195], a[192:195], v[144:159]
    s_add_u32 s50, s31, 253952
    s_add_u32 m0, s32, 106496
    s_nop 0
    buffer_load_dwordx4 v1, s[12:15], s50 offen lds
    v_exp_f32 v227, v227
    v_mfma_f32_32x32x16_bf16 v[160:175], v[192:195], a[196:199], v[160:175]
    v_mul_f32 v64, v64, v72
    v_mul_f32 v65, v65, v73
    v_mul_f32 v66, v66, v74
    ds_read_b128 v[184:187], v14 offset:30720
    s_waitcnt lgkmcnt(5)
    v_mfma_f32_32x32x16_bf16 v[144:159], v[196:199], a[200:203], v[144:159]
    s_add_u32 s51, s31, 258048
    s_add_u32 m0, s32, 110592
    s_nop 0
    buffer_load_dwordx4 v1, s[12:15], s51 offen lds
    v_mul_f32 v67, v67, v75
    v_fma_f32 v224, v224, v9, v9
    v_mfma_f32_32x32x16_bf16 v[160:175], v[196:199], a[204:207], v[160:175]
    v_fma_f32 v225, v225, v9, v9
    v_fma_f32 v226, v226, v9, v9
    v_fma_f32 v227, v227, v9, v9
    ds_read_b128 v[188:191], v14 offset:31744
    s_waitcnt lgkmcnt(5)
    v_mfma_f32_32x32x16_bf16 v[144:159], v[200:203], a[208:211], v[144:159]
    s_add_u32 s48, s31, 262144
    s_add_u32 m0, s32, 114688
    s_nop 0
    buffer_load_dwordx4 v1, s[12:15], s48 offen lds
    v_rcp_f32 v224, v224
    v_mfma_f32_32x32x16_bf16 v[160:175], v[200:203], a[212:215], v[160:175]
    v_rcp_f32 v225, v225
    ds_read_b128 v[192:195], v14 offset:32768
    s_waitcnt lgkmcnt(5)
    v_mfma_f32_32x32x16_bf16 v[144:159], v[204:207], a[216:219], v[144:159]
    s_add_u32 s49, s31, 266240
    s_add_u32 m0, s32, 118784
    s_nop 0
    buffer_load_dwordx4 v1, s[12:15], s49 offen lds
    v_rcp_f32 v226, v226
    v_mfma_f32_32x32x16_bf16 v[160:175], v[204:207], a[220:223], v[160:175]
    v_rcp_f32 v227, v227
    v_mul_f32 v64, v64, v224
    ds_read_b128 v[196:199], v14 offset:33792
    s_waitcnt lgkmcnt(5)
    v_mfma_f32_32x32x16_bf16 v[144:159], v[176:179], a[224:227], v[144:159]
    s_add_u32 s50, s31, 270336
    s_add_u32 m0, s32, 122880
    s_nop 0
    buffer_load_dwordx4 v1, s[12:15], s50 offen lds
    v_mul_f32 v65, v65, v225
    v_mul_f32 v66, v66, v226
    v_mfma_f32_32x32x16_bf16 v[160:175], v[176:179], a[228:231], v[160:175]
    v_mul_f32 v67, v67, v227
    v_fmac_f32 v68, v212, v5
    v_fmac_f32 v69, v213, v5
    ds_read_b128 v[200:203], v14 offset:34816
    s_waitcnt lgkmcnt(5)
    v_mfma_f32_32x32x16_bf16 v[144:159], v[180:183], a[232:235], v[144:159]
    s_add_u32 s51, s31, 274432
    s_add_u32 m0, s32, 126976
    s_nop 0
    buffer_load_dwordx4 v1, s[12:15], s51 offen lds
    v_fmac_f32 v70, v214, v5
    v_fmac_f32 v71, v215, v5
    v_mfma_f32_32x32x16_bf16 v[160:175], v[180:183], a[236:239], v[160:175]
    v_mul_f32 v228, v68, v7
    v_mul_f32 v229, v69, v7
    v_mul_f32 v230, v70, v7
    ds_read_b128 v[204:207], v14 offset:35840
    s_waitcnt lgkmcnt(5)
    v_mfma_f32_32x32x16_bf16 v[144:159], v[184:187], a[240:243], v[144:159]
    s_add_u32 s48, s31, 278528
    s_add_u32 m0, s32, 131072
    s_nop 0
    buffer_load_dwordx4 v1, s[12:15], s48 offen lds
    v_mul_f32 v231, v71, v7
    v_fmac_f32 v76, v220, v5
    v_mfma_f32_32x32x16_bf16 v[160:175], v[184:187], a[244:247], v[160:175]
    v_fmac_f32 v77, v221, v5
    v_fmac_f32 v78, v222, v5
    v_fmac_f32 v79, v223, v5
    ds_read_b128 v[176:179], v11 offset:0
    s_waitcnt lgkmcnt(5)
    v_mfma_f32_32x32x16_bf16 v[144:159], v[188:191], a[248:251], v[144:159]
    v_exp_f32 v228, v228
    v_exp_f32 v229, v229
    v_mfma_f32_32x32x16_bf16 v[160:175], v[188:191], a[252:255], v[160:175]
    v_exp_f32 v230, v230
    ds_read_b128 v[180:183], v11 offset:1024
    s_waitcnt lgkmcnt(5)
    v_mfma_f32_32x32x16_bf16 v[144:159], v[192:195], v[16:19], v[144:159]
    v_exp_f32 v231, v231
    v_mul_f32 v68, v68, v76
    v_mul_f32 v69, v69, v77
    v_mfma_f32_32x32x16_bf16 v[160:175], v[192:195], v[20:23], v[160:175]
    v_mul_f32 v70, v70, v78
    v_mul_f32 v71, v71, v79
    v_fma_f32 v228, v228, v9, v9
    ds_read_b128 v[184:187], v11 offset:2048
    s_waitcnt lgkmcnt(5)
    v_mfma_f32_32x32x16_bf16 v[144:159], v[196:199], v[24:27], v[144:159]
    v_fma_f32 v229, v229, v9, v9
    v_fma_f32 v230, v230, v9, v9
    v_fma_f32 v231, v231, v9, v9
    v_mfma_f32_32x32x16_bf16 v[160:175], v[196:199], v[28:31], v[160:175]
    v_rcp_f32 v228, v228
    ds_read_b128 v[188:191], v11 offset:3072
    s_waitcnt lgkmcnt(5)
    v_mfma_f32_32x32x16_bf16 v[144:159], v[200:203], v[32:35], v[144:159]
    v_rcp_f32 v229, v229
    v_rcp_f32 v230, v230
    v_mfma_f32_32x32x16_bf16 v[160:175], v[200:203], v[36:39], v[160:175]
    v_rcp_f32 v231, v231
    v_mul_f32 v68, v68, v228
    ds_read_b128 v[192:195], v11 offset:4096
    s_waitcnt lgkmcnt(5)
    v_mfma_f32_32x32x16_bf16 v[144:159], v[204:207], v[40:43], v[144:159]
    v_mul_f32 v69, v69, v229
    v_mul_f32 v70, v70, v230
    v_mul_f32 v71, v71, v231
    v_cvt_pk_bf16_f32 v236, v64, v65
    v_mfma_f32_32x32x16_bf16 v[160:175], v[204:207], v[44:47], v[160:175]
    v_cvt_pk_bf16_f32 v237, v66, v67
    v_cvt_pk_bf16_f32 v238, v68, v69
    v_cvt_pk_bf16_f32 v239, v70, v71
    ds_read_b128 v[196:199], v11 offset:5120
    s_waitcnt lgkmcnt(5)
    s_add_u32 s53, s33, 294912
    buffer_store_dwordx4 v[236:239], v2, s[16:19], s53 offen sc1
    v_mfma_f32_32x32x16_bf16 v[48:63], v[176:179], a[0:3], 0
    ds_read_b128 v[208:211], v10 offset:128
    ds_read_b128 v[212:215], v10 offset:144
    ds_read_b128 v[216:219], v10 offset:160
    ds_read_b128 v[220:223], v10 offset:176
    v_mfma_f32_32x32x16_bf16 v[64:79], v[176:179], a[4:7], 0
    s_waitcnt lgkmcnt(0)
    v_fmac_f32 v80, v208, v4
    v_fmac_f32 v81, v209, v4
    ds_read_b128 v[200:203], v11 offset:6144
    v_mfma_f32_32x32x16_bf16 v[48:63], v[180:183], a[8:11], v[48:63]
    v_fmac_f32 v82, v210, v4
    v_fmac_f32 v83, v211, v4
    v_mul_f32 v224, v80, v6
    v_mul_f32 v225, v81, v6
    v_mfma_f32_32x32x16_bf16 v[64:79], v[180:183], a[12:15], v[64:79]
    v_mul_f32 v226, v82, v6
    v_mul_f32 v227, v83, v6
    v_fmac_f32 v88, v216, v4
    ds_read_b128 v[204:207], v11 offset:7168
    v_mfma_f32_32x32x16_bf16 v[48:63], v[184:187], a[16:19], v[48:63]
    v_fmac_f32 v89, v217, v4
    v_fmac_f32 v90, v218, v4
    v_fmac_f32 v91, v219, v4
    v_mfma_f32_32x32x16_bf16 v[64:79], v[184:187], a[20:23], v[64:79]
    v_exp_f32 v224, v224
    ds_read_b128 v[176:179], v11 offset:8192
    v_mfma_f32_32x32x16_bf16 v[48:63], v[188:191], a[24:27], v[48:63]
    v_exp_f32 v225, v225
    v_exp_f32 v226, v226
    v_mfma_f32_32x32x16_bf16 v[64:79], v[188:191], a[28:31], v[64:79]
    v_exp_f32 v227, v227
    v_mul_f32 v80, v80, v88
    ds_read_b128 v[180:183], v11 offset:9216
    v_mfma_f32_32x32x16_bf16 v[48:63], v[192:195], a[32:35], v[48:63]
    v_mul_f32 v81, v81, v89
    v_mul_f32 v82, v82, v90
    v_mul_f32 v83, v83, v91
    v_fma_f32 v224, v224, v8, v8
    v_mfma_f32_32x32x16_bf16 v[64:79], v[192:195], a[36:39], v[64:79]
    v_fma_f32 v225, v225, v8, v8
    v_fma_f32 v226, v226, v8, v8
    v_fma_f32 v227, v227, v8, v8
    ds_read_b128 v[184:187], v11 offset:10240
    v_mfma_f32_32x32x16_bf16 v[48:63], v[196:199], a[40:43], v[48:63]
    v_rcp_f32 v224, v224
    v_rcp_f32 v225, v225
    v_mfma_f32_32x32x16_bf16 v[64:79], v[196:199], a[44:47], v[64:79]
    v_rcp_f32 v226, v226
    s_waitcnt vmcnt(27)
    s_barrier
    ds_read_b128 v[188:191], v11 offset:11264
    s_waitcnt lgkmcnt(5)
    v_mfma_f32_32x32x16_bf16 v[48:63], v[200:203], a[48:51], v[48:63]
    s_add_u32 s49, s31, 282624
    s_add_u32 m0, s32, 135168
    s_nop 0
    buffer_load_dwordx4 v1, s[12:15], s49 offen lds
    v_rcp_f32 v227, v227
    v_mfma_f32_32x32x16_bf16 v[64:79], v[200:203], a[52:55], v[64:79]
    v_mul_f32 v80, v80, v224
    v_mul_f32 v81, v81, v225
    v_mul_f32 v82, v82, v226
    ds_read_b128 v[192:195], v11 offset:12288
    s_waitcnt lgkmcnt(5)
    v_mfma_f32_32x32x16_bf16 v[48:63], v[204:207], a[56:59], v[48:63]
    s_add_u32 s50, s31, 286720
    s_add_u32 m0, s32, 139264
    s_nop 0
    buffer_load_dwordx4 v1, s[12:15], s50 offen lds
    v_mul_f32 v83, v83, v227
    v_fmac_f32 v84, v212, v4
    v_mfma_f32_32x32x16_bf16 v[64:79], v[204:207], a[60:63], v[64:79]
    v_fmac_f32 v85, v213, v4
    v_fmac_f32 v86, v214, v4
    v_fmac_f32 v87, v215, v4
    ds_read_b128 v[196:199], v11 offset:13312
    s_waitcnt lgkmcnt(5)
    v_mfma_f32_32x32x16_bf16 v[48:63], v[176:179], a[64:67], v[48:63]
    s_add_u32 s51, s31, 290816
    s_add_u32 m0, s32, 143360
    s_nop 0
    buffer_load_dwordx4 v1, s[12:15], s51 offen lds
    v_mul_f32 v228, v84, v6
    v_mul_f32 v229, v85, v6
    v_mfma_f32_32x32x16_bf16 v[64:79], v[176:179], a[68:71], v[64:79]
    v_mul_f32 v230, v86, v6
    v_mul_f32 v231, v87, v6
    v_fmac_f32 v92, v220, v4
    ds_read_b128 v[200:203], v11 offset:14336
    s_waitcnt lgkmcnt(5)
    v_mfma_f32_32x32x16_bf16 v[48:63], v[180:183], a[72:75], v[48:63]
    s_add_u32 s48, s31, 294912
    s_add_u32 m0, s32, 0
    s_nop 0
    buffer_load_dwordx4 v1, s[12:15], s48 offen lds
    v_fmac_f32 v93, v221, v4
    v_fmac_f32 v94, v222, v4
    v_mfma_f32_32x32x16_bf16 v[64:79], v[180:183], a[76:79], v[64:79]
    v_fmac_f32 v95, v223, v4
    v_exp_f32 v228, v228
    ds_read_b128 v[204:207], v11 offset:15360
    s_waitcnt lgkmcnt(5)
    v_mfma_f32_32x32x16_bf16 v[48:63], v[184:187], a[80:83], v[48:63]
    v_exp_f32 v229, v229
    v_exp_f32 v230, v230
    v_mfma_f32_32x32x16_bf16 v[64:79], v[184:187], a[84:87], v[64:79]
    v_exp_f32 v231, v231
    v_mul_f32 v84, v84, v92
    ds_read_b128 v[176:179], v11 offset:16384
    s_waitcnt lgkmcnt(5)
    v_mfma_f32_32x32x16_bf16 v[48:63], v[188:191], a[88:91], v[48:63]
    v_mul_f32 v85, v85, v93
    v_mul_f32 v86, v86, v94
    v_mul_f32 v87, v87, v95
    v_fma_f32 v228, v228, v8, v8
    v_mfma_f32_32x32x16_bf16 v[64:79], v[188:191], a[92:95], v[64:79]
    v_fma_f32 v229, v229, v8, v8
    v_fma_f32 v230, v230, v8, v8
    v_fma_f32 v231, v231, v8, v8
    ds_read_b128 v[180:183], v11 offset:17408
    s_waitcnt lgkmcnt(5)
    v_mfma_f32_32x32x16_bf16 v[48:63], v[192:195], a[96:99], v[48:63]
    v_rcp_f32 v228, v228
    v_rcp_f32 v229, v229
    v_mfma_f32_32x32x16_bf16 v[64:79], v[192:195], a[100:103], v[64:79]
    v_rcp_f32 v230, v230
    ds_read_b128 v[184:187], v11 offset:18432
    s_waitcnt lgkmcnt(5)
    v_mfma_f32_32x32x16_bf16 v[48:63], v[196:199], a[104:107], v[48:63]
    v_rcp_f32 v231, v231
    v_mul_f32 v84, v84, v228
    v_mul_f32 v85, v85, v229
    v_mfma_f32_32x32x16_bf16 v[64:79], v[196:199], a[108:111], v[64:79]
    v_mul_f32 v86, v86, v230
    v_mul_f32 v87, v87, v231
    v_cvt_pk_bf16_f32 v232, v80, v81
    ds_read_b128 v[188:191], v11 offset:19456
    s_waitcnt lgkmcnt(5)
    v_mfma_f32_32x32x16_bf16 v[48:63], v[200:203], a[112:115], v[48:63]
    v_cvt_pk_bf16_f32 v233, v82, v83
    v_cvt_pk_bf16_f32 v234, v84, v85
    v_cvt_pk_bf16_f32 v235, v86, v87
    v_mfma_f32_32x32x16_bf16 v[64:79], v[200:203], a[116:119], v[64:79]
    s_add_u32 s52, s33, 512
    buffer_store_dwordx4 v[232:235], v2, s[16:19], s52 offen sc1
    v_fmac_f32 v96, v208, v5
    ds_read_b128 v[192:195], v11 offset:20480
    s_waitcnt lgkmcnt(5)
    v_mfma_f32_32x32x16_bf16 v[48:63], v[204:207], a[120:123], v[48:63]
    v_fmac_f32 v97, v209, v5
    v_fmac_f32 v98, v210, v5
    v_fmac_f32 v99, v211, v5
    v_mul_f32 v224, v96, v7
    v_mfma_f32_32x32x16_bf16 v[64:79], v[204:207], a[124:127], v[64:79]
    v_mul_f32 v225, v97, v7
    v_mul_f32 v226, v98, v7
    v_mul_f32 v227, v99, v7
    ds_read_b128 v[196:199], v11 offset:21504
    s_waitcnt lgkmcnt(5)
    v_mfma_f32_32x32x16_bf16 v[48:63], v[176:179], a[128:131], v[48:63]
    v_fmac_f32 v104, v216, v5
    v_fmac_f32 v105, v217, v5
    v_fmac_f32 v106, v218, v5
    v_fmac_f32 v107, v219, v5
    v_mfma_f32_32x32x16_bf16 v[64:79], v[176:179], a[132:135], v[64:79]
    v_exp_f32 v224, v224
    ds_read_b128 v[200:203], v11 offset:22528
    s_waitcnt lgkmcnt(5)
    v_mfma_f32_32x32x16_bf16 v[48:63], v[180:183], a[136:139], v[48:63]
    v_exp_f32 v225, v225
    v_exp_f32 v226, v226
    v_mfma_f32_32x32x16_bf16 v[64:79], v[180:183], a[140:143], v[64:79]
    v_exp_f32 v227, v227
    v_mul_f32 v96, v96, v104
    ds_read_b128 v[204:207], v11 offset:23552
    s_waitcnt lgkmcnt(5)
    v_mfma_f32_32x32x16_bf16 v[48:63], v[184:187], a[144:147], v[48:63]
    v_mul_f32 v97, v97, v105
    v_mul_f32 v98, v98, v106
    v_mul_f32 v99, v99, v107
    v_fma_f32 v224, v224, v9, v9
    v_mfma_f32_32x32x16_bf16 v[64:79], v[184:187], a[148:151], v[64:79]
    v_fma_f32 v225, v225, v9, v9
    v_fma_f32 v226, v226, v9, v9
    v_fma_f32 v227, v227, v9, v9
    ds_read_b128 v[176:179], v11 offset:24576
    s_waitcnt lgkmcnt(5)
    v_mfma_f32_32x32x16_bf16 v[48:63], v[188:191], a[152:155], v[48:63]
    v_rcp_f32 v224, v224
    v_rcp_f32 v225, v225
    v_mfma_f32_32x32x16_bf16 v[64:79], v[188:191], a[156:159], v[64:79]
    v_rcp_f32 v226, v226
    ds_read_b128 v[180:183], v11 offset:25600
    s_waitcnt lgkmcnt(5)
    v_mfma_f32_32x32x16_bf16 v[48:63], v[192:195], a[160:163], v[48:63]
    v_rcp_f32 v227, v227
    v_mul_f32 v96, v96, v224
    v_mul_f32 v97, v97, v225
    v_mfma_f32_32x32x16_bf16 v[64:79], v[192:195], a[164:167], v[64:79]
    v_mul_f32 v98, v98, v226
    v_mul_f32 v99, v99, v227
    v_fmac_f32 v100, v212, v5
    ds_read_b128 v[184:187], v11 offset:26624
    s_waitcnt lgkmcnt(5)
    v_mfma_f32_32x32x16_bf16 v[48:63], v[196:199], a[168:171], v[48:63]
    v_fmac_f32 v101, v213, v5
    v_fmac_f32 v102, v214, v5
    v_fmac_f32 v103, v215, v5
    v_mul_f32 v228, v100, v7
    v_mfma_f32_32x32x16_bf16 v[64:79], v[196:199], a[172:175], v[64:79]
    v_mul_f32 v229, v101, v7
    v_mul_f32 v230, v102, v7
    v_mul_f32 v231, v103, v7
    ds_read_b128 v[188:191], v11 offset:27648
    s_waitcnt lgkmcnt(5)
    v_mfma_f32_32x32x16_bf16 v[48:63], v[200:203], a[176:179], v[48:63]
    v_fmac_f32 v108, v220, v5
    v_fmac_f32 v109, v221, v5
    v_fmac_f32 v110, v222, v5
    v_fmac_f32 v111, v223, v5
    v_mfma_f32_32x32x16_bf16 v[64:79], v[200:203], a[180:183], v[64:79]
    v_exp_f32 v228, v228
    ds_read_b128 v[192:195], v11 offset:28672
    s_waitcnt lgkmcnt(5)
    v_mfma_f32_32x32x16_bf16 v[48:63], v[204:207], a[184:187], v[48:63]
    v_exp_f32 v229, v229
    v_exp_f32 v230, v230
    v_mfma_f32_32x32x16_bf16 v[64:79], v[204:207], a[188:191], v[64:79]
    v_exp_f32 v231, v231
    v_mul_f32 v100, v100, v108
    s_waitcnt vmcnt(28)
    s_barrier
    ds_read_b128 v[196:199], v11 offset:29696
    s_waitcnt lgkmcnt(5)
    v_mfma_f32_32x32x16_bf16 v[48:63], v[176:179], a[192:195], v[48:63]
    s_add_u32 s49, s31, 299008
    s_add_u32 m0, s32, 4096
    s_nop 0
    buffer_load_dwordx4 v1, s[12:15], s49 offen lds
    v_mul_f32 v101, v101, v109
    v_mul_f32 v102, v102, v110
    v_mfma_f32_32x32x16_bf16 v[64:79], v[176:179], a[196:199], v[64:79]
    v_mul_f32 v103, v103, v111
    v_fma_f32 v228, v228, v9, v9
    v_fma_f32 v229, v229, v9, v9
    ds_read_b128 v[200:203], v11 offset:30720
    s_waitcnt lgkmcnt(5)
    v_mfma_f32_32x32x16_bf16 v[48:63], v[180:183], a[200:203], v[48:63]
    s_add_u32 s50, s31, 303104
    s_add_u32 m0, s32, 8192
    s_nop 0
    buffer_load_dwordx4 v1, s[12:15], s50 offen lds
    v_fma_f32 v230, v230, v9, v9
    v_fma_f32 v231, v231, v9, v9
    v_mfma_f32_32x32x16_bf16 v[64:79], v[180:183], a[204:207], v[64:79]
    v_rcp_f32 v228, v228
    ds_read_b128 v[204:207], v11 offset:31744
    s_waitcnt lgkmcnt(5)
    v_mfma_f32_32x32x16_bf16 v[48:63], v[184:187], a[208:211], v[48:63]
    s_add_u32 s51, s31, 307200
    s_add_u32 m0, s32, 12288
    s_nop 0
    buffer_load_dwordx4 v1, s[12:15], s51 offen lds
    v_rcp_f32 v229, v229
    v_mfma_f32_32x32x16_bf16 v[64:79], v[184:187], a[212:215], v[64:79]
    v_rcp_f32 v230, v230
    ds_read_b128 v[176:179], v11 offset:32768
    s_waitcnt lgkmcnt(5)
    v_mfma_f32_32x32x16_bf16 v[48:63], v[188:191], a[216:219], v[48:63]
    s_add_u32 s48, s31, 311296
    s_add_u32 m0, s32, 16384
    s_nop 0
    buffer_load_dwordx4 v1, s[12:15], s48 offen lds
    v_rcp_f32 v231, v231
    v_mfma_f32_32x32x16_bf16 v[64:79], v[188:191], a[220:223], v[64:79]
    v_mul_f32 v100, v100, v228
    v_mul_f32 v101, v101, v229
    v_mul_f32 v102, v102, v230
    ds_read_b128 v[180:183], v11 offset:33792
    s_waitcnt lgkmcnt(5)
    v_mfma_f32_32x32x16_bf16 v[48:63], v[192:195], a[224:227], v[48:63]
    s_add_u32 s49, s31, 315392
    s_add_u32 m0, s32, 20480
    s_nop 0
    buffer_load_dwordx4 v1, s[12:15], s49 offen lds
    v_mul_f32 v103, v103, v231
    v_cvt_pk_bf16_f32 v236, v96, v97
    v_mfma_f32_32x32x16_bf16 v[64:79], v[192:195], a[228:231], v[64:79]
    v_cvt_pk_bf16_f32 v237, v98, v99
    v_cvt_pk_bf16_f32 v238, v100, v101
    v_cvt_pk_bf16_f32 v239, v102, v103
    ds_read_b128 v[184:187], v11 offset:34816
    s_waitcnt lgkmcnt(5)
    v_mfma_f32_32x32x16_bf16 v[48:63], v[196:199], a[232:235], v[48:63]
    s_add_u32 s53, s33, 295424
    buffer_store_dwordx4 v[236:239], v2, s[16:19], s53 offen sc1
    ds_read_b128 v[208:211], v10 offset:256
    ds_read_b128 v[212:215], v10 offset:272
    v_mfma_f32_32x32x16_bf16 v[64:79], v[196:199], a[236:239], v[64:79]
    ds_read_b128 v[216:219], v10 offset:288
    ds_read_b128 v[220:223], v10 offset:304
    s_waitcnt lgkmcnt(0)
    ds_read_b128 v[188:191], v11 offset:35840
    v_mfma_f32_32x32x16_bf16 v[48:63], v[200:203], a[240:243], v[48:63]
    v_fmac_f32 v112, v208, v4
    v_fmac_f32 v113, v209, v4
    v_fmac_f32 v114, v210, v4
    v_fmac_f32 v115, v211, v4
    v_mfma_f32_32x32x16_bf16 v[64:79], v[200:203], a[244:247], v[64:79]
    v_mul_f32 v224, v112, v6
    v_mul_f32 v225, v113, v6
    v_mul_f32 v226, v114, v6
    ds_read_b128 v[192:195], v12 offset:0
    v_mfma_f32_32x32x16_bf16 v[48:63], v[204:207], a[248:251], v[48:63]
    v_mul_f32 v227, v115, v6
    v_fmac_f32 v120, v216, v4
    v_fmac_f32 v121, v217, v4
    v_fmac_f32 v122, v218, v4
    v_mfma_f32_32x32x16_bf16 v[64:79], v[204:207], a[252:255], v[64:79]
    v_fmac_f32 v123, v219, v4
    v_exp_f32 v224, v224
    ds_read_b128 v[196:199], v12 offset:1024
    v_mfma_f32_32x32x16_bf16 v[48:63], v[176:179], v[16:19], v[48:63]
    v_exp_f32 v225, v225
    v_exp_f32 v226, v226
    v_mfma_f32_32x32x16_bf16 v[64:79], v[176:179], v[20:23], v[64:79]
    v_exp_f32 v227, v227
    v_mul_f32 v112, v112, v120
    ds_read_b128 v[200:203], v12 offset:2048
    v_mfma_f32_32x32x16_bf16 v[48:63], v[180:183], v[24:27], v[48:63]
    v_mul_f32 v113, v113, v121
    v_mul_f32 v114, v114, v122
    v_mul_f32 v115, v115, v123
    v_fma_f32 v224, v224, v8, v8
    v_mfma_f32_32x32x16_bf16 v[64:79], v[180:183], v[28:31], v[64:79]
    v_fma_f32 v225, v225, v8, v8
    v_fma_f32 v226, v226, v8, v8
    v_fma_f32 v227, v227, v8, v8
    ds_read_b128 v[204:207], v12 offset:3072
    v_mfma_f32_32x32x16_bf16 v[48:63], v[184:187], v[32:35], v[48:63]
    v_rcp_f32 v224, v224
    v_rcp_f32 v225, v225
    v_mfma_f32_32x32x16_bf16 v[64:79], v[184:187], v[36:39], v[64:79]
    v_rcp_f32 v226, v226
    ds_read_b128 v[176:179], v12 offset:4096
    s_waitcnt lgkmcnt(5)
    v_mfma_f32_32x32x16_bf16 v[48:63], v[188:191], v[40:43], v[48:63]
    v_rcp_f32 v227, v227
    v_mul_f32 v112, v112, v224
    v_mul_f32 v113, v113, v225
    v_mfma_f32_32x32x16_bf16 v[64:79], v[188:191], v[44:47], v[64:79]
    v_mul_f32 v114, v114, v226
    v_mul_f32 v115, v115, v227
    v_fmac_f32 v116, v212, v4
    ds_read_b128 v[180:183], v12 offset:5120
    s_waitcnt lgkmcnt(5)
    v_mfma_f32_32x32x16_bf16 v[80:95], v[192:195], a[0:3], 0
    v_fmac_f32 v117, v213, v4
    v_fmac_f32 v118, v214, v4
    v_fmac_f32 v119, v215, v4
    v_mul_f32 v228, v116, v6
    v_mfma_f32_32x32x16_bf16 v[96:111], v[192:195], a[4:7], 0
    v_mul_f32 v229, v117, v6
    v_mul_f32 v230, v118, v6
    v_mul_f32 v231, v119, v6
    ds_read_b128 v[184:187], v12 offset:6144
    s_waitcnt lgkmcnt(5)
    v_mfma_f32_32x32x16_bf16 v[80:95], v[196:199], a[8:11], v[80:95]
    v_fmac_f32 v124, v220, v4
    v_fmac_f32 v125, v221, v4
    v_fmac_f32 v126, v222, v4
    v_fmac_f32 v127, v223, v4
    v_mfma_f32_32x32x16_bf16 v[96:111], v[196:199], a[12:15], v[96:111]
    v_exp_f32 v228, v228
    ds_read_b128 v[188:191], v12 offset:7168
    s_waitcnt lgkmcnt(5)
    v_mfma_f32_32x32x16_bf16 v[80:95], v[200:203], a[16:19], v[80:95]
    v_exp_f32 v229, v229
    v_exp_f32 v230, v230
    v_mfma_f32_32x32x16_bf16 v[96:111], v[200:203], a[20:23], v[96:111]
    v_exp_f32 v231, v231
    v_mul_f32 v116, v116, v124
    ds_read_b128 v[192:195], v12 offset:8192
    s_waitcnt lgkmcnt(5)
    v_mfma_f32_32x32x16_bf16 v[80:95], v[204:207], a[24:27], v[80:95]
    v_mul_f32 v117, v117, v125
    v_mul_f32 v118, v118, v126
    v_mul_f32 v119, v119, v127
    v_fma_f32 v228, v228, v8, v8
    v_mfma_f32_32x32x16_bf16 v[96:111], v[204:207], a[28:31], v[96:111]
    v_fma_f32 v229, v229, v8, v8
    v_fma_f32 v230, v230, v8, v8
    v_fma_f32 v231, v231, v8, v8
    ds_read_b128 v[196:199], v12 offset:9216
    s_waitcnt lgkmcnt(5)
    v_mfma_f32_32x32x16_bf16 v[80:95], v[176:179], a[32:35], v[80:95]
    v_rcp_f32 v228, v228
    v_rcp_f32 v229, v229
    v_mfma_f32_32x32x16_bf16 v[96:111], v[176:179], a[36:39], v[96:111]
    v_rcp_f32 v230, v230
    ds_read_b128 v[200:203], v12 offset:10240
    s_waitcnt lgkmcnt(5)
    v_mfma_f32_32x32x16_bf16 v[80:95], v[180:183], a[40:43], v[80:95]
    v_rcp_f32 v231, v231
    v_mul_f32 v116, v116, v228
    v_mul_f32 v117, v117, v229
    v_mfma_f32_32x32x16_bf16 v[96:111], v[180:183], a[44:47], v[96:111]
    v_mul_f32 v118, v118, v230
    v_mul_f32 v119, v119, v231
    v_cvt_pk_bf16_f32 v232, v112, v113
    s_waitcnt vmcnt(29)
    s_barrier
    ds_read_b128 v[204:207], v12 offset:11264
    s_waitcnt lgkmcnt(5)
    v_mfma_f32_32x32x16_bf16 v[80:95], v[184:187], a[48:51], v[80:95]
    s_add_u32 s50, s31, 319488
    s_add_u32 m0, s32, 24576
    s_nop 0
    buffer_load_dwordx4 v1, s[12:15], s50 offen lds
    v_cvt_pk_bf16_f32 v233, v114, v115
    v_cvt_pk_bf16_f32 v234, v116, v117
    v_mfma_f32_32x32x16_bf16 v[96:111], v[184:187], a[52:55], v[96:111]
    v_cvt_pk_bf16_f32 v235, v118, v119
    s_add_u32 s52, s33, 1024
    buffer_store_dwordx4 v[232:235], v2, s[16:19], s52 offen sc1
    ds_read_b128 v[176:179], v12 offset:12288
    s_waitcnt lgkmcnt(5)
    v_mfma_f32_32x32x16_bf16 v[80:95], v[188:191], a[56:59], v[80:95]
    s_add_u32 s51, s31, 323584
    s_add_u32 m0, s32, 28672
    s_nop 0
    buffer_load_dwordx4 v1, s[12:15], s51 offen lds
    v_fmac_f32 v128, v208, v5
    v_fmac_f32 v129, v209, v5
    v_mfma_f32_32x32x16_bf16 v[96:111], v[188:191], a[60:63], v[96:111]
    v_fmac_f32 v130, v210, v5
    v_fmac_f32 v131, v211, v5
    v_mul_f32 v224, v128, v7
    ds_read_b128 v[180:183], v12 offset:13312
    s_waitcnt lgkmcnt(5)
    v_mfma_f32_32x32x16_bf16 v[80:95], v[192:195], a[64:67], v[80:95]
    s_add_u32 s48, s31, 327680
    s_add_u32 m0, s32, 32768
    s_nop 0
    buffer_load_dwordx4 v1, s[12:15], s48 offen lds
    v_mul_f32 v225, v129, v7
    v_mul_f32 v226, v130, v7
    v_mfma_f32_32x32x16_bf16 v[96:111], v[192:195], a[68:71], v[96:111]
    v_mul_f32 v227, v131, v7
    v_fmac_f32 v136, v216, v5
    v_fmac_f32 v137, v217, v5
    ds_read_b128 v[184:187], v12 offset:14336
    s_waitcnt lgkmcnt(5)
    v_mfma_f32_32x32x16_bf16 v[80:95], v[196:199], a[72:75], v[80:95]
    v_fmac_f32 v138, v218, v5
    v_fmac_f32 v139, v219, v5
    v_exp_f32 v224, v224
    v_mfma_f32_32x32x16_bf16 v[96:111], v[196:199], a[76:79], v[96:111]
    v_exp_f32 v225, v225
    ds_read_b128 v[188:191], v12 offset:15360
    s_waitcnt lgkmcnt(5)
    v_mfma_f32_32x32x16_bf16 v[80:95], v[200:203], a[80:83], v[80:95]
    v_exp_f32 v226, v226
    v_exp_f32 v227, v227
    v_mfma_f32_32x32x16_bf16 v[96:111], v[200:203], a[84:87], v[96:111]
    v_mul_f32 v128, v128, v136
    v_mul_f32 v129, v129, v137
    v_mul_f32 v130, v130, v138
    ds_read_b128 v[192:195], v12 offset:16384
    s_waitcnt lgkmcnt(5)
    v_mfma_f32_32x32x16_bf16 v[80:95], v[204:207], a[88:91], v[80:95]
    v_mul_f32 v131, v131, v139
    v_fma_f32 v224, v224, v9, v9
    v_fma_f32 v225, v225, v9, v9
    v_fma_f32 v226, v226, v9, v9
    v_mfma_f32_32x32x16_bf16 v[96:111], v[204:207], a[92:95], v[96:111]
    v_fma_f32 v227, v227, v9, v9
    v_rcp_f32 v224, v224
    ds_read_b128 v[196:199], v12 offset:17408
    s_waitcnt lgkmcnt(5)
    v_mfma_f32_32x32x16_bf16 v[80:95], v[176:179], a[96:99], v[80:95]
    v_rcp_f32 v225, v225
    v_rcp_f32 v226, v226
    v_mfma_f32_32x32x16_bf16 v[96:111], v[176:179], a[100:103], v[96:111]
    v_rcp_f32 v227, v227
    v_mul_f32 v128, v128, v224
    ds_read_b128 v[200:203], v12 offset:18432
    s_waitcnt lgkmcnt(5)
    v_mfma_f32_32x32x16_bf16 v[80:95], v[180:183], a[104:107], v[80:95]
    v_mul_f32 v129, v129, v225
    v_mul_f32 v130, v130, v226
    v_mul_f32 v131, v131, v227
    v_fmac_f32 v132, v212, v5
    v_mfma_f32_32x32x16_bf16 v[96:111], v[180:183], a[108:111], v[96:111]
    v_fmac_f32 v133, v213, v5
    v_fmac_f32 v134, v214, v5
    v_fmac_f32 v135, v215, v5
    ds_read_b128 v[204:207], v12 offset:19456
    s_waitcnt lgkmcnt(5)
    v_mfma_f32_32x32x16_bf16 v[80:95], v[184:187], a[112:115], v[80:95]
    v_mul_f32 v228, v132, v7
    v_mul_f32 v229, v133, v7
    v_mul_f32 v230, v134, v7
    v_mul_f32 v231, v135, v7
    v_mfma_f32_32x32x16_bf16 v[96:111], v[184:187], a[116:119], v[96:111]
    v_fmac_f32 v140, v220, v5
    v_fmac_f32 v141, v221, v5
    v_fmac_f32 v142, v222, v5
    ds_read_b128 v[176:179], v12 offset:20480
    s_waitcnt lgkmcnt(5)
    v_mfma_f32_32x32x16_bf16 v[80:95], v[188:191], a[120:123], v[80:95]
    v_fmac_f32 v143, v223, v5
    v_exp_f32 v228, v228
    v_mfma_f32_32x32x16_bf16 v[96:111], v[188:191], a[124:127], v[96:111]
    v_exp_f32 v229, v229
    ds_read_b128 v[180:183], v12 offset:21504
    s_waitcnt lgkmcnt(5)
    v_mfma_f32_32x32x16_bf16 v[80:95], v[192:195], a[128:131], v[80:95]
    v_exp_f32 v230, v230
    v_exp_f32 v231, v231
    v_mfma_f32_32x32x16_bf16 v[96:111], v[192:195], a[132:135], v[96:111]
    v_mul_f32 v132, v132, v140
    v_mul_f32 v133, v133, v141
    v_mul_f32 v134, v134, v142
    ds_read_b128 v[184:187], v12 offset:22528
    s_waitcnt lgkmcnt(5)
    v_mfma_f32_32x32x16_bf16 v[80:95], v[196:199], a[136:139], v[80:95]
    v_mul_f32 v135, v135, v143
    v_fma_f32 v228, v228, v9, v9
    v_fma_f32 v229, v229, v9, v9
    v_fma_f32 v230, v230, v9, v9
    v_mfma_f32_32x32x16_bf16 v[96:111], v[196:199], a[140:143], v[96:111]
    v_fma_f32 v231, v231, v9, v9
    v_rcp_f32 v228, v228
    ds_read_b128 v[188:191], v12 offset:23552
    s_waitcnt lgkmcnt(5)
    v_mfma_f32_32x32x16_bf16 v[80:95], v[200:203], a[144:147], v[80:95]
    v_rcp_f32 v229, v229
    v_rcp_f32 v230, v230
    v_mfma_f32_32x32x16_bf16 v[96:111], v[200:203], a[148:151], v[96:111]
    v_rcp_f32 v231, v231
    v_mul_f32 v132, v132, v228
    ds_read_b128 v[192:195], v12 offset:24576
    s_waitcnt lgkmcnt(5)
    v_mfma_f32_32x32x16_bf16 v[80:95], v[204:207], a[152:155], v[80:95]
    v_mul_f32 v133, v133, v229
    v_mul_f32 v134, v134, v230
    v_mul_f32 v135, v135, v231
    v_cvt_pk_bf16_f32 v236, v128, v129
    v_mfma_f32_32x32x16_bf16 v[96:111], v[204:207], a[156:159], v[96:111]
    v_cvt_pk_bf16_f32 v237, v130, v131
    v_cvt_pk_bf16_f32 v238, v132, v133
    v_cvt_pk_bf16_f32 v239, v134, v135
    ds_read_b128 v[196:199], v12 offset:25600
    s_waitcnt lgkmcnt(5)
    v_mfma_f32_32x32x16_bf16 v[80:95], v[176:179], a[160:163], v[80:95]
    s_add_u32 s53, s33, 295936
    buffer_store_dwordx4 v[236:239], v2, s[16:19], s53 offen sc1
    ds_read_b128 v[208:211], v10 offset:384
    ds_read_b128 v[212:215], v10 offset:400
    v_mfma_f32_32x32x16_bf16 v[96:111], v[176:179], a[164:167], v[96:111]
    ds_read_b128 v[216:219], v10 offset:416
    ds_read_b128 v[220:223], v10 offset:432
    s_waitcnt lgkmcnt(0)
    ds_read_b128 v[200:203], v12 offset:26624
    v_mfma_f32_32x32x16_bf16 v[80:95], v[180:183], a[168:171], v[80:95]
    v_fmac_f32 v144, v208, v4
    v_fmac_f32 v145, v209, v4
    v_fmac_f32 v146, v210, v4
    v_fmac_f32 v147, v211, v4
    v_mfma_f32_32x32x16_bf16 v[96:111], v[180:183], a[172:175], v[96:111]
    v_mul_f32 v224, v144, v6
    v_mul_f32 v225, v145, v6
    v_mul_f32 v226, v146, v6
    ds_read_b128 v[204:207], v12 offset:27648
    v_mfma_f32_32x32x16_bf16 v[80:95], v[184:187], a[176:179], v[80:95]
    v_mul_f32 v227, v147, v6
    v_fmac_f32 v152, v216, v4
    v_fmac_f32 v153, v217, v4
    v_fmac_f32 v154, v218, v4
    v_mfma_f32_32x32x16_bf16 v[96:111], v[184:187], a[180:183], v[96:111]
    v_fmac_f32 v155, v219, v4
    v_exp_f32 v224, v224
    ds_read_b128 v[176:179], v12 offset:28672
    v_mfma_f32_32x32x16_bf16 v[80:95], v[188:191], a[184:187], v[80:95]
    v_exp_f32 v225, v225
    v_exp_f32 v226, v226
    v_mfma_f32_32x32x16_bf16 v[96:111], v[188:191], a[188:191], v[96:111]
    v_exp_f32 v227, v227
    v_mul_f32 v144, v144, v152
    s_waitcnt vmcnt(30)
    s_barrier
    ds_read_b128 v[180:183], v12 offset:29696
    v_mfma_f32_32x32x16_bf16 v[80:95], v[192:195], a[192:195], v[80:95]
    v_mul_f32 v145, v145, v153
    v_mul_f32 v146, v146, v154
    v_mul_f32 v147, v147, v155
    v_fma_f32 v224, v224, v8, v8
    v_mfma_f32_32x32x16_bf16 v[96:111], v[192:195], a[196:199], v[96:111]
    v_fma_f32 v225, v225, v8, v8
    v_fma_f32 v226, v226, v8, v8
    v_fma_f32 v227, v227, v8, v8
    ds_read_b128 v[184:187], v12 offset:30720
    v_mfma_f32_32x32x16_bf16 v[80:95], v[196:199], a[200:203], v[80:95]
    v_rcp_f32 v224, v224
    v_rcp_f32 v225, v225
    v_mfma_f32_32x32x16_bf16 v[96:111], v[196:199], a[204:207], v[96:111]
    v_rcp_f32 v226, v226
    ds_read_b128 v[188:191], v12 offset:31744
    s_waitcnt lgkmcnt(5)
    v_mfma_f32_32x32x16_bf16 v[80:95], v[200:203], a[208:211], v[80:95]
    v_rcp_f32 v227, v227
    v_mul_f32 v144, v144, v224
    v_mul_f32 v145, v145, v225
    v_mfma_f32_32x32x16_bf16 v[96:111], v[200:203], a[212:215], v[96:111]
    v_mul_f32 v146, v146, v226
    v_mul_f32 v147, v147, v227
    v_fmac_f32 v148, v212, v4
    ds_read_b128 v[192:195], v12 offset:32768
    s_waitcnt lgkmcnt(5)
    v_mfma_f32_32x32x16_bf16 v[80:95], v[204:207], a[216:219], v[80:95]
    v_fmac_f32 v149, v213, v4
    v_fmac_f32 v150, v214, v4
    v_fmac_f32 v151, v215, v4
    v_mul_f32 v228, v148, v6
    v_mfma_f32_32x32x16_bf16 v[96:111], v[204:207], a[220:223], v[96:111]
    v_mul_f32 v229, v149, v6
    v_mul_f32 v230, v150, v6
    v_mul_f32 v231, v151, v6
    ds_read_b128 v[196:199], v12 offset:33792
    s_waitcnt lgkmcnt(5)
    v_mfma_f32_32x32x16_bf16 v[80:95], v[176:179], a[224:227], v[80:95]
    v_fmac_f32 v156, v220, v4
    v_fmac_f32 v157, v221, v4
    v_fmac_f32 v158, v222, v4
    v_fmac_f32 v159, v223, v4
    v_mfma_f32_32x32x16_bf16 v[96:111], v[176:179], a[228:231], v[96:111]
    v_exp_f32 v228, v228
    ds_read_b128 v[200:203], v12 offset:34816
    s_waitcnt lgkmcnt(5)
    v_mfma_f32_32x32x16_bf16 v[80:95], v[180:183], a[232:235], v[80:95]
    v_exp_f32 v229, v229
    v_exp_f32 v230, v230
    v_mfma_f32_32x32x16_bf16 v[96:111], v[180:183], a[236:239], v[96:111]
    v_exp_f32 v231, v231
    v_mul_f32 v148, v148, v156
    ds_read_b128 v[204:207], v12 offset:35840
    s_waitcnt lgkmcnt(5)
    v_mfma_f32_32x32x16_bf16 v[80:95], v[184:187], a[240:243], v[80:95]
    v_mul_f32 v149, v149, v157
    v_mul_f32 v150, v150, v158
    v_mul_f32 v151, v151, v159
    v_fma_f32 v228, v228, v8, v8
    v_mfma_f32_32x32x16_bf16 v[96:111], v[184:187], a[244:247], v[96:111]
    v_fma_f32 v229, v229, v8, v8
    v_fma_f32 v230, v230, v8, v8
    v_fma_f32 v231, v231, v8, v8
    ds_read_b128 v[176:179], v13 offset:0
    s_waitcnt lgkmcnt(5)
    v_mfma_f32_32x32x16_bf16 v[80:95], v[188:191], a[248:251], v[80:95]
    v_rcp_f32 v228, v228
    v_rcp_f32 v229, v229
    v_mfma_f32_32x32x16_bf16 v[96:111], v[188:191], a[252:255], v[96:111]
    v_rcp_f32 v230, v230
    ds_read_b128 v[180:183], v13 offset:1024
    s_waitcnt lgkmcnt(5)
    v_mfma_f32_32x32x16_bf16 v[80:95], v[192:195], v[16:19], v[80:95]
    v_rcp_f32 v231, v231
    v_mul_f32 v148, v148, v228
    v_mul_f32 v149, v149, v229
    v_mfma_f32_32x32x16_bf16 v[96:111], v[192:195], v[20:23], v[96:111]
    v_mul_f32 v150, v150, v230
    v_mul_f32 v151, v151, v231
    v_cvt_pk_bf16_f32 v232, v144, v145
    ds_read_b128 v[184:187], v13 offset:2048
    s_waitcnt lgkmcnt(5)
    v_mfma_f32_32x32x16_bf16 v[80:95], v[196:199], v[24:27], v[80:95]
    v_cvt_pk_bf16_f32 v233, v146, v147
    v_cvt_pk_bf16_f32 v234, v148, v149
    v_cvt_pk_bf16_f32 v235, v150, v151
    v_mfma_f32_32x32x16_bf16 v[96:111], v[196:199], v[28:31], v[96:111]
    s_add_u32 s52, s33, 1536
    buffer_store_dwordx4 v[232:235], v2, s[16:19], s52 offen sc1
    v_fmac_f32 v160, v208, v5
    ds_read_b128 v[188:191], v13 offset:3072
    s_waitcnt lgkmcnt(5)
    v_mfma_f32_32x32x16_bf16 v[80:95], v[200:203], v[32:35], v[80:95]
    v_fmac_f32 v161, v209, v5
    v_fmac_f32 v162, v210, v5
    v_fmac_f32 v163, v211, v5
    v_mul_f32 v224, v160, v7
    v_mfma_f32_32x32x16_bf16 v[96:111], v[200:203], v[36:39], v[96:111]
    v_mul_f32 v225, v161, v7
    v_mul_f32 v226, v162, v7
    v_mul_f32 v227, v163, v7
    ds_read_b128 v[192:195], v13 offset:4096
    s_waitcnt lgkmcnt(5)
    v_mfma_f32_32x32x16_bf16 v[80:95], v[204:207], v[40:43], v[80:95]
    v_fmac_f32 v168, v216, v5
    v_fmac_f32 v169, v217, v5
    v_fmac_f32 v170, v218, v5
    v_fmac_f32 v171, v219, v5
    v_mfma_f32_32x32x16_bf16 v[96:111], v[204:207], v[44:47], v[96:111]
    v_exp_f32 v224, v224
    ds_read_b128 v[196:199], v13 offset:5120
    s_waitcnt lgkmcnt(5)
    v_mfma_f32_32x32x16_bf16 v[112:127], v[176:179], a[0:3], 0
    v_exp_f32 v225, v225
    v_exp_f32 v226, v226
    v_mfma_f32_32x32x16_bf16 v[128:143], v[176:179], a[4:7], 0
    v_exp_f32 v227, v227
    v_mul_f32 v160, v160, v168
    ds_read_b128 v[200:203], v13 offset:6144
    s_waitcnt lgkmcnt(5)
    v_mfma_f32_32x32x16_bf16 v[112:127], v[180:183], a[8:11], v[112:127]
    v_mul_f32 v161, v161, v169
    v_mul_f32 v162, v162, v170
    v_mul_f32 v163, v163, v171
    v_fma_f32 v224, v224, v9, v9
    v_mfma_f32_32x32x16_bf16 v[128:143], v[180:183], a[12:15], v[128:143]
    v_fma_f32 v225, v225, v9, v9
    v_fma_f32 v226, v226, v9, v9
    v_fma_f32 v227, v227, v9, v9
    ds_read_b128 v[204:207], v13 offset:7168
    s_waitcnt lgkmcnt(5)
    v_mfma_f32_32x32x16_bf16 v[112:127], v[184:187], a[16:19], v[112:127]
    v_rcp_f32 v224, v224
    v_rcp_f32 v225, v225
    v_mfma_f32_32x32x16_bf16 v[128:143], v[184:187], a[20:23], v[128:143]
    v_rcp_f32 v226, v226
    ds_read_b128 v[176:179], v13 offset:8192
    s_waitcnt lgkmcnt(5)
    v_mfma_f32_32x32x16_bf16 v[112:127], v[188:191], a[24:27], v[112:127]
    v_rcp_f32 v227, v227
    v_mul_f32 v160, v160, v224
    v_mul_f32 v161, v161, v225
    v_mfma_f32_32x32x16_bf16 v[128:143], v[188:191], a[28:31], v[128:143]
    v_mul_f32 v162, v162, v226
    v_mul_f32 v163, v163, v227
    v_fmac_f32 v164, v212, v5
    ds_read_b128 v[180:183], v13 offset:9216
    s_waitcnt lgkmcnt(5)
    v_mfma_f32_32x32x16_bf16 v[112:127], v[192:195], a[32:35], v[112:127]
    v_fmac_f32 v165, v213, v5
    v_fmac_f32 v166, v214, v5
    v_fmac_f32 v167, v215, v5
    v_mul_f32 v228, v164, v7
    v_mfma_f32_32x32x16_bf16 v[128:143], v[192:195], a[36:39], v[128:143]
    v_mul_f32 v229, v165, v7
    v_mul_f32 v230, v166, v7
    v_mul_f32 v231, v167, v7
    ds_read_b128 v[184:187], v13 offset:10240
    s_waitcnt lgkmcnt(5)
    v_mfma_f32_32x32x16_bf16 v[112:127], v[196:199], a[40:43], v[112:127]
    v_fmac_f32 v172, v220, v5
    v_fmac_f32 v173, v221, v5
    v_fmac_f32 v174, v222, v5
    v_fmac_f32 v175, v223, v5
    v_mfma_f32_32x32x16_bf16 v[128:143], v[196:199], a[44:47], v[128:143]
    v_exp_f32 v228, v228
    s_waitcnt vmcnt(25)
    s_barrier
    ds_read_b128 v[188:191], v13 offset:11264
    s_waitcnt lgkmcnt(5)
    v_mfma_f32_32x32x16_bf16 v[112:127], v[200:203], a[48:51], v[112:127]
    s_mul_i32 s54, s24, 144
    s_mul_i32 s55, s26, 36
    s_add_u32 s54, s54, s55
    s_mul_i32 s54, s54, 1152
    s_mul_i32 s55, s25, 144
    s_add_u32 s54, s54, s55
    s_mul_i32 s55, s26, 5184
    s_add_u32 m0, s55, 36864
    s_nop 0
    buffer_load_dwordx4 v240, s[80:83], s54 offen lds
    v_exp_f32 v229, v229
    v_mfma_f32_32x32x16_bf16 v[128:143], v[200:203], a[52:55], v[128:143]
    v_exp_f32 v230, v230
    ds_read_b128 v[192:195], v13 offset:12288
    s_waitcnt lgkmcnt(5)
    v_mfma_f32_32x32x16_bf16 v[112:127], v[204:207], a[56:59], v[112:127]
    s_add_u32 m0, s55, 37888
    s_nop 0
    buffer_load_dwordx4 v241, s[80:83], s54 offen lds
    v_exp_f32 v231, v231
    v_mfma_f32_32x32x16_bf16 v[128:143], v[204:207], a[60:63], v[128:143]
    v_mul_f32 v164, v164, v172
    v_mul_f32 v165, v165, v173
    v_mul_f32 v166, v166, v174
    ds_read_b128 v[196:199], v13 offset:13312
    s_waitcnt lgkmcnt(5)
    v_mfma_f32_32x32x16_bf16 v[112:127], v[176:179], a[64:67], v[112:127]
    s_add_u32 m0, s55, 38912
    s_nop 0
    buffer_load_dwordx4 v242, s[80:83], s54 offen lds
    v_mul_f32 v167, v167, v175
    v_fma_f32 v228, v228, v9, v9
    v_mfma_f32_32x32x16_bf16 v[128:143], v[176:179], a[68:71], v[128:143]
    v_fma_f32 v229, v229, v9, v9
    v_fma_f32 v230, v230, v9, v9
    v_fma_f32 v231, v231, v9, v9
    ds_read_b128 v[200:203], v13 offset:14336
    s_waitcnt lgkmcnt(5)
    v_mfma_f32_32x32x16_bf16 v[112:127], v[180:183], a[72:75], v[112:127]
    s_add_u32 m0, s55, 39936
    s_nop 0
    buffer_load_dwordx4 v243, s[80:83], s54 offen lds
    v_rcp_f32 v228, v228
    v_mfma_f32_32x32x16_bf16 v[128:143], v[180:183], a[76:79], v[128:143]
    v_rcp_f32 v229, v229
    ds_read_b128 v[204:207], v13 offset:15360
    s_waitcnt lgkmcnt(5)
    v_mfma_f32_32x32x16_bf16 v[112:127], v[184:187], a[80:83], v[112:127]
    s_add_u32 m0, s55, 40960
    s_nop 0
    buffer_load_dwordx4 v244, s[80:83], s54 offen lds
    v_rcp_f32 v230, v230
    v_mfma_f32_32x32x16_bf16 v[128:143], v[184:187], a[84:87], v[128:143]
    v_rcp_f32 v231, v231
    v_mul_f32 v164, v164, v228
    ds_read_b128 v[176:179], v13 offset:16384
    s_waitcnt lgkmcnt(5)
    v_mfma_f32_32x32x16_bf16 v[112:127], v[188:191], a[88:91], v[112:127]
    s_add_u32 m0, s55, 41984
    s_mov_b64 exec, 15
    buffer_load_dwordx4 v245, s[80:83], s54 offen lds
    s_mov_b64 exec, -1
    v_mul_f32 v165, v165, v229
    v_mul_f32 v166, v166, v230
    v_mfma_f32_32x32x16_bf16 v[128:143], v[188:191], a[92:95], v[128:143]
    v_mul_f32 v167, v167, v231
    v_cvt_pk_bf16_f32 v236, v160, v161
    v_cvt_pk_bf16_f32 v237, v162, v163
    ds_read_b128 v[180:183], v13 offset:17408
    s_waitcnt lgkmcnt(5)
    v_mfma_f32_32x32x16_bf16 v[112:127], v[192:195], a[96:99], v[112:127]
    v_cvt_pk_bf16_f32 v238, v164, v165
    v_cvt_pk_bf16_f32 v239, v166, v167
    s_add_u32 s53, s33, 296448
    buffer_store_dwordx4 v[236:239], v2, s[16:19], s53 offen sc1
    v_mfma_f32_32x32x16_bf16 v[128:143], v[192:195], a[100:103], v[128:143]
    ds_read_b128 v[208:211], v10 offset:512
    ds_read_b128 v[212:215], v10 offset:528
    ds_read_b128 v[216:219], v10 offset:544
    ds_read_b128 v[184:187], v13 offset:18432
    s_waitcnt lgkmcnt(8)
    v_mfma_f32_32x32x16_bf16 v[112:127], v[196:199], a[104:107], v[112:127]
    ds_read_b128 v[220:223], v10 offset:560
    s_waitcnt lgkmcnt(0)
    v_fmac_f32 v48, v208, v4
    v_fmac_f32 v49, v209, v4
    v_mfma_f32_32x32x16_bf16 v[128:143], v[196:199], a[108:111], v[128:143]
    v_fmac_f32 v50, v210, v4
    v_fmac_f32 v51, v211, v4
    v_mul_f32 v224, v48, v6
    ds_read_b128 v[188:191], v13 offset:19456
    v_mfma_f32_32x32x16_bf16 v[112:127], v[200:203], a[112:115], v[112:127]
    v_mul_f32 v225, v49, v6
    v_mul_f32 v226, v50, v6
    v_mul_f32 v227, v51, v6
    v_fmac_f32 v56, v216, v4
    v_mfma_f32_32x32x16_bf16 v[128:143], v[200:203], a[116:119], v[128:143]
    v_fmac_f32 v57, v217, v4
    v_fmac_f32 v58, v218, v4
    v_fmac_f32 v59, v219, v4
    ds_read_b128 v[192:195], v13 offset:20480
    v_mfma_f32_32x32x16_bf16 v[112:127], v[204:207], a[120:123], v[112:127]
    v_exp_f32 v224, v224
    v_exp_f32 v225, v225
    v_mfma_f32_32x32x16_bf16 v[128:143], v[204:207], a[124:127], v[128:143]
    v_exp_f32 v226, v226
    ds_read_b128 v[196:199], v13 offset:21504
    v_mfma_f32_32x32x16_bf16 v[112:127], v[176:179], a[128:131], v[112:127]
    v_exp_f32 v227, v227
    v_mul_f32 v48, v48, v56
    v_mul_f32 v49, v49, v57
    v_mfma_f32_32x32x16_bf16 v[128:143], v[176:179], a[132:135], v[128:143]
    v_mul_f32 v50, v50, v58
    v_mul_f32 v51, v51, v59
    v_fma_f32 v224, v224, v8, v8
    ds_read_b128 v[200:203], v13 offset:22528
    v_mfma_f32_32x32x16_bf16 v[112:127], v[180:183], a[136:139], v[112:127]
    v_fma_f32 v225, v225, v8, v8
    v_fma_f32 v226, v226, v8, v8
    v_fma_f32 v227, v227, v8, v8
    v_mfma_f32_32x32x16_bf16 v[128:143], v[180:183], a[140:143], v[128:143]
    v_rcp_f32 v224, v224
    ds_read_b128 v[204:207], v13 offset:23552
    v_mfma_f32_32x32x16_bf16 v[112:127], v[184:187], a[144:147], v[112:127]
    v_rcp_f32 v225, v225
    v_rcp_f32 v226, v226
    v_mfma_f32_32x32x16_bf16 v[128:143], v[184:187], a[148:151], v[128:143]
    v_rcp_f32 v227, v227
    v_mul_f32 v48, v48, v224
    ds_read_b128 v[176:179], v13 offset:24576
    s_waitcnt lgkmcnt(5)
    v_mfma_f32_32x32x16_bf16 v[112:127], v[188:191], a[152:155], v[112:127]
    v_mul_f32 v49, v49, v225
    v_mul_f32 v50, v50, v226
    v_mul_f32 v51, v51, v227
    v_fmac_f32 v52, v212, v4
    v_mfma_f32_32x32x16_bf16 v[128:143], v[188:191], a[156:159], v[128:143]
    v_fmac_f32 v53, v213, v4
    v_fmac_f32 v54, v214, v4
    v_fmac_f32 v55, v215, v4
    ds_read_b128 v[180:183], v13 offset:25600
    s_waitcnt lgkmcnt(5)
    v_mfma_f32_32x32x16_bf16 v[112:127], v[192:195], a[160:163], v[112:127]
    v_mul_f32 v228, v52, v6
    v_mul_f32 v229, v53, v6
    v_mul_f32 v230, v54, v6
    v_mul_f32 v231, v55, v6
    v_mfma_f32_32x32x16_bf16 v[128:143], v[192:195], a[164:167], v[128:143]
    v_fmac_f32 v60, v220, v4
    v_fmac_f32 v61, v221, v4
    v_fmac_f32 v62, v222, v4
    ds_read_b128 v[184:187], v13 offset:26624
    s_waitcnt lgkmcnt(5)
    v_mfma_f32_32x32x16_bf16 v[112:127], v[196:199], a[168:171], v[112:127]
    v_fmac_f32 v63, v223, v4
    v_exp_f32 v228, v228
    v_mfma_f32_32x32x16_bf16 v[128:143], v[196:199], a[172:175], v[128:143]
    v_exp_f32 v229, v229
    ds_read_b128 v[188:191], v13 offset:27648
    s_waitcnt lgkmcnt(5)
    v_mfma_f32_32x32x16_bf16 v[112:127], v[200:203], a[176:179], v[112:127]
    v_exp_f32 v230, v230
    v_exp_f32 v231, v231
    v_mfma_f32_32x32x16_bf16 v[128:143], v[200:203], a[180:183], v[128:143]
    v_mul_f32 v52, v52, v60
    v_mul_f32 v53, v53, v61
    v_mul_f32 v54, v54, v62
    ds_read_b128 v[192:195], v13 offset:28672
    s_waitcnt lgkmcnt(5)
    v_mfma_f32_32x32x16_bf16 v[112:127], v[204:207], a[184:187], v[112:127]
    v_mul_f32 v55, v55, v63
    v_fma_f32 v228, v228, v8, v8
    v_fma_f32 v229, v229, v8, v8
    v_fma_f32 v230, v230, v8, v8
    v_mfma_f32_32x32x16_bf16 v[128:143], v[204:207], a[188:191], v[128:143]
    v_fma_f32 v231, v231, v8, v8
    v_rcp_f32 v228, v228
    s_waitcnt vmcnt(28)
    s_barrier
    ds_read_b128 v[196:199], v13 offset:29696
    s_waitcnt lgkmcnt(5)
    v_mfma_f32_32x32x16_bf16 v[112:127], v[176:179], a[192:195], v[112:127]
    v_rcp_f32 v229, v229
    v_rcp_f32 v230, v230
    v_mfma_f32_32x32x16_bf16 v[128:143], v[176:179], a[196:199], v[128:143]
    v_rcp_f32 v231, v231
    v_mul_f32 v52, v52, v228
    ds_read_b128 v[200:203], v13 offset:30720
    s_waitcnt lgkmcnt(5)
    v_mfma_f32_32x32x16_bf16 v[112:127], v[180:183], a[200:203], v[112:127]
    v_mul_f32 v53, v53, v229
    v_mul_f32 v54, v54, v230
    v_mul_f32 v55, v55, v231
    v_cvt_pk_bf16_f32 v232, v48, v49
    v_mfma_f32_32x32x16_bf16 v[128:143], v[180:183], a[204:207], v[128:143]
    v_cvt_pk_bf16_f32 v233, v50, v51
    v_cvt_pk_bf16_f32 v234, v52, v53
    v_cvt_pk_bf16_f32 v235, v54, v55
    ds_read_b128 v[204:207], v13 offset:31744
    s_waitcnt lgkmcnt(5)
    v_mfma_f32_32x32x16_bf16 v[112:127], v[184:187], a[208:211], v[112:127]
    s_add_u32 s52, s33, 2048
    buffer_store_dwordx4 v[232:235], v2, s[16:19], s52 offen sc1
    v_fmac_f32 v64, v208, v5
    v_fmac_f32 v65, v209, v5
    v_mfma_f32_32x32x16_bf16 v[128:143], v[184:187], a[212:215], v[128:143]
    v_fmac_f32 v66, v210, v5
    v_fmac_f32 v67, v211, v5
    v_mul_f32 v224, v64, v7
    ds_read_b128 v[176:179], v13 offset:32768
    s_waitcnt lgkmcnt(5)
    v_mfma_f32_32x32x16_bf16 v[112:127], v[188:191], a[216:219], v[112:127]
    v_mul_f32 v225, v65, v7
    v_mul_f32 v226, v66, v7
    v_mul_f32 v227, v67, v7
    v_fmac_f32 v72, v216, v5
    v_mfma_f32_32x32x16_bf16 v[128:143], v[188:191], a[220:223], v[128:143]
    v_fmac_f32 v73, v217, v5
    v_fmac_f32 v74, v218, v5
    v_fmac_f32 v75, v219, v5
    ds_read_b128 v[180:183], v13 offset:33792
    s_waitcnt lgkmcnt(5)
    v_mfma_f32_32x32x16_bf16 v[112:127], v[192:195], a[224:227], v[112:127]
    v_exp_f32 v224, v224
    v_exp_f32 v225, v225
    v_mfma_f32_32x32x16_bf16 v[128:143], v[192:195], a[228:231], v[128:143]
    v_exp_f32 v226, v226
    ds_read_b128 v[184:187], v13 offset:34816
    s_waitcnt lgkmcnt(5)
    v_mfma_f32_32x32x16_bf16 v[112:127], v[196:199], a[232:235], v[112:127]
    v_exp_f32 v227, v227
    v_mul_f32 v64, v64, v72
    v_mul_f32 v65, v65, v73
    v_mfma_f32_32x32x16_bf16 v[128:143], v[196:199], a[236:239], v[128:143]
    v_mul_f32 v66, v66, v74
    v_mul_f32 v67, v67, v75
    v_fma_f32 v224, v224, v9, v9
    ds_read_b128 v[188:191], v13 offset:35840
    s_waitcnt lgkmcnt(5)
    v_mfma_f32_32x32x16_bf16 v[112:127], v[200:203], a[240:243], v[112:127]
    v_fma_f32 v225, v225, v9, v9
    v_fma_f32 v226, v226, v9, v9
    v_fma_f32 v227, v227, v9, v9
    v_mfma_f32_32x32x16_bf16 v[128:143], v[200:203], a[244:247], v[128:143]
    v_rcp_f32 v224, v224
    ds_read_b128 v[192:195], v14 offset:0
    s_waitcnt lgkmcnt(5)
    v_mfma_f32_32x32x16_bf16 v[112:127], v[204:207], a[248:251], v[112:127]
    v_rcp_f32 v225, v225
    v_rcp_f32 v226, v226
    v_mfma_f32_32x32x16_bf16 v[128:143], v[204:207], a[252:255], v[128:143]
    v_rcp_f32 v227, v227
    v_mul_f32 v64, v64, v224
    ds_read_b128 v[196:199], v14 offset:1024
    s_waitcnt lgkmcnt(5)
    v_mfma_f32_32x32x16_bf16 v[112:127], v[176:179], v[16:19], v[112:127]
    v_mul_f32 v65, v65, v225
    v_mul_f32 v66, v66, v226
    v_mul_f32 v67, v67, v227
    v_fmac_f32 v68, v212, v5
    v_mfma_f32_32x32x16_bf16 v[128:143], v[176:179], v[20:23], v[128:143]
    v_fmac_f32 v69, v213, v5
    v_fmac_f32 v70, v214, v5
    v_fmac_f32 v71, v215, v5
    ds_read_b128 v[200:203], v14 offset:2048
    s_waitcnt lgkmcnt(5)
    v_mfma_f32_32x32x16_bf16 v[112:127], v[180:183], v[24:27], v[112:127]
    v_mul_f32 v228, v68, v7
    v_mul_f32 v229, v69, v7
    v_mul_f32 v230, v70, v7
    v_mul_f32 v231, v71, v7
    v_mfma_f32_32x32x16_bf16 v[128:143], v[180:183], v[28:31], v[128:143]
    v_fmac_f32 v76, v220, v5
    v_fmac_f32 v77, v221, v5
    v_fmac_f32 v78, v222, v5
    ds_read_b128 v[204:207], v14 offset:3072
    s_waitcnt lgkmcnt(5)
    v_mfma_f32_32x32x16_bf16 v[112:127], v[184:187], v[32:35], v[112:127]
    v_fmac_f32 v79, v223, v5
    v_exp_f32 v228, v228
    v_mfma_f32_32x32x16_bf16 v[128:143], v[184:187], v[36:39], v[128:143]
    v_exp_f32 v229, v229
    ds_read_b128 v[176:179], v14 offset:4096
    s_waitcnt lgkmcnt(5)
    v_mfma_f32_32x32x16_bf16 v[112:127], v[188:191], v[40:43], v[112:127]
    v_exp_f32 v230, v230
    v_exp_f32 v231, v231
    v_mfma_f32_32x32x16_bf16 v[128:143], v[188:191], v[44:47], v[128:143]
    v_mul_f32 v68, v68, v76
    v_mul_f32 v69, v69, v77
    v_mul_f32 v70, v70, v78
    ds_read_b128 v[180:183], v14 offset:5120
    s_waitcnt lgkmcnt(5)
    v_mfma_f32_32x32x16_bf16 v[144:159], v[192:195], a[0:3], 0
    v_mul_f32 v71, v71, v79
    v_fma_f32 v228, v228, v9, v9
    v_fma_f32 v229, v229, v9, v9
    v_fma_f32 v230, v230, v9, v9
    v_mfma_f32_32x32x16_bf16 v[160:175], v[192:195], a[4:7], 0
    v_fma_f32 v231, v231, v9, v9
    v_rcp_f32 v228, v228
    ds_read_b128 v[184:187], v14 offset:6144
    s_waitcnt lgkmcnt(5)
    v_mfma_f32_32x32x16_bf16 v[144:159], v[196:199], a[8:11], v[144:159]
    v_rcp_f32 v229, v229
    v_rcp_f32 v230, v230
    v_mfma_f32_32x32x16_bf16 v[160:175], v[196:199], a[12:15], v[160:175]
    v_rcp_f32 v231, v231
    v_mul_f32 v68, v68, v228
    ds_read_b128 v[188:191], v14 offset:7168
    s_waitcnt lgkmcnt(5)
    v_mfma_f32_32x32x16_bf16 v[144:159], v[200:203], a[16:19], v[144:159]
    v_mul_f32 v69, v69, v229
    v_mul_f32 v70, v70, v230
    v_mul_f32 v71, v71, v231
    v_cvt_pk_bf16_f32 v236, v64, v65
    v_mfma_f32_32x32x16_bf16 v[160:175], v[200:203], a[20:23], v[160:175]
    v_cvt_pk_bf16_f32 v237, v66, v67
    v_cvt_pk_bf16_f32 v238, v68, v69
    v_cvt_pk_bf16_f32 v239, v70, v71
    ds_read_b128 v[192:195], v14 offset:8192
    s_waitcnt lgkmcnt(5)
    v_mfma_f32_32x32x16_bf16 v[144:159], v[204:207], a[24:27], v[144:159]
    s_add_u32 s53, s33, 296960
    buffer_store_dwordx4 v[236:239], v2, s[16:19], s53 offen sc1
    ds_read_b128 v[208:211], v10 offset:640
    ds_read_b128 v[212:215], v10 offset:656
    v_mfma_f32_32x32x16_bf16 v[160:175], v[204:207], a[28:31], v[160:175]
    ds_read_b128 v[216:219], v10 offset:672
    ds_read_b128 v[220:223], v10 offset:688
    s_waitcnt lgkmcnt(0)
    ds_read_b128 v[196:199], v14 offset:9216
    v_mfma_f32_32x32x16_bf16 v[144:159], v[176:179], a[32:35], v[144:159]
    v_fmac_f32 v80, v208, v4
    v_fmac_f32 v81, v209, v4
    v_fmac_f32 v82, v210, v4
    v_fmac_f32 v83, v211, v4
    v_mfma_f32_32x32x16_bf16 v[160:175], v[176:179], a[36:39], v[160:175]
    v_mul_f32 v224, v80, v6
    v_mul_f32 v225, v81, v6
    v_mul_f32 v226, v82, v6
    ds_read_b128 v[200:203], v14 offset:10240
    v_mfma_f32_32x32x16_bf16 v[144:159], v[180:183], a[40:43], v[144:159]
    v_mul_f32 v227, v83, v6
    v_fmac_f32 v88, v216, v4
    v_fmac_f32 v89, v217, v4
    v_fmac_f32 v90, v218, v4
    v_mfma_f32_32x32x16_bf16 v[160:175], v[180:183], a[44:47], v[160:175]
    v_fmac_f32 v91, v219, v4
    v_exp_f32 v224, v224
    s_waitcnt vmcnt(3)
    s_barrier
    ds_read_b128 v[204:207], v14 offset:11264
    v_mfma_f32_32x32x16_bf16 v[144:159], v[184:187], a[48:51], v[144:159]
    v_exp_f32 v225, v225
    v_exp_f32 v226, v226
    v_mfma_f32_32x32x16_bf16 v[160:175], v[184:187], a[52:55], v[160:175]
    v_exp_f32 v227, v227
    v_mul_f32 v80, v80, v88
    ds_read_b128 v[176:179], v14 offset:12288
    v_mfma_f32_32x32x16_bf16 v[144:159], v[188:191], a[56:59], v[144:159]
    v_mul_f32 v81, v81, v89
    v_mul_f32 v82, v82, v90
    v_mul_f32 v83, v83, v91
    v_fma_f32 v224, v224, v8, v8
    v_mfma_f32_32x32x16_bf16 v[160:175], v[188:191], a[60:63], v[160:175]
    v_fma_f32 v225, v225, v8, v8
    v_fma_f32 v226, v226, v8, v8
    v_fma_f32 v227, v227, v8, v8
    ds_read_b128 v[180:183], v14 offset:13312
    v_mfma_f32_32x32x16_bf16 v[144:159], v[192:195], a[64:67], v[144:159]
    v_rcp_f32 v224, v224
    v_rcp_f32 v225, v225
    v_mfma_f32_32x32x16_bf16 v[160:175], v[192:195], a[68:71], v[160:175]
    v_rcp_f32 v226, v226
    ds_read_b128 v[184:187], v14 offset:14336
    s_waitcnt lgkmcnt(5)
    v_mfma_f32_32x32x16_bf16 v[144:159], v[196:199], a[72:75], v[144:159]
    v_rcp_f32 v227, v227
    v_mul_f32 v80, v80, v224
    v_mul_f32 v81, v81, v225
    v_mfma_f32_32x32x16_bf16 v[160:175], v[196:199], a[76:79], v[160:175]
    v_mul_f32 v82, v82, v226
    v_mul_f32 v83, v83, v227
    v_fmac_f32 v84, v212, v4
    ds_read_b128 v[188:191], v14 offset:15360
    s_waitcnt lgkmcnt(5)
    v_mfma_f32_32x32x16_bf16 v[144:159], v[200:203], a[80:83], v[144:159]
    v_fmac_f32 v85, v213, v4
    v_fmac_f32 v86, v214, v4
    v_fmac_f32 v87, v215, v4
    v_mul_f32 v228, v84, v6
    v_mfma_f32_32x32x16_bf16 v[160:175], v[200:203], a[84:87], v[160:175]
    v_mul_f32 v229, v85, v6
    v_mul_f32 v230, v86, v6
    v_mul_f32 v231, v87, v6
    ds_read_b128 v[192:195], v14 offset:16384
    s_waitcnt lgkmcnt(5)
    v_mfma_f32_32x32x16_bf16 v[144:159], v[204:207], a[88:91], v[144:159]
    v_fmac_f32 v92, v220, v4
    v_fmac_f32 v93, v221, v4
    v_fmac_f32 v94, v222, v4
    v_fmac_f32 v95, v223, v4
    v_mfma_f32_32x32x16_bf16 v[160:175], v[204:207], a[92:95], v[160:175]
    v_exp_f32 v228, v228
    ds_read_b128 v[196:199], v14 offset:17408
    s_waitcnt lgkmcnt(5)
    v_mfma_f32_32x32x16_bf16 v[144:159], v[176:179], a[96:99], v[144:159]
    v_exp_f32 v229, v229
    v_exp_f32 v230, v230
    v_mfma_f32_32x32x16_bf16 v[160:175], v[176:179], a[100:103], v[160:175]
    v_exp_f32 v231, v231
    v_mul_f32 v84, v84, v92
    ds_read_b128 v[200:203], v14 offset:18432
    s_waitcnt lgkmcnt(5)
    v_mfma_f32_32x32x16_bf16 v[144:159], v[180:183], a[104:107], v[144:159]
    v_mul_f32 v85, v85, v93
    v_mul_f32 v86, v86, v94
    v_mul_f32 v87, v87, v95
    v_fma_f32 v228, v228, v8, v8
    v_mfma_f32_32x32x16_bf16 v[160:175], v[180:183], a[108:111], v[160:175]
    v_fma_f32 v229, v229, v8, v8
    v_fma_f32 v230, v230, v8, v8
    v_fma_f32 v231, v231, v8, v8
    ds_read_b128 v[204:207], v14 offset:19456
    s_waitcnt lgkmcnt(5)
    v_mfma_f32_32x32x16_bf16 v[144:159], v[184:187], a[112:115], v[144:159]
    v_rcp_f32 v228, v228
    v_rcp_f32 v229, v229
    v_mfma_f32_32x32x16_bf16 v[160:175], v[184:187], a[116:119], v[160:175]
    v_rcp_f32 v230, v230
    ds_read_b128 v[176:179], v14 offset:20480
    s_waitcnt lgkmcnt(5)
    v_mfma_f32_32x32x16_bf16 v[144:159], v[188:191], a[120:123], v[144:159]
    v_rcp_f32 v231, v231
    v_mul_f32 v84, v84, v228
    v_mul_f32 v85, v85, v229
    v_mfma_f32_32x32x16_bf16 v[160:175], v[188:191], a[124:127], v[160:175]
    v_mul_f32 v86, v86, v230
    v_mul_f32 v87, v87, v231
    v_cvt_pk_bf16_f32 v232, v80, v81
    ds_read_b128 v[180:183], v14 offset:21504
    s_waitcnt lgkmcnt(5)
    v_mfma_f32_32x32x16_bf16 v[144:159], v[192:195], a[128:131], v[144:159]
    v_cvt_pk_bf16_f32 v233, v82, v83
    v_cvt_pk_bf16_f32 v234, v84, v85
    v_cvt_pk_bf16_f32 v235, v86, v87
    v_mfma_f32_32x32x16_bf16 v[160:175], v[192:195], a[132:135], v[160:175]
    s_add_u32 s52, s33, 2560
    buffer_store_dwordx4 v[232:235], v2, s[16:19], s52 offen sc1
    v_fmac_f32 v96, v208, v5
    ds_read_b128 v[184:187], v14 offset:22528
    s_waitcnt lgkmcnt(5)
    v_mfma_f32_32x32x16_bf16 v[144:159], v[196:199], a[136:139], v[144:159]
    v_fmac_f32 v97, v209, v5
    v_fmac_f32 v98, v210, v5
    v_fmac_f32 v99, v211, v5
    v_mul_f32 v224, v96, v7
    v_mfma_f32_32x32x16_bf16 v[160:175], v[196:199], a[140:143], v[160:175]
    v_mul_f32 v225, v97, v7
    v_mul_f32 v226, v98, v7
    v_mul_f32 v227, v99, v7
    ds_read_b128 v[188:191], v14 offset:23552
    s_waitcnt lgkmcnt(5)
    v_mfma_f32_32x32x16_bf16 v[144:159], v[200:203], a[144:147], v[144:159]
    v_fmac_f32 v104, v216, v5
    v_fmac_f32 v105, v217, v5
    v_fmac_f32 v106, v218, v5
    v_fmac_f32 v107, v219, v5
    v_mfma_f32_32x32x16_bf16 v[160:175], v[200:203], a[148:151], v[160:175]
    v_exp_f32 v224, v224
    ds_read_b128 v[192:195], v14 offset:24576
    s_waitcnt lgkmcnt(5)
    v_mfma_f32_32x32x16_bf16 v[144:159], v[204:207], a[152:155], v[144:159]
    v_exp_f32 v225, v225
    v_exp_f32 v226, v226
    v_mfma_f32_32x32x16_bf16 v[160:175], v[204:207], a[156:159], v[160:175]
    v_exp_f32 v227, v227
    v_mul_f32 v96, v96, v104
    ds_read_b128 v[196:199], v14 offset:25600
    s_waitcnt lgkmcnt(5)
    v_mfma_f32_32x32x16_bf16 v[144:159], v[176:179], a[160:163], v[144:159]
    v_mul_f32 v97, v97, v105
    v_mul_f32 v98, v98, v106
    v_mul_f32 v99, v99, v107
    v_fma_f32 v224, v224, v9, v9
    v_mfma_f32_32x32x16_bf16 v[160:175], v[176:179], a[164:167], v[160:175]
    v_fma_f32 v225, v225, v9, v9
    v_fma_f32 v226, v226, v9, v9
    v_fma_f32 v227, v227, v9, v9
    ds_read_b128 v[200:203], v14 offset:26624
    s_waitcnt lgkmcnt(5)
    v_mfma_f32_32x32x16_bf16 v[144:159], v[180:183], a[168:171], v[144:159]
    v_rcp_f32 v224, v224
    v_rcp_f32 v225, v225
    v_mfma_f32_32x32x16_bf16 v[160:175], v[180:183], a[172:175], v[160:175]
    v_rcp_f32 v226, v226
    ds_read_b128 v[204:207], v14 offset:27648
    s_waitcnt lgkmcnt(5)
    v_mfma_f32_32x32x16_bf16 v[144:159], v[184:187], a[176:179], v[144:159]
    v_rcp_f32 v227, v227
    v_mul_f32 v96, v96, v224
    v_mul_f32 v97, v97, v225
    v_mfma_f32_32x32x16_bf16 v[160:175], v[184:187], a[180:183], v[160:175]
    v_mul_f32 v98, v98, v226
    v_mul_f32 v99, v99, v227
    v_fmac_f32 v100, v212, v5
    ds_read_b128 v[176:179], v14 offset:28672
    s_waitcnt lgkmcnt(5)
    v_mfma_f32_32x32x16_bf16 v[144:159], v[188:191], a[184:187], v[144:159]
    v_fmac_f32 v101, v213, v5
    v_fmac_f32 v102, v214, v5
    v_fmac_f32 v103, v215, v5
    v_mul_f32 v228, v100, v7
    v_mfma_f32_32x32x16_bf16 v[160:175], v[188:191], a[188:191], v[160:175]
    v_mul_f32 v229, v101, v7
    v_mul_f32 v230, v102, v7
    v_mul_f32 v231, v103, v7
    s_barrier
    ds_read_b128 v[180:183], v14 offset:29696
    s_waitcnt lgkmcnt(5)
    v_mfma_f32_32x32x16_bf16 v[144:159], v[192:195], a[192:195], v[144:159]
    v_fmac_f32 v108, v220, v5
    v_fmac_f32 v109, v221, v5
    v_fmac_f32 v110, v222, v5
    v_fmac_f32 v111, v223, v5
    v_mfma_f32_32x32x16_bf16 v[160:175], v[192:195], a[196:199], v[160:175]
    v_exp_f32 v228, v228
    ds_read_b128 v[184:187], v14 offset:30720
    s_waitcnt lgkmcnt(5)
    v_mfma_f32_32x32x16_bf16 v[144:159], v[196:199], a[200:203], v[144:159]
    v_exp_f32 v229, v229
    v_exp_f32 v230, v230
    v_mfma_f32_32x32x16_bf16 v[160:175], v[196:199], a[204:207], v[160:175]
    v_exp_f32 v231, v231
    v_mul_f32 v100, v100, v108
    ds_read_b128 v[188:191], v14 offset:31744
    s_waitcnt lgkmcnt(5)
    v_mfma_f32_32x32x16_bf16 v[144:159], v[200:203], a[208:211], v[144:159]
    v_mul_f32 v101, v101, v109
    v_mul_f32 v102, v102, v110
    v_mul_f32 v103, v103, v111
    v_fma_f32 v228, v228, v9, v9
    v_mfma_f32_32x32x16_bf16 v[160:175], v[200:203], a[212:215], v[160:175]
    v_fma_f32 v229, v229, v9, v9
    v_fma_f32 v230, v230, v9, v9
    v_fma_f32 v231, v231, v9, v9
    ds_read_b128 v[192:195], v14 offset:32768
    s_waitcnt lgkmcnt(5)
    v_mfma_f32_32x32x16_bf16 v[144:159], v[204:207], a[216:219], v[144:159]
    v_rcp_f32 v228, v228
    v_rcp_f32 v229, v229
    v_mfma_f32_32x32x16_bf16 v[160:175], v[204:207], a[220:223], v[160:175]
    v_rcp_f32 v230, v230
    ds_read_b128 v[196:199], v14 offset:33792
    s_waitcnt lgkmcnt(5)
    v_mfma_f32_32x32x16_bf16 v[144:159], v[176:179], a[224:227], v[144:159]
    v_rcp_f32 v231, v231
    v_mul_f32 v100, v100, v228
    v_mul_f32 v101, v101, v229
    v_mfma_f32_32x32x16_bf16 v[160:175], v[176:179], a[228:231], v[160:175]
    v_mul_f32 v102, v102, v230
    v_mul_f32 v103, v103, v231
    v_cvt_pk_bf16_f32 v236, v96, v97
    ds_read_b128 v[200:203], v14 offset:34816
    s_waitcnt lgkmcnt(5)
    v_mfma_f32_32x32x16_bf16 v[144:159], v[180:183], a[232:235], v[144:159]
    v_cvt_pk_bf16_f32 v237, v98, v99
    v_cvt_pk_bf16_f32 v238, v100, v101
    v_cvt_pk_bf16_f32 v239, v102, v103
    v_mfma_f32_32x32x16_bf16 v[160:175], v[180:183], a[236:239], v[160:175]
    s_add_u32 s53, s33, 297472
    buffer_store_dwordx4 v[236:239], v2, s[16:19], s53 offen sc1
    ds_read_b128 v[204:207], v14 offset:35840
    s_waitcnt lgkmcnt(5)
    v_mfma_f32_32x32x16_bf16 v[144:159], v[184:187], a[240:243], v[144:159]
    s_add_u32 s57, s26, 0
    s_mul_i32 s59, s57, 2304
    v_add_u32 v249, s59, v246
    s_mul_i32 s56, s24, 9
    s_add_u32 s56, s56, s57
    s_lshr_b32 s57, s56, 1
    s_and_b32 s56, s56, 1
    s_lshr_b32 s59, s25, 1
    s_mul_i32 s59, s59, 144
    s_add_u32 s57, s57, s59
    s_mul_i32 s57, s57, 9216
    s_lshl_b32 s59, s56, 9
    s_add_u32 s57, s57, s59
    s_and_b32 s59, s25, 1
    s_lshl_b32 s59, s59, 12
    s_add_u32 s88, s57, s59
    s_add_u32 s89, s88, 4096
    v_mfma_f32_32x32x16_bf16 v[160:175], v[184:187], a[244:247], v[160:175]
    ds_read_b64_tr_b16 v[250:251], v249 offset:0
    ds_read_b64_tr_b16 v[252:253], v249 offset:32
    ds_read_b64_tr_b16 v[254:255], v249 offset:64
    ds_read_b128 v[176:179], v11 offset:0
    s_waitcnt lgkmcnt(8)
    v_mfma_f32_32x32x16_bf16 v[144:159], v[188:191], a[248:251], v[144:159]
    s_waitcnt lgkmcnt(3)
    buffer_store_dwordx2 v[250:251], v247, s[84:87], s88 offen offset:0 sc1
    s_waitcnt lgkmcnt(2)
    buffer_store_dwordx2 v[252:253], v247, s[84:87], s88 offen offset:1024 sc1
    v_mfma_f32_32x32x16_bf16 v[160:175], v[188:191], a[252:255], v[160:175]
    s_waitcnt lgkmcnt(1)
    buffer_store_dwordx2 v[254:255], v247, s[84:87], s88 offen offset:2048 sc1
    ds_read_b64_tr_b16 v[250:251], v249 offset:96
    ds_read_b128 v[180:183], v11 offset:1024
    v_mfma_f32_32x32x16_bf16 v[144:159], v[192:195], v[16:19], v[144:159]
    ds_read_b64_tr_b16 v[252:253], v249 offset:128
    s_waitcnt lgkmcnt(2)
    buffer_store_dwordx2 v[250:251], v247, s[84:87], s88 offen offset:3072 sc1
    v_mfma_f32_32x32x16_bf16 v[160:175], v[192:195], v[20:23], v[160:175]
    s_waitcnt lgkmcnt(0)
    buffer_store_dwordx2 v[252:253], v248, s[84:87], s89 offen sc1
    ds_read_b128 v[184:187], v11 offset:2048
    v_mfma_f32_32x32x16_bf16 v[144:159], v[196:199], v[24:27], v[144:159]
    s_add_u32 s57, s26, 4
    s_mul_i32 s59, s57, 2304
    v_add_u32 v249, s59, v246
    s_mul_i32 s56, s24, 9
    s_add_u32 s56, s56, s57
    s_lshr_b32 s57, s56, 1
    s_and_b32 s56, s56, 1
    s_lshr_b32 s59, s25, 1
    s_mul_i32 s59, s59, 144
    s_add_u32 s57, s57, s59
    s_mul_i32 s57, s57, 9216
    s_lshl_b32 s59, s56, 9
    s_add_u32 s57, s57, s59
    s_and_b32 s59, s25, 1
    s_lshl_b32 s59, s59, 12
    s_add_u32 s88, s57, s59
    s_add_u32 s89, s88, 4096
    v_mfma_f32_32x32x16_bf16 v[160:175], v[196:199], v[28:31], v[160:175]
    ds_read_b64_tr_b16 v[250:251], v249 offset:0
    ds_read_b64_tr_b16 v[252:253], v249 offset:32
    ds_read_b64_tr_b16 v[254:255], v249 offset:64
    ds_read_b128 v[188:191], v11 offset:3072
    v_mfma_f32_32x32x16_bf16 v[144:159], v[200:203], v[32:35], v[144:159]
    s_waitcnt lgkmcnt(3)
    buffer_store_dwordx2 v[250:251], v247, s[84:87], s88 offen offset:0 sc1
    s_waitcnt lgkmcnt(2)
    buffer_store_dwordx2 v[252:253], v247, s[84:87], s88 offen offset:1024 sc1
    v_mfma_f32_32x32x16_bf16 v[160:175], v[200:203], v[36:39], v[160:175]
    s_waitcnt lgkmcnt(1)
    buffer_store_dwordx2 v[254:255], v247, s[84:87], s88 offen offset:2048 sc1
    ds_read_b64_tr_b16 v[250:251], v249 offset:96
    ds_read_b128 v[192:195], v11 offset:4096
    v_mfma_f32_32x32x16_bf16 v[144:159], v[204:207], v[40:43], v[144:159]
    ds_read_b64_tr_b16 v[252:253], v249 offset:128
    s_waitcnt lgkmcnt(2)
    buffer_store_dwordx2 v[250:251], v247, s[84:87], s88 offen offset:3072 sc1
    v_mfma_f32_32x32x16_bf16 v[160:175], v[204:207], v[44:47], v[160:175]
    s_waitcnt lgkmcnt(0)
    buffer_store_dwordx2 v[252:253], v248, s[84:87], s89 offen sc1
    ds_read_b128 v[196:199], v11 offset:5120
    v_mfma_f32_32x32x16_bf16 v[48:63], v[176:179], a[0:3], 0
    s_cmp_eq_u32 s26, 0
    s_cselect_b32 s57, 8, s26
    s_mul_i32 s59, s57, 2304
    v_add_u32 v249, s59, v246
    s_mul_i32 s56, s24, 9
    s_add_u32 s56, s56, s57
    s_lshr_b32 s57, s56, 1
    s_and_b32 s56, s56, 1
    s_lshr_b32 s59, s25, 1
    s_mul_i32 s59, s59, 144
    s_add_u32 s57, s57, s59
    s_mul_i32 s57, s57, 9216
    s_lshl_b32 s59, s56, 9
    s_add_u32 s57, s57, s59
    s_and_b32 s59, s25, 1
    s_lshl_b32 s59, s59, 12
    s_add_u32 s88, s57, s59
    s_add_u32 s89, s88, 4096
    v_mfma_f32_32x32x16_bf16 v[64:79], v[176:179], a[4:7], 0
    ds_read_b64_tr_b16 v[250:251], v249 offset:0
    ds_read_b64_tr_b16 v[252:253], v249 offset:32
    ds_read_b64_tr_b16 v[254:255], v249 offset:64
    ds_read_b128 v[200:203], v11 offset:6144
    v_mfma_f32_32x32x16_bf16 v[48:63], v[180:183], a[8:11], v[48:63]
    s_waitcnt lgkmcnt(3)
    buffer_store_dwordx2 v[250:251], v247, s[84:87], s88 offen offset:0 sc1
    s_waitcnt lgkmcnt(2)
    buffer_store_dwordx2 v[252:253], v247, s[84:87], s88 offen offset:1024 sc1
    v_mfma_f32_32x32x16_bf16 v[64:79], v[180:183], a[12:15], v[64:79]
    s_waitcnt lgkmcnt(1)
    buffer_store_dwordx2 v[254:255], v247, s[84:87], s88 offen offset:2048 sc1
    ds_read_b64_tr_b16 v[250:251], v249 offset:96
    ds_read_b128 v[204:207], v11 offset:7168
    v_mfma_f32_32x32x16_bf16 v[48:63], v[184:187], a[16:19], v[48:63]
    ds_read_b64_tr_b16 v[252:253], v249 offset:128
    s_waitcnt lgkmcnt(2)
    buffer_store_dwordx2 v[250:251], v247, s[84:87], s88 offen offset:3072 sc1
    v_mfma_f32_32x32x16_bf16 v[64:79], v[184:187], a[20:23], v[64:79]
    s_waitcnt lgkmcnt(0)
    buffer_store_dwordx2 v[252:253], v248, s[84:87], s89 offen sc1
    ds_read_b128 v[208:211], v10 offset:768
    ds_read_b128 v[176:179], v11 offset:8192
    v_mfma_f32_32x32x16_bf16 v[48:63], v[188:191], a[24:27], v[48:63]
    ds_read_b128 v[212:215], v10 offset:784
    ds_read_b128 v[216:219], v10 offset:800
    ds_read_b128 v[220:223], v10 offset:816
    s_waitcnt lgkmcnt(0)
    v_mfma_f32_32x32x16_bf16 v[64:79], v[188:191], a[28:31], v[64:79]
    v_fmac_f32 v112, v208, v4
    v_fmac_f32 v113, v209, v4
    v_fmac_f32 v114, v210, v4
    ds_read_b128 v[180:183], v11 offset:9216
    v_mfma_f32_32x32x16_bf16 v[48:63], v[192:195], a[32:35], v[48:63]
    v_fmac_f32 v115, v211, v4
    v_mul_f32 v224, v112, v6
    v_mul_f32 v225, v113, v6
    v_mul_f32 v226, v114, v6
    v_mfma_f32_32x32x16_bf16 v[64:79], v[192:195], a[36:39], v[64:79]
    v_mul_f32 v227, v115, v6
    v_fmac_f32 v120, v216, v4
    v_fmac_f32 v121, v217, v4
    ds_read_b128 v[184:187], v11 offset:10240
    v_mfma_f32_32x32x16_bf16 v[48:63], v[196:199], a[40:43], v[48:63]
    v_fmac_f32 v122, v218, v4
    v_fmac_f32 v123, v219, v4
    v_exp_f32 v224, v224
    v_mfma_f32_32x32x16_bf16 v[64:79], v[196:199], a[44:47], v[64:79]
    v_exp_f32 v225, v225
    s_barrier
    ds_read_b128 v[188:191], v11 offset:11264
    v_mfma_f32_32x32x16_bf16 v[48:63], v[200:203], a[48:51], v[48:63]
    v_exp_f32 v226, v226
    v_exp_f32 v227, v227
    v_mfma_f32_32x32x16_bf16 v[64:79], v[200:203], a[52:55], v[64:79]
    v_mul_f32 v112, v112, v120
    v_mul_f32 v113, v113, v121
    v_mul_f32 v114, v114, v122
    ds_read_b128 v[192:195], v11 offset:12288
    v_mfma_f32_32x32x16_bf16 v[48:63], v[204:207], a[56:59], v[48:63]
    v_mul_f32 v115, v115, v123
    v_fma_f32 v224, v224, v8, v8
    v_fma_f32 v225, v225, v8, v8
    v_fma_f32 v226, v226, v8, v8
    v_mfma_f32_32x32x16_bf16 v[64:79], v[204:207], a[60:63], v[64:79]
    v_fma_f32 v227, v227, v8, v8
    v_rcp_f32 v224, v224
    ds_read_b128 v[196:199], v11 offset:13312
    v_mfma_f32_32x32x16_bf16 v[48:63], v[176:179], a[64:67], v[48:63]
    v_rcp_f32 v225, v225
    v_rcp_f32 v226, v226
    v_mfma_f32_32x32x16_bf16 v[64:79], v[176:179], a[68:71], v[64:79]
    v_rcp_f32 v227, v227
    v_mul_f32 v112, v112, v224
    ds_read_b128 v[200:203], v11 offset:14336
    s_waitcnt lgkmcnt(5)
    v_mfma_f32_32x32x16_bf16 v[48:63], v[180:183], a[72:75], v[48:63]
    v_mul_f32 v113, v113, v225
    v_mul_f32 v114, v114, v226
    v_mul_f32 v115, v115, v227
    v_fmac_f32 v116, v212, v4
    v_mfma_f32_32x32x16_bf16 v[64:79], v[180:183], a[76:79], v[64:79]
    v_fmac_f32 v117, v213, v4
    v_fmac_f32 v118, v214, v4
    v_fmac_f32 v119, v215, v4
    ds_read_b128 v[204:207], v11 offset:15360
    s_waitcnt lgkmcnt(5)
    v_mfma_f32_32x32x16_bf16 v[48:63], v[184:187], a[80:83], v[48:63]
    v_mul_f32 v228, v116, v6
    v_mul_f32 v229, v117, v6
    v_mul_f32 v230, v118, v6
    v_mul_f32 v231, v119, v6
    v_mfma_f32_32x32x16_bf16 v[64:79], v[184:187], a[84:87], v[64:79]
    v_fmac_f32 v124, v220, v4
    v_fmac_f32 v125, v221, v4
    v_fmac_f32 v126, v222, v4
    ds_read_b128 v[176:179], v11 offset:16384
    s_waitcnt lgkmcnt(5)
    v_mfma_f32_32x32x16_bf16 v[48:63], v[188:191], a[88:91], v[48:63]
    v_fmac_f32 v127, v223, v4
    v_exp_f32 v228, v228
    v_mfma_f32_32x32x16_bf16 v[64:79], v[188:191], a[92:95], v[64:79]
    v_exp_f32 v229, v229
    ds_read_b128 v[180:183], v11 offset:17408
    s_waitcnt lgkmcnt(5)
    v_mfma_f32_32x32x16_bf16 v[48:63], v[192:195], a[96:99], v[48:63]
    v_exp_f32 v230, v230
    v_exp_f32 v231, v231
    v_mfma_f32_32x32x16_bf16 v[64:79], v[192:195], a[100:103], v[64:79]
    v_mul_f32 v116, v116, v124
    v_mul_f32 v117, v117, v125
    v_mul_f32 v118, v118, v126
    ds_read_b128 v[184:187], v11 offset:18432
    s_waitcnt lgkmcnt(5)
    v_mfma_f32_32x32x16_bf16 v[48:63], v[196:199], a[104:107], v[48:63]
    v_mul_f32 v119, v119, v127
    v_fma_f32 v228, v228, v8, v8
    v_fma_f32 v229, v229, v8, v8
    v_fma_f32 v230, v230, v8, v8
    v_mfma_f32_32x32x16_bf16 v[64:79], v[196:199], a[108:111], v[64:79]
    v_fma_f32 v231, v231, v8, v8
    v_rcp_f32 v228, v228
    ds_read_b128 v[188:191], v11 offset:19456
    s_waitcnt lgkmcnt(5)
    v_mfma_f32_32x32x16_bf16 v[48:63], v[200:203], a[112:115], v[48:63]
    v_rcp_f32 v229, v229
    v_rcp_f32 v230, v230
    v_mfma_f32_32x32x16_bf16 v[64:79], v[200:203], a[116:119], v[64:79]
    v_rcp_f32 v231, v231
    v_mul_f32 v116, v116, v228
    ds_read_b128 v[192:195], v11 offset:20480
    s_waitcnt lgkmcnt(5)
    v_mfma_f32_32x32x16_bf16 v[48:63], v[204:207], a[120:123], v[48:63]
    v_mul_f32 v117, v117, v229
    v_mul_f32 v118, v118, v230
    v_mul_f32 v119, v119, v231
    v_cvt_pk_bf16_f32 v232, v112, v113
    v_mfma_f32_32x32x16_bf16 v[64:79], v[204:207], a[124:127], v[64:79]
    v_cvt_pk_bf16_f32 v233, v114, v115
    v_cvt_pk_bf16_f32 v234, v116, v117
    v_cvt_pk_bf16_f32 v235, v118, v119
    ds_read_b128 v[196:199], v11 offset:21504
    s_waitcnt lgkmcnt(5)
    v_mfma_f32_32x32x16_bf16 v[48:63], v[176:179], a[128:131], v[48:63]
    s_add_u32 s52, s33, 3072
    buffer_store_dwordx4 v[232:235], v2, s[16:19], s52 offen sc1
    v_fmac_f32 v128, v208, v5
    v_fmac_f32 v129, v209, v5
    v_mfma_f32_32x32x16_bf16 v[64:79], v[176:179], a[132:135], v[64:79]
    v_fmac_f32 v130, v210, v5
    v_fmac_f32 v131, v211, v5
    v_mul_f32 v224, v128, v7
    ds_read_b128 v[200:203], v11 offset:22528
    s_waitcnt lgkmcnt(5)
    v_mfma_f32_32x32x16_bf16 v[48:63], v[180:183], a[136:139], v[48:63]
    v_mul_f32 v225, v129, v7
    v_mul_f32 v226, v130, v7
    v_mul_f32 v227, v131, v7
    v_fmac_f32 v136, v216, v5
    v_mfma_f32_32x32x16_bf16 v[64:79], v[180:183], a[140:143], v[64:79]
    v_fmac_f32 v137, v217, v5
    v_fmac_f32 v138, v218, v5
    v_fmac_f32 v139, v219, v5
    ds_read_b128 v[204:207], v11 offset:23552
    s_waitcnt lgkmcnt(5)
    v_mfma_f32_32x32x16_bf16 v[48:63], v[184:187], a[144:147], v[48:63]
    v_exp_f32 v224, v224
    v_exp_f32 v225, v225
    v_mfma_f32_32x32x16_bf16 v[64:79], v[184:187], a[148:151], v[64:79]
    v_exp_f32 v226, v226
    ds_read_b128 v[176:179], v11 offset:24576
    s_waitcnt lgkmcnt(5)
    v_mfma_f32_32x32x16_bf16 v[48:63], v[188:191], a[152:155], v[48:63]
    v_exp_f32 v227, v227
    v_mul_f32 v128, v128, v136
    v_mul_f32 v129, v129, v137
    v_mfma_f32_32x32x16_bf16 v[64:79], v[188:191], a[156:159], v[64:79]
    v_mul_f32 v130, v130, v138
    v_mul_f32 v131, v131, v139
    v_fma_f32 v224, v224, v9, v9
    ds_read_b128 v[180:183], v11 offset:25600
    s_waitcnt lgkmcnt(5)
    v_mfma_f32_32x32x16_bf16 v[48:63], v[192:195], a[160:163], v[48:63]
    v_fma_f32 v225, v225, v9, v9
    v_fma_f32 v226, v226, v9, v9
    v_fma_f32 v227, v227, v9, v9
    v_mfma_f32_32x32x16_bf16 v[64:79], v[192:195], a[164:167], v[64:79]
    v_rcp_f32 v224, v224
    ds_read_b128 v[184:187], v11 offset:26624
    s_waitcnt lgkmcnt(5)
    v_mfma_f32_32x32x16_bf16 v[48:63], v[196:199], a[168:171], v[48:63]
    v_rcp_f32 v225, v225
    v_rcp_f32 v226, v226
    v_mfma_f32_32x32x16_bf16 v[64:79], v[196:199], a[172:175], v[64:79]
    v_rcp_f32 v227, v227
    v_mul_f32 v128, v128, v224
    ds_read_b128 v[188:191], v11 offset:27648
    s_waitcnt lgkmcnt(5)
    v_mfma_f32_32x32x16_bf16 v[48:63], v[200:203], a[176:179], v[48:63]
    v_mul_f32 v129, v129, v225
    v_mul_f32 v130, v130, v226
    v_mul_f32 v131, v131, v227
    v_fmac_f32 v132, v212, v5
    v_mfma_f32_32x32x16_bf16 v[64:79], v[200:203], a[180:183], v[64:79]
    v_fmac_f32 v133, v213, v5
    v_fmac_f32 v134, v214, v5
    v_fmac_f32 v135, v215, v5
    ds_read_b128 v[192:195], v11 offset:28672
    s_waitcnt lgkmcnt(5)
    v_mfma_f32_32x32x16_bf16 v[48:63], v[204:207], a[184:187], v[48:63]
    v_mul_f32 v228, v132, v7
    v_mul_f32 v229, v133, v7
    v_mul_f32 v230, v134, v7
    v_mul_f32 v231, v135, v7
    v_mfma_f32_32x32x16_bf16 v[64:79], v[204:207], a[188:191], v[64:79]
    v_fmac_f32 v140, v220, v5
    v_fmac_f32 v141, v221, v5
    v_fmac_f32 v142, v222, v5
    s_barrier
    ds_read_b128 v[196:199], v11 offset:29696
    s_waitcnt lgkmcnt(5)
    v_mfma_f32_32x32x16_bf16 v[48:63], v[176:179], a[192:195], v[48:63]
    v_fmac_f32 v143, v223, v5
    v_exp_f32 v228, v228
    v_mfma_f32_32x32x16_bf16 v[64:79], v[176:179], a[196:199], v[64:79]
    v_exp_f32 v229, v229
    ds_read_b128 v[200:203], v11 offset:30720
    s_waitcnt lgkmcnt(5)
    v_mfma_f32_32x32x16_bf16 v[48:63], v[180:183], a[200:203], v[48:63]
    v_exp_f32 v230, v230
    v_exp_f32 v231, v231
    v_mfma_f32_32x32x16_bf16 v[64:79], v[180:183], a[204:207], v[64:79]
    v_mul_f32 v132, v132, v140
    v_mul_f32 v133, v133, v141
    v_mul_f32 v134, v134, v142
    ds_read_b128 v[204:207], v11 offset:31744
    s_waitcnt lgkmcnt(5)
    v_mfma_f32_32x32x16_bf16 v[48:63], v[184:187], a[208:211], v[48:63]
    v_mul_f32 v135, v135, v143
    v_fma_f32 v228, v228, v9, v9
    v_fma_f32 v229, v229, v9, v9
    v_fma_f32 v230, v230, v9, v9
    v_mfma_f32_32x32x16_bf16 v[64:79], v[184:187], a[212:215], v[64:79]
    v_fma_f32 v231, v231, v9, v9
    v_rcp_f32 v228, v228
    ds_read_b128 v[176:179], v11 offset:32768
    s_waitcnt lgkmcnt(5)
    v_mfma_f32_32x32x16_bf16 v[48:63], v[188:191], a[216:219], v[48:63]
    v_rcp_f32 v229, v229
    v_rcp_f32 v230, v230
    v_mfma_f32_32x32x16_bf16 v[64:79], v[188:191], a[220:223], v[64:79]
    v_rcp_f32 v231, v231
    v_mul_f32 v132, v132, v228
    ds_read_b128 v[180:183], v11 offset:33792
    s_waitcnt lgkmcnt(5)
    v_mfma_f32_32x32x16_bf16 v[48:63], v[192:195], a[224:227], v[48:63]
    v_mul_f32 v133, v133, v229
    v_mul_f32 v134, v134, v230
    v_mul_f32 v135, v135, v231
    v_cvt_pk_bf16_f32 v236, v128, v129
    v_mfma_f32_32x32x16_bf16 v[64:79], v[192:195], a[228:231], v[64:79]
    v_cvt_pk_bf16_f32 v237, v130, v131
    v_cvt_pk_bf16_f32 v238, v132, v133
    v_cvt_pk_bf16_f32 v239, v134, v135
    ds_read_b128 v[184:187], v11 offset:34816
    s_waitcnt lgkmcnt(5)
    v_mfma_f32_32x32x16_bf16 v[48:63], v[196:199], a[232:235], v[48:63]
    s_add_u32 s53, s33, 297984
    buffer_store_dwordx4 v[236:239], v2, s[16:19], s53 offen sc1
    ds_read_b128 v[208:211], v10 offset:896
    ds_read_b128 v[212:215], v10 offset:912
    v_mfma_f32_32x32x16_bf16 v[64:79], v[196:199], a[236:239], v[64:79]
    ds_read_b128 v[216:219], v10 offset:928
    ds_read_b128 v[220:223], v10 offset:944
    s_waitcnt lgkmcnt(0)
    ds_read_b128 v[188:191], v11 offset:35840
    v_mfma_f32_32x32x16_bf16 v[48:63], v[200:203], a[240:243], v[48:63]
    v_fmac_f32 v144, v208, v4
    v_fmac_f32 v145, v209, v4
    v_fmac_f32 v146, v210, v4
    v_fmac_f32 v147, v211, v4
    v_mfma_f32_32x32x16_bf16 v[64:79], v[200:203], a[244:247], v[64:79]
    v_mul_f32 v224, v144, v6
    v_mul_f32 v225, v145, v6
    v_mul_f32 v226, v146, v6
    v_mfma_f32_32x32x16_bf16 v[48:63], v[204:207], a[248:251], v[48:63]
    v_mul_f32 v227, v147, v6
    v_fmac_f32 v152, v216, v4
    v_fmac_f32 v153, v217, v4
    v_fmac_f32 v154, v218, v4
    v_mfma_f32_32x32x16_bf16 v[64:79], v[204:207], a[252:255], v[64:79]
    v_fmac_f32 v155, v219, v4
    v_exp_f32 v224, v224
    v_mfma_f32_32x32x16_bf16 v[48:63], v[176:179], v[16:19], v[48:63]
    v_exp_f32 v225, v225
    v_exp_f32 v226, v226
    v_mfma_f32_32x32x16_bf16 v[64:79], v[176:179], v[20:23], v[64:79]
    v_exp_f32 v227, v227
    v_mul_f32 v144, v144, v152
    v_mfma_f32_32x32x16_bf16 v[48:63], v[180:183], v[24:27], v[48:63]
    v_mul_f32 v145, v145, v153
    v_mul_f32 v146, v146, v154
    v_mul_f32 v147, v147, v155
    v_fma_f32 v224, v224, v8, v8
    v_mfma_f32_32x32x16_bf16 v[64:79], v[180:183], v[28:31], v[64:79]
    v_fma_f32 v225, v225, v8, v8
    v_fma_f32 v226, v226, v8, v8
    v_fma_f32 v227, v227, v8, v8
    v_mfma_f32_32x32x16_bf16 v[48:63], v[184:187], v[32:35], v[48:63]
    v_rcp_f32 v224, v224
    v_rcp_f32 v225, v225
    v_mfma_f32_32x32x16_bf16 v[64:79], v[184:187], v[36:39], v[64:79]
    v_rcp_f32 v226, v226
    s_waitcnt lgkmcnt(0)
    v_mfma_f32_32x32x16_bf16 v[48:63], v[188:191], v[40:43], v[48:63]
    v_rcp_f32 v227, v227
    v_mul_f32 v144, v144, v224
    v_mul_f32 v145, v145, v225
    v_mfma_f32_32x32x16_bf16 v[64:79], v[188:191], v[44:47], v[64:79]
    v_mul_f32 v146, v146, v226
    v_mul_f32 v147, v147, v227
    v_fmac_f32 v148, v212, v4
    v_fmac_f32 v149, v213, v4
    v_fmac_f32 v150, v214, v4
    v_fmac_f32 v151, v215, v4
    v_mul_f32 v228, v148, v6
    v_mul_f32 v229, v149, v6
    v_mul_f32 v230, v150, v6
    v_mul_f32 v231, v151, v6
    v_fmac_f32 v156, v220, v4
    v_fmac_f32 v157, v221, v4
    v_fmac_f32 v158, v222, v4
    v_fmac_f32 v159, v223, v4
    v_exp_f32 v228, v228
    v_exp_f32 v229, v229
    v_exp_f32 v230, v230
    v_exp_f32 v231, v231
    v_mul_f32 v148, v148, v156
    v_mul_f32 v149, v149, v157
    v_mul_f32 v150, v150, v158
    v_mul_f32 v151, v151, v159
    v_fma_f32 v228, v228, v8, v8
    v_fma_f32 v229, v229, v8, v8
    v_fma_f32 v230, v230, v8, v8
    v_fma_f32 v231, v231, v8, v8
    v_rcp_f32 v228, v228
    v_rcp_f32 v229, v229
    v_rcp_f32 v230, v230
    v_rcp_f32 v231, v231
    v_mul_f32 v148, v148, v228
    v_mul_f32 v149, v149, v229
    v_mul_f32 v150, v150, v230
    v_mul_f32 v151, v151, v231
    v_cvt_pk_bf16_f32 v232, v144, v145
    v_cvt_pk_bf16_f32 v233, v146, v147
    v_cvt_pk_bf16_f32 v234, v148, v149
    v_cvt_pk_bf16_f32 v235, v150, v151
    s_add_u32 s52, s33, 3584
    buffer_store_dwordx4 v[232:235], v2, s[16:19], s52 offen sc1
    v_fmac_f32 v160, v208, v5
    v_fmac_f32 v161, v209, v5
    v_fmac_f32 v162, v210, v5
    v_fmac_f32 v163, v211, v5
    v_mul_f32 v224, v160, v7
    v_mul_f32 v225, v161, v7
    v_mul_f32 v226, v162, v7
    v_mul_f32 v227, v163, v7
    v_fmac_f32 v168, v216, v5
    v_fmac_f32 v169, v217, v5
    v_fmac_f32 v170, v218, v5
    v_fmac_f32 v171, v219, v5
    v_exp_f32 v224, v224
    v_exp_f32 v225, v225
    v_exp_f32 v226, v226
    v_exp_f32 v227, v227
    v_mul_f32 v160, v160, v168
    v_mul_f32 v161, v161, v169
    v_mul_f32 v162, v162, v170
    v_mul_f32 v163, v163, v171
    v_fma_f32 v224, v224, v9, v9
    v_fma_f32 v225, v225, v9, v9
    v_fma_f32 v226, v226, v9, v9
    v_fma_f32 v227, v227, v9, v9
    v_rcp_f32 v224, v224
    v_rcp_f32 v225, v225
    v_rcp_f32 v226, v226
    v_rcp_f32 v227, v227
    v_mul_f32 v160, v160, v224
    v_mul_f32 v161, v161, v225
    v_mul_f32 v162, v162, v226
    v_mul_f32 v163, v163, v227
    v_fmac_f32 v164, v212, v5
    v_fmac_f32 v165, v213, v5
    v_fmac_f32 v166, v214, v5
    v_fmac_f32 v167, v215, v5
    v_mul_f32 v228, v164, v7
    v_mul_f32 v229, v165, v7
    v_mul_f32 v230, v166, v7
    v_mul_f32 v231, v167, v7
    v_fmac_f32 v172, v220, v5
    v_fmac_f32 v173, v221, v5
    v_fmac_f32 v174, v222, v5
    v_fmac_f32 v175, v223, v5
    v_exp_f32 v228, v228
    v_exp_f32 v229, v229
    v_exp_f32 v230, v230
    v_exp_f32 v231, v231
    v_mul_f32 v164, v164, v172
    v_mul_f32 v165, v165, v173
    v_mul_f32 v166, v166, v174
    v_mul_f32 v167, v167, v175
    v_fma_f32 v228, v228, v9, v9
    v_fma_f32 v229, v229, v9, v9
    v_fma_f32 v230, v230, v9, v9
    v_fma_f32 v231, v231, v9, v9
    v_rcp_f32 v228, v228
    v_rcp_f32 v229, v229
    v_rcp_f32 v230, v230
    v_rcp_f32 v231, v231
    v_mul_f32 v164, v164, v228
    v_mul_f32 v165, v165, v229
    v_mul_f32 v166, v166, v230
    v_mul_f32 v167, v167, v231
    v_cvt_pk_bf16_f32 v236, v160, v161
    v_cvt_pk_bf16_f32 v237, v162, v163
    v_cvt_pk_bf16_f32 v238, v164, v165
    v_cvt_pk_bf16_f32 v239, v166, v167
    s_add_u32 s53, s33, 298496
    buffer_store_dwordx4 v[236:239], v2, s[16:19], s53 offen sc1
    ds_read_b128 v[208:211], v10 offset:1024
    ds_read_b128 v[212:215], v10 offset:1040
    ds_read_b128 v[216:219], v10 offset:1056
    ds_read_b128 v[220:223], v10 offset:1072
    s_waitcnt lgkmcnt(0)
    v_fmac_f32 v48, v208, v4
    v_fmac_f32 v49, v209, v4
    v_fmac_f32 v50, v210, v4
    v_fmac_f32 v51, v211, v4
    v_mul_f32 v224, v48, v6
    v_mul_f32 v225, v49, v6
    v_mul_f32 v226, v50, v6
    v_mul_f32 v227, v51, v6
    v_fmac_f32 v56, v216, v4
    v_fmac_f32 v57, v217, v4
    v_fmac_f32 v58, v218, v4
    v_fmac_f32 v59, v219, v4
    v_exp_f32 v224, v224
    v_exp_f32 v225, v225
    v_exp_f32 v226, v226
    v_exp_f32 v227, v227
    v_mul_f32 v48, v48, v56
    v_mul_f32 v49, v49, v57
    v_mul_f32 v50, v50, v58
    v_mul_f32 v51, v51, v59
    v_fma_f32 v224, v224, v8, v8
    v_fma_f32 v225, v225, v8, v8
    v_fma_f32 v226, v226, v8, v8
    v_fma_f32 v227, v227, v8, v8
    v_rcp_f32 v224, v224
    v_rcp_f32 v225, v225
    v_rcp_f32 v226, v226
    v_rcp_f32 v227, v227
    v_mul_f32 v48, v48, v224
    v_mul_f32 v49, v49, v225
    v_mul_f32 v50, v50, v226
    v_mul_f32 v51, v51, v227
    v_fmac_f32 v52, v212, v4
    v_fmac_f32 v53, v213, v4
    v_fmac_f32 v54, v214, v4
    v_fmac_f32 v55, v215, v4
    v_mul_f32 v228, v52, v6
    v_mul_f32 v229, v53, v6
    v_mul_f32 v230, v54, v6
    v_mul_f32 v231, v55, v6
    v_fmac_f32 v60, v220, v4
    v_fmac_f32 v61, v221, v4
    v_fmac_f32 v62, v222, v4
    v_fmac_f32 v63, v223, v4
    v_exp_f32 v228, v228
    v_exp_f32 v229, v229
    v_exp_f32 v230, v230
    v_exp_f32 v231, v231
    v_mul_f32 v52, v52, v60
    v_mul_f32 v53, v53, v61
    v_mul_f32 v54, v54, v62
    v_mul_f32 v55, v55, v63
    v_fma_f32 v228, v228, v8, v8
    v_fma_f32 v229, v229, v8, v8
    v_fma_f32 v230, v230, v8, v8
    v_fma_f32 v231, v231, v8, v8
    v_rcp_f32 v228, v228
    v_rcp_f32 v229, v229
    v_rcp_f32 v230, v230
    v_rcp_f32 v231, v231
    v_mul_f32 v52, v52, v228
    v_mul_f32 v53, v53, v229
    v_mul_f32 v54, v54, v230
    v_mul_f32 v55, v55, v231
    v_cvt_pk_bf16_f32 v232, v48, v49
    v_cvt_pk_bf16_f32 v233, v50, v51
    v_cvt_pk_bf16_f32 v234, v52, v53
    v_cvt_pk_bf16_f32 v235, v54, v55
    s_add_u32 s52, s33, 4096
    buffer_store_dwordx4 v[232:235], v2, s[16:19], s52 offen sc1
    v_fmac_f32 v64, v208, v5
    v_fmac_f32 v65, v209, v5
    v_fmac_f32 v66, v210, v5
    v_fmac_f32 v67, v211, v5
    v_mul_f32 v224, v64, v7
    v_mul_f32 v225, v65, v7
    v_mul_f32 v226, v66, v7
    v_mul_f32 v227, v67, v7
    v_fmac_f32 v72, v216, v5
    v_fmac_f32 v73, v217, v5
    v_fmac_f32 v74, v218, v5
    v_fmac_f32 v75, v219, v5
    v_exp_f32 v224, v224
    v_exp_f32 v225, v225
    v_exp_f32 v226, v226
    v_exp_f32 v227, v227
    v_mul_f32 v64, v64, v72
    v_mul_f32 v65, v65, v73
    v_mul_f32 v66, v66, v74
    v_mul_f32 v67, v67, v75
    v_fma_f32 v224, v224, v9, v9
    v_fma_f32 v225, v225, v9, v9
    v_fma_f32 v226, v226, v9, v9
    v_fma_f32 v227, v227, v9, v9
    v_rcp_f32 v224, v224
    v_rcp_f32 v225, v225
    v_rcp_f32 v226, v226
    v_rcp_f32 v227, v227
    v_mul_f32 v64, v64, v224
    v_mul_f32 v65, v65, v225
    v_mul_f32 v66, v66, v226
    v_mul_f32 v67, v67, v227
    v_fmac_f32 v68, v212, v5
    v_fmac_f32 v69, v213, v5
    v_fmac_f32 v70, v214, v5
    v_fmac_f32 v71, v215, v5
    v_mul_f32 v228, v68, v7
    v_mul_f32 v229, v69, v7
    v_mul_f32 v230, v70, v7
    v_mul_f32 v231, v71, v7
    v_fmac_f32 v76, v220, v5
    v_fmac_f32 v77, v221, v5
    v_fmac_f32 v78, v222, v5
    v_fmac_f32 v79, v223, v5
    v_exp_f32 v228, v228
    v_exp_f32 v229, v229
    v_exp_f32 v230, v230
    v_exp_f32 v231, v231
    v_mul_f32 v68, v68, v76
    v_mul_f32 v69, v69, v77
    v_mul_f32 v70, v70, v78
    v_mul_f32 v71, v71, v79
    v_fma_f32 v228, v228, v9, v9
    v_fma_f32 v229, v229, v9, v9
    v_fma_f32 v230, v230, v9, v9
    v_fma_f32 v231, v231, v9, v9
    v_rcp_f32 v228, v228
    v_rcp_f32 v229, v229
    v_rcp_f32 v230, v230
    v_rcp_f32 v231, v231
    v_mul_f32 v68, v68, v228
    v_mul_f32 v69, v69, v229
    v_mul_f32 v70, v70, v230
    v_mul_f32 v71, v71, v231
    v_cvt_pk_bf16_f32 v236, v64, v65
    v_cvt_pk_bf16_f32 v237, v66, v67
    v_cvt_pk_bf16_f32 v238, v68, v69
    v_cvt_pk_bf16_f32 v239, v70, v71
    s_add_u32 s53, s33, 299008
    buffer_store_dwordx4 v[236:239], v2, s[16:19], s53 offen sc1
k3_kernel_end:
    s_endpgm
.globl k4_kernel
.p2align 8
.type k4_kernel,@function
k4_kernel:
    s_cmp_ge_u32 s2, 256
    s_cbranch_scc1 k4_kernel_end
    s_getpc_b64 s[16:17]
k4_kernel_pc:
    v_lshlrev_b32 v230, 7, v0
    v_min_u32 v230, k4_kernel_end-k4_kernel_pc, v230
    global_load_dword v231, v230, s[16:17]
    s_load_dwordx2 s[4:5], s[0:1], 72
    s_and_b32 s22, s2, 3
    s_bfe_u32 s23, s2, 0x10002
    s_lshl_b32 s23, s23, 3
    s_lshr_b32 s25, s2, 5
    s_add_u32 s25, s25, s23
    s_bfe_u32 s24, s2, 0x20003
    v_lshrrev_b32 v1, 6, v0
    v_and_b32 v0, 63, v0
    v_readfirstlane_b32 s26, v1
    v_lshlrev_b32 v2, 4, v0
    v_add_u32 v3, 36864, v2
    s_waitcnt lgkmcnt(0)
    s_add_u32 s8, s4, 0x1200000
    s_addc_u32 s9, s5, 0
    s_mov_b32 s10, 0x1200000
    s_mov_b32 s11, 0x20000
    s_add_u32 s12, s4, 0x2400000
    s_addc_u32 s13, s5, 0
    s_mov_b32 s14, 0x510000
    s_mov_b32 s15, 0x20000
    s_add_u32 s16, s4, 0x3800000
    s_addc_u32 s17, s5, 0
    s_mov_b32 s18, 0x900000
    s_mov_b32 s19, 0x20000
    s_add_u32 s44, s4, 0x4c0000
    s_addc_u32 s45, s5, 0
    s_mov_b32 s46, 0x240000
    s_mov_b32 s47, 0x20000
    s_lshl_b32 s28, s25, 3
    s_lshl_b32 s29, s26, 1
    s_add_u32 s28, s28, s29
    s_mul_i32 s28, s28, 144
    s_mul_i32 s29, s22, 36
    s_add_u32 s28, s28, s29
    s_lshl_b32 s30, s28, 10
    s_mul_i32 s31, s24, 144
    s_add_u32 s31, s31, s29
    s_mul_i32 s31, s31, 9216
    s_lshl_b32 s32, s26, 10
    s_add_u32 s31, s31, s32
    s_cmp_lt_u32 s26, 2
    s_cselect_b32 s27, 0, 0x7f000000
    v_add_u32 v4, s27, v2
    s_cselect_b32 s27, 16384, 0
    s_add_u32 s34, s31, 16384
    s_add_u32 m0, s32, 16384
    s_cmp_ge_u32 s26, 2
    s_cbranch_scc1 k4_kernel_skip5_1
    buffer_load_dwordx4 v2, s[12:15], s34 offen lds
k4_kernel_skip5_1:
    s_add_u32 s35, s31, 0
    s_add_u32 m0, s32, 0
    s_nop 0
    buffer_load_dwordx4 v2, s[12:15], s35 offen lds
    s_add_u32 s36, s31, 4096
    s_add_u32 m0, s32, 4096
    s_nop 0
    buffer_load_dwordx4 v2, s[12:15], s36 offen lds
    s_add_u32 s37, s31, 8192
    s_add_u32 m0, s32, 8192
    s_nop 0
    buffer_load_dwordx4 v2, s[12:15], s37 offen lds
    s_add_u32 s38, s31, 12288
    s_add_u32 m0, s32, 12288
    s_nop 0
    buffer_load_dwordx4 v2, s[12:15], s38 offen lds
    s_add_u32 s33, s30, 0
    buffer_load_dwordx4 v[16:19], v2, s[8:11], s33 offen
    s_add_u32 s34, s30, 147456
    buffer_load_dwordx4 v[20:23], v2, s[8:11], s34 offen
    s_add_u32 s35, s30, 1024
    buffer_load_dwordx4 v[24:27], v2, s[8:11], s35 offen
    s_add_u32 s36, s30, 148480
    buffer_load_dwordx4 v[28:31], v2, s[8:11], s36 offen
    s_add_u32 s37, s31, 34816
    s_add_u32 m0, s32, 34816
    s_cmp_ge_u32 s26, 2
    s_cbranch_scc1 k4_kernel_skip5_2
    buffer_load_dwordx4 v2, s[12:15], s37 offen lds
k4_kernel_skip5_2:
    s_add_u32 s38, s31, 18432
    s_add_u32 m0, s32, 18432
    s_nop 0
    buffer_load_dwordx4 v2, s[12:15], s38 offen lds
    s_add_u32 s33, s31, 22528
    s_add_u32 m0, s32, 22528
    s_nop 0
    buffer_load_dwordx4 v2, s[12:15], s33 offen lds
    s_add_u32 s34, s31, 26624
    s_add_u32 m0, s32, 26624
    s_nop 0
    buffer_load_dwordx4 v2, s[12:15], s34 offen lds
    s_add_u32 s35, s31, 30720
    s_add_u32 m0, s32, 30720
    s_nop 0
    buffer_load_dwordx4 v2, s[12:15], s35 offen lds
    s_add_u32 s36, s30, 2048
    buffer_load_dwordx4 v[32:35], v2, s[8:11], s36 offen
    s_add_u32 s37, s30, 149504
    buffer_load_dwordx4 v[36:39], v2, s[8:11], s37 offen
    s_add_u32 s38, s30, 3072
    buffer_load_dwordx4 v[40:43], v2, s[8:11], s38 offen
    s_add_u32 s33, s30, 150528
    buffer_load_dwordx4 v[44:47], v2, s[8:11], s33 offen
    s_add_u32 s34, s31, 53248
    s_add_u32 m0, s32, 53248
    s_cmp_ge_u32 s26, 2
    s_cbranch_scc1 k4_kernel_skip5_3
    buffer_load_dwordx4 v2, s[12:15], s34 offen lds
k4_kernel_skip5_3:
    s_add_u32 s35, s31, 36864
    s_add_u32 m0, s32, 36864
    s_nop 0
    buffer_load_dwordx4 v2, s[12:15], s35 offen lds
    s_add_u32 s36, s31, 40960
    s_add_u32 m0, s32, 40960
    s_nop 0
    buffer_load_dwordx4 v2, s[12:15], s36 offen lds
    s_add_u32 s37, s31, 45056
    s_add_u32 m0, s32, 45056
    s_nop 0
    buffer_load_dwordx4 v2, s[12:15], s37 offen lds
    s_add_u32 s38, s31, 49152
    s_add_u32 m0, s32, 49152
    s_nop 0
    buffer_load_dwordx4 v2, s[12:15], s38 offen lds
    s_add_u32 s33, s30, 4096
    buffer_load_dwordx4 v[48:51], v2, s[8:11], s33 offen
    s_add_u32 s34, s30, 151552
    buffer_load_dwordx4 v[52:55], v2, s[8:11], s34 offen
    s_add_u32 s35, s30, 5120
    buffer_load_dwordx4 v[56:59], v2, s[8:11], s35 offen
    s_add_u32 s36, s30, 152576
    buffer_load_dwordx4 v[60:63], v2, s[8:11], s36 offen
    s_mul_i32 s40, s26, 9728
    s_add_u32 s40, s40, 73728
    v_lshrrev_b32 v8, 4, v0
    v_and_b32 v7, 15, v0
    v_mul_u32_u24 v7, 304, v7
    v_lshl_add_u32 v7, v8, 3, v7
    v_add_u32 v7, s40, v7
    s_mov_b32 s29, 0xe38e38f
    v_add_u32 v8, 0, v0
    v_mul_hi_u32 v9, v8, s29
    v_mul_u32_u24 v10, 18, v9
    v_sub_u32 v10, v8, v10
    v_lshlrev_b32 v10, 4, v10
    v_mul_u32_u24 v11, 304, v9
    v_add3_u32 v204, v11, v10, s40
    v_mul_u32_u24 v11, 1152, v9
    v_add_u32 v213, v11, v10
    v_add_u32 v8, 64, v0
    v_mul_hi_u32 v9, v8, s29
    v_mul_u32_u24 v10, 18, v9
    v_sub_u32 v10, v8, v10
    v_lshlrev_b32 v10, 4, v10
    v_mul_u32_u24 v11, 304, v9
    v_add3_u32 v205, v11, v10, s40
    v_mul_u32_u24 v11, 1152, v9
    v_add_u32 v214, v11, v10
    v_add_u32 v8, 128, v0
    v_mul_hi_u32 v9, v8, s29
    v_mul_u32_u24 v10, 18, v9
    v_sub_u32 v10, v8, v10
    v_lshlrev_b32 v10, 4, v10
    v_mul_u32_u24 v11, 304, v9
    v_add3_u32 v206, v11, v10, s40
    v_mul_u32_u24 v11, 1152, v9
    v_add_u32 v215, v11, v10
    v_add_u32 v8, 192, v0
    v_mul_hi_u32 v9, v8, s29
    v_mul_u32_u24 v10, 18, v9
    v_sub_u32 v10, v8, v10
    v_lshlrev_b32 v10, 4, v10
    v_mul_u32_u24 v11, 304, v9
    v_add3_u32 v207, v11, v10, s40
    v_mul_u32_u24 v11, 1152, v9
    v_add_u32 v216, v11, v10
    v_add_u32 v8, 256, v0
    v_mul_hi_u32 v9, v8, s29
    v_mul_u32_u24 v10, 18, v9
    v_sub_u32 v10, v8, v10
    v_lshlrev_b32 v10, 4, v10
    v_mul_u32_u24 v11, 304, v9
    v_add3_u32 v208, v11, v10, s40
    v_mul_u32_u24 v11, 1152, v9
    v_add_u32 v217, v11, v10
    v_add_u32 v8, 320, v0
    v_mul_hi_u32 v9, v8, s29
    v_mul_u32_u24 v10, 18, v9
    v_sub_u32 v10, v8, v10
    v_lshlrev_b32 v10, 4, v10
    v_mul_u32_u24 v11, 304, v9
    v_add3_u32 v209, v11, v10, s40
    v_mul_u32_u24 v11, 1152, v9
    v_add_u32 v218, v11, v10
    v_add_u32 v8, 384, v0
    v_mul_hi_u32 v9, v8, s29
    v_mul_u32_u24 v10, 18, v9
    v_sub_u32 v10, v8, v10
    v_lshlrev_b32 v10, 4, v10
    v_mul_u32_u24 v11, 304, v9
    v_add3_u32 v210, v11, v10, s40
    v_mul_u32_u24 v11, 1152, v9
    v_add_u32 v219, v11, v10
    v_add_u32 v8, 448, v0
    v_mul_hi_u32 v9, v8, s29
    v_mul_u32_u24 v10, 18, v9
    v_sub_u32 v10, v8, v10
    v_lshlrev_b32 v10, 4, v10
    v_mul_u32_u24 v11, 304, v9
    v_add3_u32 v211, v11, v10, s40
    v_mul_u32_u24 v11, 1152, v9
    v_add_u32 v220, v11, v10
    v_add_u32 v8, 512, v0
    v_mul_hi_u32 v9, v8, s29
    v_mul_u32_u24 v10, 18, v9
    v_sub_u32 v10, v8, v10
    v_lshlrev_b32 v10, 4, v10
    v_mul_u32_u24 v11, 304, v9
    v_add3_u32 v212, v11, v10, s40
    v_mul_u32_u24 v11, 1152, v9
    v_add_u32 v221, v11, v10
    s_lshl_b32 s28, s22, 11
    s_lshl_b32 s29, s25, 7
    s_add_u32 s28, s28, s29
    s_lshl_b32 s29, s26, 5
    s_add_u32 s28, s28, s29
    s_mul_i32 s28, s28, 1152
    s_mul_i32 s29, s24, 288
    s_add_u32 s41, s28, s29
    s_waitcnt vmcnt(20)
    s_barrier
    s_waitcnt vmcnt(18)
    ds_read_b128 v[80:83], v2 offset:0
    ds_read_b128 v[84:87], v2 offset:1024
    ds_read_b128 v[88:91], v2 offset:2048
    ds_read_b128 v[92:95], v2 offset:3072
    ds_read_b128 v[96:99], v2 offset:4096
    ds_read_b128 v[100:103], v2 offset:5120
    ds_read_b128 v[104:107], v2 offset:6144
    ds_read_b128 v[108:111], v2 offset:7168
    s_waitcnt lgkmcnt(7)
    v_mfma_f32_16x16x32_bf16 v[120:123], v[80:83], v[16:19], 0
    v_mfma_f32_16x16x32_bf16 v[124:127], v[80:83], v[20:23], 0
    ds_read_b128 v[112:115], v2 offset:8192
    s_waitcnt lgkmcnt(7)
    v_mfma_f32_16x16x32_bf16 v[128:131], v[84:87], v[16:19], 0
    v_mfma_f32_16x16x32_bf16 v[132:135], v[84:87], v[20:23], 0
    s_add_u32 s37, s31, 71680
    s_add_u32 m0, s32, 71680
    s_cmp_ge_u32 s26, 2
    s_cbranch_scc1 k4_kernel_skip5_4
    buffer_load_dwordx4 v2, s[12:15], s37 offen lds
k4_kernel_skip5_4:
    ds_read_b128 v[116:119], v2 offset:9216
    s_waitcnt lgkmcnt(7)
    v_mfma_f32_16x16x32_bf16 v[136:139], v[88:91], v[16:19], 0
    v_mfma_f32_16x16x32_bf16 v[140:143], v[88:91], v[20:23], 0
    ds_read_b128 v[80:83], v2 offset:10240
    s_waitcnt lgkmcnt(7)
    v_mfma_f32_16x16x32_bf16 v[144:147], v[92:95], v[16:19], 0
    v_mfma_f32_16x16x32_bf16 v[148:151], v[92:95], v[20:23], 0
    s_add_u32 s38, s31, 55296
    s_add_u32 m0, s32, 55296
    s_nop 0
    buffer_load_dwordx4 v2, s[12:15], s38 offen lds
    ds_read_b128 v[84:87], v2 offset:11264
    s_waitcnt lgkmcnt(7)
    v_mfma_f32_16x16x32_bf16 v[152:155], v[96:99], v[16:19], 0
    v_mfma_f32_16x16x32_bf16 v[156:159], v[96:99], v[20:23], 0
    ds_read_b128 v[88:91], v2 offset:12288
    s_waitcnt lgkmcnt(7)
    v_mfma_f32_16x16x32_bf16 v[160:163], v[100:103], v[16:19], 0
    v_mfma_f32_16x16x32_bf16 v[164:167], v[100:103], v[20:23], 0
    s_add_u32 s33, s31, 59392
    s_add_u32 m0, s32, 59392
    s_nop 0
    buffer_load_dwordx4 v2, s[12:15], s33 offen lds
    s_add_u32 s34, s31, 63488
    s_add_u32 m0, s32, 63488
    s_nop 0
    buffer_load_dwordx4 v2, s[12:15], s34 offen lds
    s_add_u32 s35, s31, 67584
    s_add_u32 m0, s32, 67584
    s_nop 0
    buffer_load_dwordx4 v2, s[12:15], s35 offen lds
    s_add_u32 s36, s30, 6144
    buffer_load_dwordx4 v[64:67], v2, s[8:11], s36 offen
    s_add_u32 s37, s30, 153600
    buffer_load_dwordx4 v[68:71], v2, s[8:11], s37 offen
    s_waitcnt vmcnt(18)
    s_barrier
    ds_read_b128 v[92:95], v2 offset:13312
    s_waitcnt lgkmcnt(7)
    v_mfma_f32_16x16x32_bf16 v[168:171], v[104:107], v[16:19], 0
    v_mfma_f32_16x16x32_bf16 v[172:175], v[104:107], v[20:23], 0
    ds_read_b128 v[96:99], v2 offset:14336
    s_waitcnt lgkmcnt(7)
    v_mfma_f32_16x16x32_bf16 v[176:179], v[108:111], v[16:19], 0
    v_mfma_f32_16x16x32_bf16 v[180:183], v[108:111], v[20:23], 0
    ds_read_b128 v[100:103], v2 offset:15360
    s_waitcnt lgkmcnt(7)
    v_mfma_f32_16x16x32_bf16 v[184:187], v[112:115], v[16:19], 0
    v_mfma_f32_16x16x32_bf16 v[188:191], v[112:115], v[20:23], 0
    ds_read_b128 v[104:107], v2 offset:16384
    s_waitcnt lgkmcnt(7)
    v_mfma_f32_16x16x32_bf16 v[120:123], v[116:119], v[24:27], v[120:123]
    v_mfma_f32_16x16x32_bf16 v[124:127], v[116:119], v[28:31], v[124:127]
    s_add_u32 s38, s30, 7168
    buffer_load_dwordx4 v[72:75], v2, s[8:11], s38 offen
    ds_read_b128 v[108:111], v2 offset:17408
    s_waitcnt lgkmcnt(7)
    v_mfma_f32_16x16x32_bf16 v[128:131], v[80:83], v[24:27], v[128:131]
    v_mfma_f32_16x16x32_bf16 v[132:135], v[80:83], v[28:31], v[132:135]
    ds_read_b128 v[112:115], v2 offset:18432
    s_waitcnt lgkmcnt(7)
    v_mfma_f32_16x16x32_bf16 v[136:139], v[84:87], v[24:27], v[136:139]
    v_mfma_f32_16x16x32_bf16 v[140:143], v[84:87], v[28:31], v[140:143]
    s_add_u32 s33, s30, 154624
    buffer_load_dwordx4 v[76:79], v2, s[8:11], s33 offen
    ds_read_b128 v[116:119], v2 offset:19456
    s_waitcnt lgkmcnt(7)
    v_mfma_f32_16x16x32_bf16 v[144:147], v[88:91], v[24:27], v[144:147]
    v_mfma_f32_16x16x32_bf16 v[148:151], v[88:91], v[28:31], v[148:151]
    ds_read_b128 v[80:83], v2 offset:20480
    s_waitcnt lgkmcnt(7)
    v_mfma_f32_16x16x32_bf16 v[152:155], v[92:95], v[24:27], v[152:155]
    v_mfma_f32_16x16x32_bf16 v[156:159], v[92:95], v[28:31], v[156:159]
    ds_read_b128 v[84:87], v2 offset:21504
    s_waitcnt lgkmcnt(7)
    v_mfma_f32_16x16x32_bf16 v[160:163], v[96:99], v[24:27], v[160:163]
    v_mfma_f32_16x16x32_bf16 v[164:167], v[96:99], v[28:31], v[164:167]
    ds_read_b128 v[88:91], v2 offset:22528
    s_waitcnt lgkmcnt(7)
    v_mfma_f32_16x16x32_bf16 v[168:171], v[100:103], v[24:27], v[168:171]
    v_mfma_f32_16x16x32_bf16 v[172:175], v[100:103], v[28:31], v[172:175]
    ds_read_b128 v[92:95], v2 offset:23552
    s_waitcnt lgkmcnt(7)
    v_mfma_f32_16x16x32_bf16 v[176:179], v[104:107], v[24:27], v[176:179]
    v_mfma_f32_16x16x32_bf16 v[180:183], v[104:107], v[28:31], v[180:183]
    ds_read_b128 v[96:99], v2 offset:24576
    s_waitcnt lgkmcnt(7)
    v_mfma_f32_16x16x32_bf16 v[184:187], v[108:111], v[24:27], v[184:187]
    v_mfma_f32_16x16x32_bf16 v[188:191], v[108:111], v[28:31], v[188:191]
    s_waitcnt vmcnt(18)
    ds_read_b128 v[100:103], v2 offset:25600
    s_waitcnt lgkmcnt(7)
    v_mfma_f32_16x16x32_bf16 v[120:123], v[112:115], v[32:35], v[120:123]
    v_mfma_f32_16x16x32_bf16 v[124:127], v[112:115], v[36:39], v[124:127]
    ds_read_b128 v[104:107], v2 offset:26624
    s_waitcnt lgkmcnt(7)
    v_mfma_f32_16x16x32_bf16 v[128:131], v[116:119], v[32:35], v[128:131]
    v_mfma_f32_16x16x32_bf16 v[132:135], v[116:119], v[36:39], v[132:135]
    s_add_u32 s34, s30, 8192
    buffer_load_dwordx4 v[16:19], v2, s[8:11], s34 offen
    ds_read_b128 v[108:111], v2 offset:27648
    s_waitcnt lgkmcnt(7)
    v_mfma_f32_16x16x32_bf16 v[136:139], v[80:83], v[32:35], v[136:139]
    v_mfma_f32_16x16x32_bf16 v[140:143], v[80:83], v[36:39], v[140:143]
    ds_read_b128 v[112:115], v2 offset:28672
    s_waitcnt lgkmcnt(7)
    v_mfma_f32_16x16x32_bf16 v[144:147], v[84:87], v[32:35], v[144:147]
    v_mfma_f32_16x16x32_bf16 v[148:151], v[84:87], v[36:39], v[148:151]
    s_add_u32 s35, s30, 155648
    buffer_load_dwordx4 v[20:23], v2, s[8:11], s35 offen
    ds_read_b128 v[116:119], v2 offset:29696
    s_waitcnt lgkmcnt(7)
    v_mfma_f32_16x16x32_bf16 v[152:155], v[88:91], v[32:35], v[152:155]
    v_mfma_f32_16x16x32_bf16 v[156:159], v[88:91], v[36:39], v[156:159]
    ds_read_b128 v[80:83], v2 offset:30720
    s_waitcnt lgkmcnt(7)
    v_mfma_f32_16x16x32_bf16 v[160:163], v[92:95], v[32:35], v[160:163]
    v_mfma_f32_16x16x32_bf16 v[164:167], v[92:95], v[36:39], v[164:167]
    s_waitcnt vmcnt(14)
    s_barrier
    ds_read_b128 v[84:87], v2 offset:31744
    s_waitcnt lgkmcnt(7)
    v_mfma_f32_16x16x32_bf16 v[168:171], v[96:99], v[32:35], v[168:171]
    v_mfma_f32_16x16x32_bf16 v[172:175], v[96:99], v[36:39], v[172:175]
    ds_read_b128 v[88:91], v2 offset:32768
    s_waitcnt lgkmcnt(7)
    v_mfma_f32_16x16x32_bf16 v[176:179], v[100:103], v[32:35], v[176:179]
    v_mfma_f32_16x16x32_bf16 v[180:183], v[100:103], v[36:39], v[180:183]
    s_add_u32 s36, s31, 90112
    s_add_u32 m0, s32, 16384
    s_cmp_ge_u32 s26, 2
    s_cbranch_scc1 k4_kernel_skip5_5
    buffer_load_dwordx4 v2, s[12:15], s36 offen lds
k4_kernel_skip5_5:
    ds_read_b128 v[92:95], v2 offset:33792
    s_waitcnt lgkmcnt(7)
    v_mfma_f32_16x16x32_bf16 v[184:187], v[104:107], v[32:35], v[184:187]
    v_mfma_f32_16x16x32_bf16 v[188:191], v[104:107], v[36:39], v[188:191]
    ds_read_b128 v[96:99], v2 offset:34816
    s_waitcnt lgkmcnt(7)
    v_mfma_f32_16x16x32_bf16 v[120:123], v[108:111], v[40:43], v[120:123]
    v_mfma_f32_16x16x32_bf16 v[124:127], v[108:111], v[44:47], v[124:127]
    s_add_u32 s37, s31, 73728
    s_add_u32 m0, s32, 0
    s_nop 0
    buffer_load_dwordx4 v2, s[12:15], s37 offen lds
    ds_read_b128 v[100:103], v2 offset:35840
    s_waitcnt lgkmcnt(7)
    v_mfma_f32_16x16x32_bf16 v[128:131], v[112:115], v[40:43], v[128:131]
    v_mfma_f32_16x16x32_bf16 v[132:135], v[112:115], v[44:47], v[132:135]
    ds_read_b128 v[104:107], v3 offset:0
    s_waitcnt lgkmcnt(7)
    v_mfma_f32_16x16x32_bf16 v[136:139], v[116:119], v[40:43], v[136:139]
    v_mfma_f32_16x16x32_bf16 v[140:143], v[116:119], v[44:47], v[140:143]
    s_add_u32 s38, s31, 77824
    s_add_u32 m0, s32, 4096
    s_nop 0
    buffer_load_dwordx4 v2, s[12:15], s38 offen lds
    ds_read_b128 v[108:111], v3 offset:1024
    s_waitcnt lgkmcnt(7)
    v_mfma_f32_16x16x32_bf16 v[144:147], v[80:83], v[40:43], v[144:147]
    v_mfma_f32_16x16x32_bf16 v[148:151], v[80:83], v[44:47], v[148:151]
    ds_read_b128 v[112:115], v3 offset:2048
    s_waitcnt lgkmcnt(7)
    v_mfma_f32_16x16x32_bf16 v[152:155], v[84:87], v[40:43], v[152:155]
    v_mfma_f32_16x16x32_bf16 v[156:159], v[84:87], v[44:47], v[156:159]
    s_add_u32 s33, s31, 81920
    s_add_u32 m0, s32, 8192
    s_nop 0
    buffer_load_dwordx4 v2, s[12:15], s33 offen lds
    ds_read_b128 v[116:119], v3 offset:3072
    s_waitcnt lgkmcnt(7)
    v_mfma_f32_16x16x32_bf16 v[160:163], v[88:91], v[40:43], v[160:163]
    v_mfma_f32_16x16x32_bf16 v[164:167], v[88:91], v[44:47], v[164:167]
    ds_read_b128 v[80:83], v3 offset:4096
    s_waitcnt lgkmcnt(7)
    v_mfma_f32_16x16x32_bf16 v[168:171], v[92:95], v[40:43], v[168:171]
    v_mfma_f32_16x16x32_bf16 v[172:175], v[92:95], v[44:47], v[172:175]
    s_add_u32 s34, s31, 86016
    s_add_u32 m0, s32, 12288
    s_nop 0
    buffer_load_dwordx4 v2, s[12:15], s34 offen lds
    ds_read_b128 v[84:87], v3 offset:5120
    s_waitcnt lgkmcnt(7)
    v_mfma_f32_16x16x32_bf16 v[176:179], v[96:99], v[40:43], v[176:179]
    v_mfma_f32_16x16x32_bf16 v[180:183], v[96:99], v[44:47], v[180:183]
    ds_read_b128 v[88:91], v3 offset:6144
    s_waitcnt lgkmcnt(7)
    v_mfma_f32_16x16x32_bf16 v[184:187], v[100:103], v[40:43], v[184:187]
    v_mfma_f32_16x16x32_bf16 v[188:191], v[100:103], v[44:47], v[188:191]
    s_add_u32 s35, s30, 9216
    buffer_load_dwordx4 v[24:27], v2, s[8:11], s35 offen
    s_waitcnt vmcnt(17)
    ds_read_b128 v[92:95], v3 offset:7168
    s_waitcnt lgkmcnt(7)
    v_mfma_f32_16x16x32_bf16 v[120:123], v[104:107], v[48:51], v[120:123]
    v_mfma_f32_16x16x32_bf16 v[124:127], v[104:107], v[52:55], v[124:127]
    ds_read_b128 v[96:99], v3 offset:8192
    s_waitcnt lgkmcnt(7)
    v_mfma_f32_16x16x32_bf16 v[128:131], v[108:111], v[48:51], v[128:131]
    v_mfma_f32_16x16x32_bf16 v[132:135], v[108:111], v[52:55], v[132:135]
    s_add_u32 s36, s30, 156672
    buffer_load_dwordx4 v[28:31], v2, s[8:11], s36 offen
    ds_read_b128 v[100:103], v3 offset:9216
    s_waitcnt lgkmcnt(7)
    v_mfma_f32_16x16x32_bf16 v[136:139], v[112:115], v[48:51], v[136:139]
    v_mfma_f32_16x16x32_bf16 v[140:143], v[112:115], v[52:55], v[140:143]
    ds_read_b128 v[104:107], v3 offset:10240
    s_waitcnt lgkmcnt(7)
    v_mfma_f32_16x16x32_bf16 v[144:147], v[116:119], v[48:51], v[144:147]
    v_mfma_f32_16x16x32_bf16 v[148:151], v[116:119], v[52:55], v[148:151]
    s_add_u32 s37, s30, 10240
    buffer_load_dwordx4 v[32:35], v2, s[8:11], s37 offen
    ds_read_b128 v[108:111], v3 offset:11264
    s_waitcnt lgkmcnt(7)
    v_mfma_f32_16x16x32_bf16 v[152:155], v[80:83], v[48:51], v[152:155]
    v_mfma_f32_16x16x32_bf16 v[156:159], v[80:83], v[52:55], v[156:159]
    ds_read_b128 v[112:115], v3 offset:12288
    s_waitcnt lgkmcnt(7)
    v_mfma_f32_16x16x32_bf16 v[160:163], v[84:87], v[48:51], v[160:163]
    v_mfma_f32_16x16x32_bf16 v[164:167], v[84:87], v[52:55], v[164:167]
    s_add_u32 s38, s30, 157696
    buffer_load_dwordx4 v[36:39], v2, s[8:11], s38 offen
    s_waitcnt vmcnt(14)
    s_barrier
    ds_read_b128 v[116:119], v3 offset:13312
    s_waitcnt lgkmcnt(7)
    v_mfma_f32_16x16x32_bf16 v[168:171], v[88:91], v[48:51], v[168:171]
    v_mfma_f32_16x16x32_bf16 v[172:175], v[88:91], v[52:55], v[172:175]
    ds_read_b128 v[80:83], v3 offset:14336
    s_waitcnt lgkmcnt(7)
    v_mfma_f32_16x16x32_bf16 v[176:179], v[92:95], v[48:51], v[176:179]
    v_mfma_f32_16x16x32_bf16 v[180:183], v[92:95], v[52:55], v[180:183]
    s_add_u32 s33, s31, 108544
    s_add_u32 m0, s32, 34816
    s_cmp_ge_u32 s26, 2
    s_cbranch_scc1 k4_kernel_skip5_6
    buffer_load_dwordx4 v2, s[12:15], s33 offen lds
k4_kernel_skip5_6:
    ds_read_b128 v[84:87], v3 offset:15360
    s_waitcnt lgkmcnt(7)
    v_mfma_f32_16x16x32_bf16 v[184:187], v[96:99], v[48:51], v[184:187]
    v_mfma_f32_16x16x32_bf16 v[188:191], v[96:99], v[52:55], v[188:191]
    ds_read_b128 v[88:91], v3 offset:16384
    s_waitcnt lgkmcnt(7)
    v_mfma_f32_16x16x32_bf16 v[120:123], v[100:103], v[56:59], v[120:123]
    v_mfma_f32_16x16x32_bf16 v[124:127], v[100:103], v[60:63], v[124:127]
    s_add_u32 s34, s31, 92160
    s_add_u32 m0, s32, 18432
    s_nop 0
    buffer_load_dwordx4 v2, s[12:15], s34 offen lds
    ds_read_b128 v[92:95], v3 offset:17408
    s_waitcnt lgkmcnt(7)
    v_mfma_f32_16x16x32_bf16 v[128:131], v[104:107], v[56:59], v[128:131]
    v_mfma_f32_16x16x32_bf16 v[132:135], v[104:107], v[60:63], v[132:135]
    ds_read_b128 v[96:99], v3 offset:18432
    s_waitcnt lgkmcnt(7)
    v_mfma_f32_16x16x32_bf16 v[136:139], v[108:111], v[56:59], v[136:139]
    v_mfma_f32_16x16x32_bf16 v[140:143], v[108:111], v[60:63], v[140:143]
    s_add_u32 s35, s31, 96256
    s_add_u32 m0, s32, 22528
    s_nop 0
    buffer_load_dwordx4 v2, s[12:15], s35 offen lds
    ds_read_b128 v[100:103], v3 offset:19456
    s_waitcnt lgkmcnt(7)
    v_mfma_f32_16x16x32_bf16 v[144:147], v[112:115], v[56:59], v[144:147]
    v_mfma_f32_16x16x32_bf16 v[148:151], v[112:115], v[60:63], v[148:151]
    ds_read_b128 v[104:107], v3 offset:20480
    s_waitcnt lgkmcnt(7)
    v_mfma_f32_16x16x32_bf16 v[152:155], v[116:119], v[56:59], v[152:155]
    v_mfma_f32_16x16x32_bf16 v[156:159], v[116:119], v[60:63], v[156:159]
    s_add_u32 s36, s31, 100352
    s_add_u32 m0, s32, 26624
    s_nop 0
    buffer_load_dwordx4 v2, s[12:15], s36 offen lds
    ds_read_b128 v[108:111], v3 offset:21504
    s_waitcnt lgkmcnt(7)
    v_mfma_f32_16x16x32_bf16 v[160:163], v[80:83], v[56:59], v[160:163]
    v_mfma_f32_16x16x32_bf16 v[164:167], v[80:83], v[60:63], v[164:167]
    ds_read_b128 v[112:115], v3 offset:22528
    s_waitcnt lgkmcnt(7)
    v_mfma_f32_16x16x32_bf16 v[168:171], v[84:87], v[56:59], v[168:171]
    v_mfma_f32_16x16x32_bf16 v[172:175], v[84:87], v[60:63], v[172:175]
    s_add_u32 s37, s31, 104448
    s_add_u32 m0, s32, 30720
    s_nop 0
    buffer_load_dwordx4 v2, s[12:15], s37 offen lds
    ds_read_b128 v[116:119], v3 offset:23552
    s_waitcnt lgkmcnt(7)
    v_mfma_f32_16x16x32_bf16 v[176:179], v[88:91], v[56:59], v[176:179]
    v_mfma_f32_16x16x32_bf16 v[180:183], v[88:91], v[60:63], v[180:183]
    ds_read_b128 v[80:83], v3 offset:24576
    s_waitcnt lgkmcnt(7)
    v_mfma_f32_16x16x32_bf16 v[184:187], v[92:95], v[56:59], v[184:187]
    v_mfma_f32_16x16x32_bf16 v[188:191], v[92:95], v[60:63], v[188:191]
    s_add_u32 s38, s30, 11264
    buffer_load_dwordx4 v[40:43], v2, s[8:11], s38 offen
    s_waitcnt vmcnt(17)
    ds_read_b128 v[84:87], v3 offset:25600
    s_waitcnt lgkmcnt(7)
    v_mfma_f32_16x16x32_bf16 v[120:123], v[96:99], v[64:67], v[120:123]
    v_mfma_f32_16x16x32_bf16 v[124:127], v[96:99], v[68:71], v[124:127]
    ds_read_b128 v[88:91], v3 offset:26624
    s_waitcnt lgkmcnt(7)
    v_mfma_f32_16x16x32_bf16 v[128:131], v[100:103], v[64:67], v[128:131]
    v_mfma_f32_16x16x32_bf16 v[132:135], v[100:103], v[68:71], v[132:135]
    s_add_u32 s33, s30, 158720
    buffer_load_dwordx4 v[44:47], v2, s[8:11], s33 offen
    ds_read_b128 v[92:95], v3 offset:27648
    s_waitcnt lgkmcnt(7)
    v_mfma_f32_16x16x32_bf16 v[136:139], v[104:107], v[64:67], v[136:139]
    v_mfma_f32_16x16x32_bf16 v[140:143], v[104:107], v[68:71], v[140:143]
    ds_read_b128 v[96:99], v3 offset:28672
    s_waitcnt lgkmcnt(7)
    v_mfma_f32_16x16x32_bf16 v[144:147], v[108:111], v[64:67], v[144:147]
    v_mfma_f32_16x16x32_bf16 v[148:151], v[108:111], v[68:71], v[148:151]
    s_add_u32 s34, s30, 12288
    buffer_load_dwordx4 v[48:51], v2, s[8:11], s34 offen
    ds_read_b128 v[100:103], v3 offset:29696
    s_waitcnt lgkmcnt(7)
    v_mfma_f32_16x16x32_bf16 v[152:155], v[112:115], v[64:67], v[152:155]
    v_mfma_f32_16x16x32_bf16 v[156:159], v[112:115], v[68:71], v[156:159]
    ds_read_b128 v[104:107], v3 offset:30720
    s_waitcnt lgkmcnt(7)
    v_mfma_f32_16x16x32_bf16 v[160:163], v[116:119], v[64:67], v[160:163]
    v_mfma_f32_16x16x32_bf16 v[164:167], v[116:119], v[68:71], v[164:167]
    s_add_u32 s35, s30, 159744
    buffer_load_dwordx4 v[52:55], v2, s[8:11], s35 offen
    s_waitcnt vmcnt(12)
    s_barrier
    ds_read_b128 v[108:111], v3 offset:31744
    s_waitcnt lgkmcnt(7)
    v_mfma_f32_16x16x32_bf16 v[168:171], v[80:83], v[64:67], v[168:171]
    v_mfma_f32_16x16x32_bf16 v[172:175], v[80:83], v[68:71], v[172:175]
    ds_read_b128 v[112:115], v3 offset:32768
    s_waitcnt lgkmcnt(7)
    v_mfma_f32_16x16x32_bf16 v[176:179], v[84:87], v[64:67], v[176:179]
    v_mfma_f32_16x16x32_bf16 v[180:183], v[84:87], v[68:71], v[180:183]
    s_add_u32 s36, s31, 126976
    s_add_u32 m0, s32, 53248
    s_cmp_ge_u32 s26, 2
    s_cbranch_scc1 k4_kernel_skip5_7
    buffer_load_dwordx4 v2, s[12:15], s36 offen lds
k4_kernel_skip5_7:
    ds_read_b128 v[116:119], v3 offset:33792
    s_waitcnt lgkmcnt(7)
    v_mfma_f32_16x16x32_bf16 v[184:187], v[88:91], v[64:67], v[184:187]
    v_mfma_f32_16x16x32_bf16 v[188:191], v[88:91], v[68:71], v[188:191]
    ds_read_b128 v[80:83], v3 offset:34816
    s_waitcnt lgkmcnt(7)
    v_mfma_f32_16x16x32_bf16 v[120:123], v[92:95], v[72:75], v[120:123]
    v_mfma_f32_16x16x32_bf16 v[124:127], v[92:95], v[76:79], v[124:127]
    s_add_u32 s37, s31, 110592
    s_add_u32 m0, s32, 36864
    s_nop 0
    buffer_load_dwordx4 v2, s[12:15], s37 offen lds
    ds_read_b128 v[84:87], v3 offset:35840
    s_waitcnt lgkmcnt(7)
    v_mfma_f32_16x16x32_bf16 v[128:131], v[96:99], v[72:75], v[128:131]
    v_mfma_f32_16x16x32_bf16 v[132:135], v[96:99], v[76:79], v[132:135]
    ds_read_b128 v[88:91], v2 offset:0
    s_waitcnt lgkmcnt(7)
    v_mfma_f32_16x16x32_bf16 v[136:139], v[100:103], v[72:75], v[136:139]
    v_mfma_f32_16x16x32_bf16 v[140:143], v[100:103], v[76:79], v[140:143]
    s_add_u32 s38, s31, 114688
    s_add_u32 m0, s32, 40960
    s_nop 0
    buffer_load_dwordx4 v2, s[12:15], s38 offen lds
    ds_read_b128 v[92:95], v2 offset:1024
    s_waitcnt lgkmcnt(7)
    v_mfma_f32_16x16x32_bf16 v[144:147], v[104:107], v[72:75], v[144:147]
    v_mfma_f32_16x16x32_bf16 v[148:151], v[104:107], v[76:79], v[148:151]
    ds_read_b128 v[96:99], v2 offset:2048
    s_waitcnt lgkmcnt(7)
    v_mfma_f32_16x16x32_bf16 v[152:155], v[108:111], v[72:75], v[152:155]
    v_mfma_f32_16x16x32_bf16 v[156:159], v[108:111], v[76:79], v[156:159]
    s_add_u32 s33, s31, 118784
    s_add_u32 m0, s32, 45056
    s_nop 0
    buffer_load_dwordx4 v2, s[12:15], s33 offen lds
    ds_read_b128 v[100:103], v2 offset:3072
    s_waitcnt lgkmcnt(7)
    v_mfma_f32_16x16x32_bf16 v[160:163], v[112:115], v[72:75], v[160:163]
    v_mfma_f32_16x16x32_bf16 v[164:167], v[112:115], v[76:79], v[164:167]
    ds_read_b128 v[104:107], v2 offset:4096
    s_waitcnt lgkmcnt(7)
    v_mfma_f32_16x16x32_bf16 v[168:171], v[116:119], v[72:75], v[168:171]
    v_mfma_f32_16x16x32_bf16 v[172:175], v[116:119], v[76:79], v[172:175]
    s_add_u32 s34, s31, 122880
    s_add_u32 m0, s32, 49152
    s_nop 0
    buffer_load_dwordx4 v2, s[12:15], s34 offen lds
    ds_read_b128 v[108:111], v2 offset:5120
    s_waitcnt lgkmcnt(7)
    v_mfma_f32_16x16x32_bf16 v[176:179], v[80:83], v[72:75], v[176:179]
    v_mfma_f32_16x16x32_bf16 v[180:183], v[80:83], v[76:79], v[180:183]
    ds_read_b128 v[112:115], v2 offset:6144
    s_waitcnt lgkmcnt(7)
    v_mfma_f32_16x16x32_bf16 v[184:187], v[84:87], v[72:75], v[184:187]
    v_mfma_f32_16x16x32_bf16 v[188:191], v[84:87], v[76:79], v[188:191]
    s_add_u32 s35, s30, 13312
    buffer_load_dwordx4 v[56:59], v2, s[8:11], s35 offen
    ds_read_b128 v[116:119], v2 offset:7168
    s_waitcnt lgkmcnt(7)
    v_mfma_f32_16x16x32_bf16 v[120:123], v[88:91], v[16:19], v[120:123]
    v_mfma_f32_16x16x32_bf16 v[124:127], v[88:91], v[20:23], v[124:127]
    ds_read_b128 v[80:83], v2 offset:8192
    s_waitcnt lgkmcnt(7)
    v_mfma_f32_16x16x32_bf16 v[128:131], v[92:95], v[16:19], v[128:131]
    v_mfma_f32_16x16x32_bf16 v[132:135], v[92:95], v[20:23], v[132:135]
    s_add_u32 s36, s30, 160768
    buffer_load_dwordx4 v[60:63], v2, s[8:11], s36 offen
    ds_read_b128 v[84:87], v2 offset:9216
    s_waitcnt lgkmcnt(7)
    v_mfma_f32_16x16x32_bf16 v[136:139], v[96:99], v[16:19], v[136:139]
    v_mfma_f32_16x16x32_bf16 v[140:143], v[96:99], v[20:23], v[140:143]
    ds_read_b128 v[88:91], v2 offset:10240
    s_waitcnt lgkmcnt(7)
    v_mfma_f32_16x16x32_bf16 v[144:147], v[100:103], v[16:19], v[144:147]
    v_mfma_f32_16x16x32_bf16 v[148:151], v[100:103], v[20:23], v[148:151]
    s_add_u32 s37, s30, 14336
    buffer_load_dwordx4 v[64:67], v2, s[8:11], s37 offen
    ds_read_b128 v[92:95], v2 offset:11264
    s_waitcnt lgkmcnt(7)
    v_mfma_f32_16x16x32_bf16 v[152:155], v[104:107], v[16:19], v[152:155]
    v_mfma_f32_16x16x32_bf16 v[156:159], v[104:107], v[20:23], v[156:159]
    ds_read_b128 v[96:99], v2 offset:12288
    s_waitcnt lgkmcnt(7)
    v_mfma_f32_16x16x32_bf16 v[160:163], v[108:111], v[16:19], v[160:163]
    v_mfma_f32_16x16x32_bf16 v[164:167], v[108:111], v[20:23], v[164:167]
    s_add_u32 s38, s30, 161792
    buffer_load_dwordx4 v[68:71], v2, s[8:11], s38 offen
    s_waitcnt vmcnt(12)
    s_barrier
    ds_read_b128 v[100:103], v2 offset:13312
    s_waitcnt lgkmcnt(7)
    v_mfma_f32_16x16x32_bf16 v[168:171], v[112:115], v[16:19], v[168:171]
    v_mfma_f32_16x16x32_bf16 v[172:175], v[112:115], v[20:23], v[172:175]
    ds_read_b128 v[104:107], v2 offset:14336
    s_waitcnt lgkmcnt(7)
    v_mfma_f32_16x16x32_bf16 v[176:179], v[116:119], v[16:19], v[176:179]
    v_mfma_f32_16x16x32_bf16 v[180:183], v[116:119], v[20:23], v[180:183]
    s_add_u32 s33, s31, 145408
    s_add_u32 m0, s32, 71680
    s_cmp_ge_u32 s26, 2
    s_cbranch_scc1 k4_kernel_skip5_8
    buffer_load_dwordx4 v2, s[12:15], s33 offen lds
k4_kernel_skip5_8:
    ds_read_b128 v[108:111], v2 offset:15360
    s_waitcnt lgkmcnt(7)
    v_mfma_f32_16x16x32_bf16 v[184:187], v[80:83], v[16:19], v[184:187]
    v_mfma_f32_16x16x32_bf16 v[188:191], v[80:83], v[20:23], v[188:191]
    ds_read_b128 v[112:115], v2 offset:16384
    s_waitcnt lgkmcnt(7)
    v_mfma_f32_16x16x32_bf16 v[120:123], v[84:87], v[24:27], v[120:123]
    v_mfma_f32_16x16x32_bf16 v[124:127], v[84:87], v[28:31], v[124:127]
    s_add_u32 s34, s31, 129024
    s_add_u32 m0, s32, 55296
    s_nop 0
    buffer_load_dwordx4 v2, s[12:15], s34 offen lds
    ds_read_b128 v[116:119], v2 offset:17408
    s_waitcnt lgkmcnt(7)
    v_mfma_f32_16x16x32_bf16 v[128:131], v[88:91], v[24:27], v[128:131]
    v_mfma_f32_16x16x32_bf16 v[132:135], v[88:91], v[28:31], v[132:135]
    ds_read_b128 v[80:83], v2 offset:18432
    s_waitcnt lgkmcnt(7)
    v_mfma_f32_16x16x32_bf16 v[136:139], v[92:95], v[24:27], v[136:139]
    v_mfma_f32_16x16x32_bf16 v[140:143], v[92:95], v[28:31], v[140:143]
    s_add_u32 s35, s31, 133120
    s_add_u32 m0, s32, 59392
    s_nop 0
    buffer_load_dwordx4 v2, s[12:15], s35 offen lds
    ds_read_b128 v[84:87], v2 offset:19456
    s_waitcnt lgkmcnt(7)
    v_mfma_f32_16x16x32_bf16 v[144:147], v[96:99], v[24:27], v[144:147]
    v_mfma_f32_16x16x32_bf16 v[148:151], v[96:99], v[28:31], v[148:151]
    ds_read_b128 v[88:91], v2 offset:20480
    s_waitcnt lgkmcnt(7)
    v_mfma_f32_16x16x32_bf16 v[152:155], v[100:103], v[24:27], v[152:155]
    v_mfma_f32_16x16x32_bf16 v[156:159], v[100:103], v[28:31], v[156:159]
    s_add_u32 s36, s31, 137216
    s_add_u32 m0, s32, 63488
    s_nop 0
    buffer_load_dwordx4 v2, s[12:15], s36 offen lds
    ds_read_b128 v[92:95], v2 offset:21504
    s_waitcnt lgkmcnt(7)
    v_mfma_f32_16x16x32_bf16 v[160:163], v[104:107], v[24:27], v[160:163]
    v_mfma_f32_16x16x32_bf16 v[164:167], v[104:107], v[28:31], v[164:167]
    ds_read_b128 v[96:99], v2 offset:22528
    s_waitcnt lgkmcnt(7)
    v_mfma_f32_16x16x32_bf16 v[168:171], v[108:111], v[24:27], v[168:171]
    v_mfma_f32_16x16x32_bf16 v[172:175], v[108:111], v[28:31], v[172:175]
    s_add_u32 s37, s31, 141312
    s_add_u32 m0, s32, 67584
    s_nop 0
    buffer_load_dwordx4 v2, s[12:15], s37 offen lds
    ds_read_b128 v[100:103], v2 offset:23552
    s_waitcnt lgkmcnt(7)
    v_mfma_f32_16x16x32_bf16 v[176:179], v[112:115], v[24:27], v[176:179]
    v_mfma_f32_16x16x32_bf16 v[180:183], v[112:115], v[28:31], v[180:183]
    ds_read_b128 v[104:107], v2 offset:24576
    s_waitcnt lgkmcnt(7)
    v_mfma_f32_16x16x32_bf16 v[184:187], v[116:119], v[24:27], v[184:187]
    v_mfma_f32_16x16x32_bf16 v[188:191], v[116:119], v[28:31], v[188:191]
    s_add_u32 s38, s30, 15360
    buffer_load_dwordx4 v[72:75], v2, s[8:11], s38 offen
    ds_read_b128 v[108:111], v2 offset:25600
    s_waitcnt lgkmcnt(7)
    v_mfma_f32_16x16x32_bf16 v[120:123], v[80:83], v[32:35], v[120:123]
    v_mfma_f32_16x16x32_bf16 v[124:127], v[80:83], v[36:39], v[124:127]
    ds_read_b128 v[112:115], v2 offset:26624
    s_waitcnt lgkmcnt(7)
    v_mfma_f32_16x16x32_bf16 v[128:131], v[84:87], v[32:35], v[128:131]
    v_mfma_f32_16x16x32_bf16 v[132:135], v[84:87], v[36:39], v[132:135]
    s_add_u32 s33, s30, 162816
    buffer_load_dwordx4 v[76:79], v2, s[8:11], s33 offen
    ds_read_b128 v[116:119], v2 offset:27648
    s_waitcnt lgkmcnt(7)
    v_mfma_f32_16x16x32_bf16 v[136:139], v[88:91], v[32:35], v[136:139]
    v_mfma_f32_16x16x32_bf16 v[140:143], v[88:91], v[36:39], v[140:143]
    ds_read_b128 v[80:83], v2 offset:28672
    s_waitcnt lgkmcnt(7)
    v_mfma_f32_16x16x32_bf16 v[144:147], v[92:95], v[32:35], v[144:147]
    v_mfma_f32_16x16x32_bf16 v[148:151], v[92:95], v[36:39], v[148:151]
    s_add_u32 s34, s30, 16384
    buffer_load_dwordx4 v[16:19], v2, s[8:11], s34 offen
    ds_read_b128 v[84:87], v2 offset:29696
    s_waitcnt lgkmcnt(7)
    v_mfma_f32_16x16x32_bf16 v[152:155], v[96:99], v[32:35], v[152:155]
    v_mfma_f32_16x16x32_bf16 v[156:159], v[96:99], v[36:39], v[156:159]
    ds_read_b128 v[88:91], v2 offset:30720
    s_waitcnt lgkmcnt(7)
    v_mfma_f32_16x16x32_bf16 v[160:163], v[100:103], v[32:35], v[160:163]
    v_mfma_f32_16x16x32_bf16 v[164:167], v[100:103], v[36:39], v[164:167]
    s_add_u32 s35, s30, 163840
    buffer_load_dwordx4 v[20:23], v2, s[8:11], s35 offen
    s_waitcnt vmcnt(12)
    s_barrier
    ds_read_b128 v[92:95], v2 offset:31744
    s_waitcnt lgkmcnt(7)
    v_mfma_f32_16x16x32_bf16 v[168:171], v[104:107], v[32:35], v[168:171]
    v_mfma_f32_16x16x32_bf16 v[172:175], v[104:107], v[36:39], v[172:175]
    ds_read_b128 v[96:99], v2 offset:32768
    s_waitcnt lgkmcnt(7)
    v_mfma_f32_16x16x32_bf16 v[176:179], v[108:111], v[32:35], v[176:179]
    v_mfma_f32_16x16x32_bf16 v[180:183], v[108:111], v[36:39], v[180:183]
    s_add_u32 s36, s31, 163840
    s_add_u32 m0, s32, 16384
    s_cmp_ge_u32 s26, 2
    s_cbranch_scc1 k4_kernel_skip5_9
    buffer_load_dwordx4 v2, s[12:15], s36 offen lds
k4_kernel_skip5_9:
    ds_read_b128 v[100:103], v2 offset:33792
    s_waitcnt lgkmcnt(7)
    v_mfma_f32_16x16x32_bf16 v[184:187], v[112:115], v[32:35], v[184:187]
    v_mfma_f32_16x16x32_bf16 v[188:191], v[112:115], v[36:39], v[188:191]
    ds_read_b128 v[104:107], v2 offset:34816
    s_waitcnt lgkmcnt(7)
    v_mfma_f32_16x16x32_bf16 v[120:123], v[116:119], v[40:43], v[120:123]
    v_mfma_f32_16x16x32_bf16 v[124:127], v[116:119], v[44:47], v[124:127]
    s_add_u32 s37, s31, 147456
    s_add_u32 m0, s32, 0
    s_nop 0
    buffer_load_dwordx4 v2, s[12:15], s37 offen lds
    ds_read_b128 v[108:111], v2 offset:35840
    s_waitcnt lgkmcnt(7)
    v_mfma_f32_16x16x32_bf16 v[128:131], v[80:83], v[40:43], v[128:131]
    v_mfma_f32_16x16x32_bf16 v[132:135], v[80:83], v[44:47], v[132:135]
    ds_read_b128 v[112:115], v3 offset:0
    s_waitcnt lgkmcnt(7)
    v_mfma_f32_16x16x32_bf16 v[136:139], v[84:87], v[40:43], v[136:139]
    v_mfma_f32_16x16x32_bf16 v[140:143], v[84:87], v[44:47], v[140:143]
    s_add_u32 s38, s31, 151552
    s_add_u32 m0, s32, 4096
    s_nop 0
    buffer_load_dwordx4 v2, s[12:15], s38 offen lds
    ds_read_b128 v[116:119], v3 offset:1024
    s_waitcnt lgkmcnt(7)
    v_mfma_f32_16x16x32_bf16 v[144:147], v[88:91], v[40:43], v[144:147]
    v_mfma_f32_16x16x32_bf16 v[148:151], v[88:91], v[44:47], v[148:151]
    ds_read_b128 v[80:83], v3 offset:2048
    s_waitcnt lgkmcnt(7)
    v_mfma_f32_16x16x32_bf16 v[152:155], v[92:95], v[40:43], v[152:155]
    v_mfma_f32_16x16x32_bf16 v[156:159], v[92:95], v[44:47], v[156:159]
    s_add_u32 s33, s31, 155648
    s_add_u32 m0, s32, 8192
    s_nop 0
    buffer_load_dwordx4 v2, s[12:15], s33 offen lds
    ds_read_b128 v[84:87], v3 offset:3072
    s_waitcnt lgkmcnt(7)
    v_mfma_f32_16x16x32_bf16 v[160:163], v[96:99], v[40:43], v[160:163]
    v_mfma_f32_16x16x32_bf16 v[164:167], v[96:99], v[44:47], v[164:167]
    ds_read_b128 v[88:91], v3 offset:4096
    s_waitcnt lgkmcnt(7)
    v_mfma_f32_16x16x32_bf16 v[168:171], v[100:103], v[40:43], v[168:171]
    v_mfma_f32_16x16x32_bf16 v[172:175], v[100:103], v[44:47], v[172:175]
    s_add_u32 s34, s31, 159744
    s_add_u32 m0, s32, 12288
    s_nop 0
    buffer_load_dwordx4 v2, s[12:15], s34 offen lds
    ds_read_b128 v[92:95], v3 offset:5120
    s_waitcnt lgkmcnt(7)
    v_mfma_f32_16x16x32_bf16 v[176:179], v[104:107], v[40:43], v[176:179]
    v_mfma_f32_16x16x32_bf16 v[180:183], v[104:107], v[44:47], v[180:183]
    ds_read_b128 v[96:99], v3 offset:6144
    s_waitcnt lgkmcnt(7)
    v_mfma_f32_16x16x32_bf16 v[184:187], v[108:111], v[40:43], v[184:187]
    v_mfma_f32_16x16x32_bf16 v[188:191], v[108:111], v[44:47], v[188:191]
    s_add_u32 s35, s30, 17408
    buffer_load_dwordx4 v[24:27], v2, s[8:11], s35 offen
    ds_read_b128 v[100:103], v3 offset:7168
    s_waitcnt lgkmcnt(7)
    v_mfma_f32_16x16x32_bf16 v[120:123], v[112:115], v[48:51], v[120:123]
    v_mfma_f32_16x16x32_bf16 v[124:127], v[112:115], v[52:55], v[124:127]
    ds_read_b128 v[104:107], v3 offset:8192
    s_waitcnt lgkmcnt(7)
    v_mfma_f32_16x16x32_bf16 v[128:131], v[116:119], v[48:51], v[128:131]
    v_mfma_f32_16x16x32_bf16 v[132:135], v[116:119], v[52:55], v[132:135]
    s_add_u32 s36, s30, 164864
    buffer_load_dwordx4 v[28:31], v2, s[8:11], s36 offen
    ds_read_b128 v[108:111], v3 offset:9216
    s_waitcnt lgkmcnt(7)
    v_mfma_f32_16x16x32_bf16 v[136:139], v[80:83], v[48:51], v[136:139]
    v_mfma_f32_16x16x32_bf16 v[140:143], v[80:83], v[52:55], v[140:143]
    ds_read_b128 v[112:115], v3 offset:10240
    s_waitcnt lgkmcnt(7)
    v_mfma_f32_16x16x32_bf16 v[144:147], v[84:87], v[48:51], v[144:147]
    v_mfma_f32_16x16x32_bf16 v[148:151], v[84:87], v[52:55], v[148:151]
    s_add_u32 s37, s30, 18432
    buffer_load_dwordx4 v[32:35], v2, s[8:11], s37 offen
    ds_read_b128 v[116:119], v3 offset:11264
    s_waitcnt lgkmcnt(7)
    v_mfma_f32_16x16x32_bf16 v[152:155], v[88:91], v[48:51], v[152:155]
    v_mfma_f32_16x16x32_bf16 v[156:159], v[88:91], v[52:55], v[156:159]
    ds_read_b128 v[80:83], v3 offset:12288
    s_waitcnt lgkmcnt(7)
    v_mfma_f32_16x16x32_bf16 v[160:163], v[92:95], v[48:51], v[160:163]
    v_mfma_f32_16x16x32_bf16 v[164:167], v[92:95], v[52:55], v[164:167]
    s_add_u32 s38, s30, 165888
    buffer_load_dwordx4 v[36:39], v2, s[8:11], s38 offen
    s_waitcnt vmcnt(12)
    s_barrier
    ds_read_b128 v[84:87], v3 offset:13312
    s_waitcnt lgkmcnt(7)
    v_mfma_f32_16x16x32_bf16 v[168:171], v[96:99], v[48:51], v[168:171]
    v_mfma_f32_16x16x32_bf16 v[172:175], v[96:99], v[52:55], v[172:175]
    ds_read_b128 v[88:91], v3 offset:14336
    s_waitcnt lgkmcnt(7)
    v_mfma_f32_16x16x32_bf16 v[176:179], v[100:103], v[48:51], v[176:179]
    v_mfma_f32_16x16x32_bf16 v[180:183], v[100:103], v[52:55], v[180:183]
    s_add_u32 s33, s31, 182272
    s_add_u32 m0, s32, 34816
    s_cmp_ge_u32 s26, 2
    s_cbranch_scc1 k4_kernel_skip5_10
    buffer_load_dwordx4 v2, s[12:15], s33 offen lds
k4_kernel_skip5_10:
    ds_read_b128 v[92:95], v3 offset:15360
    s_waitcnt lgkmcnt(7)
    v_mfma_f32_16x16x32_bf16 v[184:187], v[104:107], v[48:51], v[184:187]
    v_mfma_f32_16x16x32_bf16 v[188:191], v[104:107], v[52:55], v[188:191]
    ds_read_b128 v[96:99], v3 offset:16384
    s_waitcnt lgkmcnt(7)
    v_mfma_f32_16x16x32_bf16 v[120:123], v[108:111], v[56:59], v[120:123]
    v_mfma_f32_16x16x32_bf16 v[124:127], v[108:111], v[60:63], v[124:127]
    s_add_u32 s34, s31, 165888
    s_add_u32 m0, s32, 18432
    s_nop 0
    buffer_load_dwordx4 v2, s[12:15], s34 offen lds
    ds_read_b128 v[100:103], v3 offset:17408
    s_waitcnt lgkmcnt(7)
    v_mfma_f32_16x16x32_bf16 v[128:131], v[112:115], v[56:59], v[128:131]
    v_mfma_f32_16x16x32_bf16 v[132:135], v[112:115], v[60:63], v[132:135]
    ds_read_b128 v[104:107], v3 offset:18432
    s_waitcnt lgkmcnt(7)
    v_mfma_f32_16x16x32_bf16 v[136:139], v[116:119], v[56:59], v[136:139]
    v_mfma_f32_16x16x32_bf16 v[140:143], v[116:119], v[60:63], v[140:143]
    s_add_u32 s35, s31, 169984
    s_add_u32 m0, s32, 22528
    s_nop 0
    buffer_load_dwordx4 v2, s[12:15], s35 offen lds
    ds_read_b128 v[108:111], v3 offset:19456
    s_waitcnt lgkmcnt(7)
    v_mfma_f32_16x16x32_bf16 v[144:147], v[80:83], v[56:59], v[144:147]
    v_mfma_f32_16x16x32_bf16 v[148:151], v[80:83], v[60:63], v[148:151]
    ds_read_b128 v[112:115], v3 offset:20480
    s_waitcnt lgkmcnt(7)
    v_mfma_f32_16x16x32_bf16 v[152:155], v[84:87], v[56:59], v[152:155]
    v_mfma_f32_16x16x32_bf16 v[156:159], v[84:87], v[60:63], v[156:159]
    s_add_u32 s36, s31, 174080
    s_add_u32 m0, s32, 26624
    s_nop 0
    buffer_load_dwordx4 v2, s[12:15], s36 offen lds
    ds_read_b128 v[116:119], v3 offset:21504
    s_waitcnt lgkmcnt(7)
    v_mfma_f32_16x16x32_bf16 v[160:163], v[88:91], v[56:59], v[160:163]
    v_mfma_f32_16x16x32_bf16 v[164:167], v[88:91], v[60:63], v[164:167]
    ds_read_b128 v[80:83], v3 offset:22528
    s_waitcnt lgkmcnt(7)
    v_mfma_f32_16x16x32_bf16 v[168:171], v[92:95], v[56:59], v[168:171]
    v_mfma_f32_16x16x32_bf16 v[172:175], v[92:95], v[60:63], v[172:175]
    s_add_u32 s37, s31, 178176
    s_add_u32 m0, s32, 30720
    s_nop 0
    buffer_load_dwordx4 v2, s[12:15], s37 offen lds
    ds_read_b128 v[84:87], v3 offset:23552
    s_waitcnt lgkmcnt(7)
    v_mfma_f32_16x16x32_bf16 v[176:179], v[96:99], v[56:59], v[176:179]
    v_mfma_f32_16x16x32_bf16 v[180:183], v[96:99], v[60:63], v[180:183]
    ds_read_b128 v[88:91], v3 offset:24576
    s_waitcnt lgkmcnt(7)
    v_mfma_f32_16x16x32_bf16 v[184:187], v[100:103], v[56:59], v[184:187]
    v_mfma_f32_16x16x32_bf16 v[188:191], v[100:103], v[60:63], v[188:191]
    s_add_u32 s38, s30, 19456
    buffer_load_dwordx4 v[40:43], v2, s[8:11], s38 offen
    ds_read_b128 v[92:95], v3 offset:25600
    s_waitcnt lgkmcnt(7)
    v_mfma_f32_16x16x32_bf16 v[120:123], v[104:107], v[64:67], v[120:123]
    v_mfma_f32_16x16x32_bf16 v[124:127], v[104:107], v[68:71], v[124:127]
    ds_read_b128 v[96:99], v3 offset:26624
    s_waitcnt lgkmcnt(7)
    v_mfma_f32_16x16x32_bf16 v[128:131], v[108:111], v[64:67], v[128:131]
    v_mfma_f32_16x16x32_bf16 v[132:135], v[108:111], v[68:71], v[132:135]
    s_add_u32 s33, s30, 166912
    buffer_load_dwordx4 v[44:47], v2, s[8:11], s33 offen
    ds_read_b128 v[100:103], v3 offset:27648
    s_waitcnt lgkmcnt(7)
    v_mfma_f32_16x16x32_bf16 v[136:139], v[112:115], v[64:67], v[136:139]
    v_mfma_f32_16x16x32_bf16 v[140:143], v[112:115], v[68:71], v[140:143]
    ds_read_b128 v[104:107], v3 offset:28672
    s_waitcnt lgkmcnt(7)
    v_mfma_f32_16x16x32_bf16 v[144:147], v[116:119], v[64:67], v[144:147]
    v_mfma_f32_16x16x32_bf16 v[148:151], v[116:119], v[68:71], v[148:151]
    s_add_u32 s34, s30, 20480
    buffer_load_dwordx4 v[48:51], v2, s[8:11], s34 offen
    ds_read_b128 v[108:111], v3 offset:29696
    s_waitcnt lgkmcnt(7)
    v_mfma_f32_16x16x32_bf16 v[152:155], v[80:83], v[64:67], v[152:155]
    v_mfma_f32_16x16x32_bf16 v[156:159], v[80:83], v[68:71], v[156:159]
    ds_read_b128 v[112:115], v3 offset:30720
    s_waitcnt lgkmcnt(7)
    v_mfma_f32_16x16x32_bf16 v[160:163], v[84:87], v[64:67], v[160:163]
    v_mfma_f32_16x16x32_bf16 v[164:167], v[84:87], v[68:71], v[164:167]
    s_add_u32 s35, s30, 167936
    buffer_load_dwordx4 v[52:55], v2, s[8:11], s35 offen
    s_waitcnt vmcnt(12)
    s_barrier
    ds_read_b128 v[116:119], v3 offset:31744
    s_waitcnt lgkmcnt(7)
    v_mfma_f32_16x16x32_bf16 v[168:171], v[88:91], v[64:67], v[168:171]
    v_mfma_f32_16x16x32_bf16 v[172:175], v[88:91], v[68:71], v[172:175]
    ds_read_b128 v[80:83], v3 offset:32768
    s_waitcnt lgkmcnt(7)
    v_mfma_f32_16x16x32_bf16 v[176:179], v[92:95], v[64:67], v[176:179]
    v_mfma_f32_16x16x32_bf16 v[180:183], v[92:95], v[68:71], v[180:183]
    s_add_u32 s36, s31, 200704
    s_add_u32 m0, s32, 53248
    s_cmp_ge_u32 s26, 2
    s_cbranch_scc1 k4_kernel_skip5_11
    buffer_load_dwordx4 v2, s[12:15], s36 offen lds
k4_kernel_skip5_11:
    ds_read_b128 v[84:87], v3 offset:33792
    s_waitcnt lgkmcnt(7)
    v_mfma_f32_16x16x32_bf16 v[184:187], v[96:99], v[64:67], v[184:187]
    v_mfma_f32_16x16x32_bf16 v[188:191], v[96:99], v[68:71], v[188:191]
    ds_read_b128 v[88:91], v3 offset:34816
    s_waitcnt lgkmcnt(7)
    v_mfma_f32_16x16x32_bf16 v[120:123], v[100:103], v[72:75], v[120:123]
    v_mfma_f32_16x16x32_bf16 v[124:127], v[100:103], v[76:79], v[124:127]
    s_add_u32 s37, s31, 184320
    s_add_u32 m0, s32, 36864
    s_nop 0
    buffer_load_dwordx4 v2, s[12:15], s37 offen lds
    ds_read_b128 v[92:95], v3 offset:35840
    s_waitcnt lgkmcnt(7)
    v_mfma_f32_16x16x32_bf16 v[128:131], v[104:107], v[72:75], v[128:131]
    v_mfma_f32_16x16x32_bf16 v[132:135], v[104:107], v[76:79], v[132:135]
    ds_read_b128 v[96:99], v2 offset:0
    s_waitcnt lgkmcnt(7)
    v_mfma_f32_16x16x32_bf16 v[136:139], v[108:111], v[72:75], v[136:139]
    v_mfma_f32_16x16x32_bf16 v[140:143], v[108:111], v[76:79], v[140:143]
    s_add_u32 s38, s31, 188416
    s_add_u32 m0, s32, 40960
    s_nop 0
    buffer_load_dwordx4 v2, s[12:15], s38 offen lds
    ds_read_b128 v[100:103], v2 offset:1024
    s_waitcnt lgkmcnt(7)
    v_mfma_f32_16x16x32_bf16 v[144:147], v[112:115], v[72:75], v[144:147]
    v_mfma_f32_16x16x32_bf16 v[148:151], v[112:115], v[76:79], v[148:151]
    ds_read_b128 v[104:107], v2 offset:2048
    s_waitcnt lgkmcnt(7)
    v_mfma_f32_16x16x32_bf16 v[152:155], v[116:119], v[72:75], v[152:155]
    v_mfma_f32_16x16x32_bf16 v[156:159], v[116:119], v[76:79], v[156:159]
    s_add_u32 s33, s31, 192512
    s_add_u32 m0, s32, 45056
    s_nop 0
    buffer_load_dwordx4 v2, s[12:15], s33 offen lds
    ds_read_b128 v[108:111], v2 offset:3072
    s_waitcnt lgkmcnt(7)
    v_mfma_f32_16x16x32_bf16 v[160:163], v[80:83], v[72:75], v[160:163]
    v_mfma_f32_16x16x32_bf16 v[164:167], v[80:83], v[76:79], v[164:167]
    ds_read_b128 v[112:115], v2 offset:4096
    s_waitcnt lgkmcnt(7)
    v_mfma_f32_16x16x32_bf16 v[168:171], v[84:87], v[72:75], v[168:171]
    v_mfma_f32_16x16x32_bf16 v[172:175], v[84:87], v[76:79], v[172:175]
    s_add_u32 s34, s31, 196608
    s_add_u32 m0, s32, 49152
    s_nop 0
    buffer_load_dwordx4 v2, s[12:15], s34 offen lds
    ds_read_b128 v[116:119], v2 offset:5120
    s_waitcnt lgkmcnt(7)
    v_mfma_f32_16x16x32_bf16 v[176:179], v[88:91], v[72:75], v[176:179]
    v_mfma_f32_16x16x32_bf16 v[180:183], v[88:91], v[76:79], v[180:183]
    ds_read_b128 v[80:83], v2 offset:6144
    s_waitcnt lgkmcnt(7)
    v_mfma_f32_16x16x32_bf16 v[184:187], v[92:95], v[72:75], v[184:187]
    v_mfma_f32_16x16x32_bf16 v[188:191], v[92:95], v[76:79], v[188:191]
    s_add_u32 s35, s30, 21504
    buffer_load_dwordx4 v[56:59], v2, s[8:11], s35 offen
    ds_read_b128 v[84:87], v2 offset:7168
    s_waitcnt lgkmcnt(7)
    v_mfma_f32_16x16x32_bf16 v[120:123], v[96:99], v[16:19], v[120:123]
    v_mfma_f32_16x16x32_bf16 v[124:127], v[96:99], v[20:23], v[124:127]
    ds_read_b128 v[88:91], v2 offset:8192
    s_waitcnt lgkmcnt(7)
    v_mfma_f32_16x16x32_bf16 v[128:131], v[100:103], v[16:19], v[128:131]
    v_mfma_f32_16x16x32_bf16 v[132:135], v[100:103], v[20:23], v[132:135]
    s_add_u32 s36, s30, 168960
    buffer_load_dwordx4 v[60:63], v2, s[8:11], s36 offen
    ds_read_b128 v[92:95], v2 offset:9216
    s_waitcnt lgkmcnt(7)
    v_mfma_f32_16x16x32_bf16 v[136:139], v[104:107], v[16:19], v[136:139]
    v_mfma_f32_16x16x32_bf16 v[140:143], v[104:107], v[20:23], v[140:143]
    ds_read_b128 v[96:99], v2 offset:10240
    s_waitcnt lgkmcnt(7)
    v_mfma_f32_16x16x32_bf16 v[144:147], v[108:111], v[16:19], v[144:147]
    v_mfma_f32_16x16x32_bf16 v[148:151], v[108:111], v[20:23], v[148:151]
    s_add_u32 s37, s30, 22528
    buffer_load_dwordx4 v[64:67], v2, s[8:11], s37 offen
    ds_read_b128 v[100:103], v2 offset:11264
    s_waitcnt lgkmcnt(7)
    v_mfma_f32_16x16x32_bf16 v[152:155], v[112:115], v[16:19], v[152:155]
    v_mfma_f32_16x16x32_bf16 v[156:159], v[112:115], v[20:23], v[156:159]
    ds_read_b128 v[104:107], v2 offset:12288
    s_waitcnt lgkmcnt(7)
    v_mfma_f32_16x16x32_bf16 v[160:163], v[116:119], v[16:19], v[160:163]
    v_mfma_f32_16x16x32_bf16 v[164:167], v[116:119], v[20:23], v[164:167]
    s_add_u32 s38, s30, 169984
    buffer_load_dwordx4 v[68:71], v2, s[8:11], s38 offen
    s_waitcnt vmcnt(12)
    s_barrier
    ds_read_b128 v[108:111], v2 offset:13312
    s_waitcnt lgkmcnt(7)
    v_mfma_f32_16x16x32_bf16 v[168:171], v[80:83], v[16:19], v[168:171]
    v_mfma_f32_16x16x32_bf16 v[172:175], v[80:83], v[20:23], v[172:175]
    ds_read_b128 v[112:115], v2 offset:14336
    s_waitcnt lgkmcnt(7)
    v_mfma_f32_16x16x32_bf16 v[176:179], v[84:87], v[16:19], v[176:179]
    v_mfma_f32_16x16x32_bf16 v[180:183], v[84:87], v[20:23], v[180:183]
    s_add_u32 s33, s31, 219136
    s_add_u32 m0, s32, 71680
    s_cmp_ge_u32 s26, 2
    s_cbranch_scc1 k4_kernel_skip5_12
    buffer_load_dwordx4 v2, s[12:15], s33 offen lds
k4_kernel_skip5_12:
    ds_read_b128 v[116:119], v2 offset:15360
    s_waitcnt lgkmcnt(7)
    v_mfma_f32_16x16x32_bf16 v[184:187], v[88:91], v[16:19], v[184:187]
    v_mfma_f32_16x16x32_bf16 v[188:191], v[88:91], v[20:23], v[188:191]
    ds_read_b128 v[80:83], v2 offset:16384
    s_waitcnt lgkmcnt(7)
    v_mfma_f32_16x16x32_bf16 v[120:123], v[92:95], v[24:27], v[120:123]
    v_mfma_f32_16x16x32_bf16 v[124:127], v[92:95], v[28:31], v[124:127]
    s_add_u32 s34, s31, 202752
    s_add_u32 m0, s32, 55296
    s_nop 0
    buffer_load_dwordx4 v2, s[12:15], s34 offen lds
    ds_read_b128 v[84:87], v2 offset:17408
    s_waitcnt lgkmcnt(7)
    v_mfma_f32_16x16x32_bf16 v[128:131], v[96:99], v[24:27], v[128:131]
    v_mfma_f32_16x16x32_bf16 v[132:135], v[96:99], v[28:31], v[132:135]
    ds_read_b128 v[88:91], v2 offset:18432
    s_waitcnt lgkmcnt(7)
    v_mfma_f32_16x16x32_bf16 v[136:139], v[100:103], v[24:27], v[136:139]
    v_mfma_f32_16x16x32_bf16 v[140:143], v[100:103], v[28:31], v[140:143]
    s_add_u32 s35, s31, 206848
    s_add_u32 m0, s32, 59392
    s_nop 0
    buffer_load_dwordx4 v2, s[12:15], s35 offen lds
    ds_read_b128 v[92:95], v2 offset:19456
    s_waitcnt lgkmcnt(7)
    v_mfma_f32_16x16x32_bf16 v[144:147], v[104:107], v[24:27], v[144:147]
    v_mfma_f32_16x16x32_bf16 v[148:151], v[104:107], v[28:31], v[148:151]
    ds_read_b128 v[96:99], v2 offset:20480
    s_waitcnt lgkmcnt(7)
    v_mfma_f32_16x16x32_bf16 v[152:155], v[108:111], v[24:27], v[152:155]
    v_mfma_f32_16x16x32_bf16 v[156:159], v[108:111], v[28:31], v[156:159]
    s_add_u32 s36, s31, 210944
    s_add_u32 m0, s32, 63488
    s_nop 0
    buffer_load_dwordx4 v2, s[12:15], s36 offen lds
    ds_read_b128 v[100:103], v2 offset:21504
    s_waitcnt lgkmcnt(7)
    v_mfma_f32_16x16x32_bf16 v[160:163], v[112:115], v[24:27], v[160:163]
    v_mfma_f32_16x16x32_bf16 v[164:167], v[112:115], v[28:31], v[164:167]
    ds_read_b128 v[104:107], v2 offset:22528
    s_waitcnt lgkmcnt(7)
    v_mfma_f32_16x16x32_bf16 v[168:171], v[116:119], v[24:27], v[168:171]
    v_mfma_f32_16x16x32_bf16 v[172:175], v[116:119], v[28:31], v[172:175]
    s_add_u32 s37, s31, 215040
    s_add_u32 m0, s32, 67584
    s_nop 0
    buffer_load_dwordx4 v2, s[12:15], s37 offen lds
    ds_read_b128 v[108:111], v2 offset:23552
    s_waitcnt lgkmcnt(7)
    v_mfma_f32_16x16x32_bf16 v[176:179], v[80:83], v[24:27], v[176:179]
    v_mfma_f32_16x16x32_bf16 v[180:183], v[80:83], v[28:31], v[180:183]
    ds_read_b128 v[112:115], v2 offset:24576
    s_waitcnt lgkmcnt(7)
    v_mfma_f32_16x16x32_bf16 v[184:187], v[84:87], v[24:27], v[184:187]
    v_mfma_f32_16x16x32_bf16 v[188:191], v[84:87], v[28:31], v[188:191]
    s_add_u32 s38, s30, 23552
    buffer_load_dwordx4 v[72:75], v2, s[8:11], s38 offen
    ds_read_b128 v[116:119], v2 offset:25600
    s_waitcnt lgkmcnt(7)
    v_mfma_f32_16x16x32_bf16 v[120:123], v[88:91], v[32:35], v[120:123]
    v_mfma_f32_16x16x32_bf16 v[124:127], v[88:91], v[36:39], v[124:127]
    ds_read_b128 v[80:83], v2 offset:26624
    s_waitcnt lgkmcnt(7)
    v_mfma_f32_16x16x32_bf16 v[128:131], v[92:95], v[32:35], v[128:131]
    v_mfma_f32_16x16x32_bf16 v[132:135], v[92:95], v[36:39], v[132:135]
    s_add_u32 s33, s30, 171008
    buffer_load_dwordx4 v[76:79], v2, s[8:11], s33 offen
    ds_read_b128 v[84:87], v2 offset:27648
    s_waitcnt lgkmcnt(7)
    v_mfma_f32_16x16x32_bf16 v[136:139], v[96:99], v[32:35], v[136:139]
    v_mfma_f32_16x16x32_bf16 v[140:143], v[96:99], v[36:39], v[140:143]
    ds_read_b128 v[88:91], v2 offset:28672
    s_waitcnt lgkmcnt(7)
    v_mfma_f32_16x16x32_bf16 v[144:147], v[100:103], v[32:35], v[144:147]
    v_mfma_f32_16x16x32_bf16 v[148:151], v[100:103], v[36:39], v[148:151]
    s_add_u32 s34, s30, 24576
    buffer_load_dwordx4 v[16:19], v2, s[8:11], s34 offen
    ds_read_b128 v[92:95], v2 offset:29696
    s_waitcnt lgkmcnt(7)
    v_mfma_f32_16x16x32_bf16 v[152:155], v[104:107], v[32:35], v[152:155]
    v_mfma_f32_16x16x32_bf16 v[156:159], v[104:107], v[36:39], v[156:159]
    ds_read_b128 v[96:99], v2 offset:30720
    s_waitcnt lgkmcnt(7)
    v_mfma_f32_16x16x32_bf16 v[160:163], v[108:111], v[32:35], v[160:163]
    v_mfma_f32_16x16x32_bf16 v[164:167], v[108:111], v[36:39], v[164:167]
    s_add_u32 s35, s30, 172032
    buffer_load_dwordx4 v[20:23], v2, s[8:11], s35 offen
    s_waitcnt vmcnt(12)
    s_barrier
    ds_read_b128 v[100:103], v2 offset:31744
    s_waitcnt lgkmcnt(7)
    v_mfma_f32_16x16x32_bf16 v[168:171], v[112:115], v[32:35], v[168:171]
    v_mfma_f32_16x16x32_bf16 v[172:175], v[112:115], v[36:39], v[172:175]
    ds_read_b128 v[104:107], v2 offset:32768
    s_waitcnt lgkmcnt(7)
    v_mfma_f32_16x16x32_bf16 v[176:179], v[116:119], v[32:35], v[176:179]
    v_mfma_f32_16x16x32_bf16 v[180:183], v[116:119], v[36:39], v[180:183]
    s_add_u32 s36, s31, 237568
    s_add_u32 m0, s32, 16384
    s_cmp_ge_u32 s26, 2
    s_cbranch_scc1 k4_kernel_skip5_13
    buffer_load_dwordx4 v2, s[12:15], s36 offen lds
k4_kernel_skip5_13:
    ds_read_b128 v[108:111], v2 offset:33792
    s_waitcnt lgkmcnt(7)
    v_mfma_f32_16x16x32_bf16 v[184:187], v[80:83], v[32:35], v[184:187]
    v_mfma_f32_16x16x32_bf16 v[188:191], v[80:83], v[36:39], v[188:191]
    ds_read_b128 v[112:115], v2 offset:34816
    s_waitcnt lgkmcnt(7)
    v_mfma_f32_16x16x32_bf16 v[120:123], v[84:87], v[40:43], v[120:123]
    v_mfma_f32_16x16x32_bf16 v[124:127], v[84:87], v[44:47], v[124:127]
    s_add_u32 s37, s31, 221184
    s_add_u32 m0, s32, 0
    s_nop 0
    buffer_load_dwordx4 v2, s[12:15], s37 offen lds
    ds_read_b128 v[116:119], v2 offset:35840
    s_waitcnt lgkmcnt(7)
    v_mfma_f32_16x16x32_bf16 v[128:131], v[88:91], v[40:43], v[128:131]
    v_mfma_f32_16x16x32_bf16 v[132:135], v[88:91], v[44:47], v[132:135]
    ds_read_b128 v[80:83], v3 offset:0
    s_waitcnt lgkmcnt(7)
    v_mfma_f32_16x16x32_bf16 v[136:139], v[92:95], v[40:43], v[136:139]
    v_mfma_f32_16x16x32_bf16 v[140:143], v[92:95], v[44:47], v[140:143]
    s_add_u32 s38, s31, 225280
    s_add_u32 m0, s32, 4096
    s_nop 0
    buffer_load_dwordx4 v2, s[12:15], s38 offen lds
    ds_read_b128 v[84:87], v3 offset:1024
    s_waitcnt lgkmcnt(7)
    v_mfma_f32_16x16x32_bf16 v[144:147], v[96:99], v[40:43], v[144:147]
    v_mfma_f32_16x16x32_bf16 v[148:151], v[96:99], v[44:47], v[148:151]
    ds_read_b128 v[88:91], v3 offset:2048
    s_waitcnt lgkmcnt(7)
    v_mfma_f32_16x16x32_bf16 v[152:155], v[100:103], v[40:43], v[152:155]
    v_mfma_f32_16x16x32_bf16 v[156:159], v[100:103], v[44:47], v[156:159]
    s_add_u32 s33, s31, 229376
    s_add_u32 m0, s32, 8192
    s_nop 0
    buffer_load_dwordx4 v2, s[12:15], s33 offen lds
    ds_read_b128 v[92:95], v3 offset:3072
    s_waitcnt lgkmcnt(7)
    v_mfma_f32_16x16x32_bf16 v[160:163], v[104:107], v[40:43], v[160:163]
    v_mfma_f32_16x16x32_bf16 v[164:167], v[104:107], v[44:47], v[164:167]
    ds_read_b128 v[96:99], v3 offset:4096
    s_waitcnt lgkmcnt(7)
    v_mfma_f32_16x16x32_bf16 v[168:171], v[108:111], v[40:43], v[168:171]
    v_mfma_f32_16x16x32_bf16 v[172:175], v[108:111], v[44:47], v[172:175]
    s_add_u32 s34, s31, 233472
    s_add_u32 m0, s32, 12288
    s_nop 0
    buffer_load_dwordx4 v2, s[12:15], s34 offen lds
    ds_read_b128 v[100:103], v3 offset:5120
    s_waitcnt lgkmcnt(7)
    v_mfma_f32_16x16x32_bf16 v[176:179], v[112:115], v[40:43], v[176:179]
    v_mfma_f32_16x16x32_bf16 v[180:183], v[112:115], v[44:47], v[180:183]
    ds_read_b128 v[104:107], v3 offset:6144
    s_waitcnt lgkmcnt(7)
    v_mfma_f32_16x16x32_bf16 v[184:187], v[116:119], v[40:43], v[184:187]
    v_mfma_f32_16x16x32_bf16 v[188:191], v[116:119], v[44:47], v[188:191]
    s_add_u32 s35, s30, 25600
    buffer_load_dwordx4 v[24:27], v2, s[8:11], s35 offen
    ds_read_b128 v[108:111], v3 offset:7168
    s_waitcnt lgkmcnt(7)
    v_mfma_f32_16x16x32_bf16 v[120:123], v[80:83], v[48:51], v[120:123]
    v_mfma_f32_16x16x32_bf16 v[124:127], v[80:83], v[52:55], v[124:127]
    ds_read_b128 v[112:115], v3 offset:8192
    s_waitcnt lgkmcnt(7)
    v_mfma_f32_16x16x32_bf16 v[128:131], v[84:87], v[48:51], v[128:131]
    v_mfma_f32_16x16x32_bf16 v[132:135], v[84:87], v[52:55], v[132:135]
    s_add_u32 s36, s30, 173056
    buffer_load_dwordx4 v[28:31], v2, s[8:11], s36 offen
    ds_read_b128 v[116:119], v3 offset:9216
    s_waitcnt lgkmcnt(7)
    v_mfma_f32_16x16x32_bf16 v[136:139], v[88:91], v[48:51], v[136:139]
    v_mfma_f32_16x16x32_bf16 v[140:143], v[88:91], v[52:55], v[140:143]
    ds_read_b128 v[80:83], v3 offset:10240
    s_waitcnt lgkmcnt(7)
    v_mfma_f32_16x16x32_bf16 v[144:147], v[92:95], v[48:51], v[144:147]
    v_mfma_f32_16x16x32_bf16 v[148:151], v[92:95], v[52:55], v[148:151]
    s_add_u32 s37, s30, 26624
    buffer_load_dwordx4 v[32:35], v2, s[8:11], s37 offen
    ds_read_b128 v[84:87], v3 offset:11264
    s_waitcnt lgkmcnt(7)
    v_mfma_f32_16x16x32_bf16 v[152:155], v[96:99], v[48:51], v[152:155]
    v_mfma_f32_16x16x32_bf16 v[156:159], v[96:99], v[52:55], v[156:159]
    ds_read_b128 v[88:91], v3 offset:12288
    s_waitcnt lgkmcnt(7)
    v_mfma_f32_16x16x32_bf16 v[160:163], v[100:103], v[48:51], v[160:163]
    v_mfma_f32_16x16x32_bf16 v[164:167], v[100:103], v[52:55], v[164:167]
    s_add_u32 s38, s30, 174080
    buffer_load_dwordx4 v[36:39], v2, s[8:11], s38 offen
    s_waitcnt vmcnt(12)
    s_barrier
    ds_read_b128 v[92:95], v3 offset:13312
    s_waitcnt lgkmcnt(7)
    v_mfma_f32_16x16x32_bf16 v[168:171], v[104:107], v[48:51], v[168:171]
    v_mfma_f32_16x16x32_bf16 v[172:175], v[104:107], v[52:55], v[172:175]
    ds_read_b128 v[96:99], v3 offset:14336
    s_waitcnt lgkmcnt(7)
    v_mfma_f32_16x16x32_bf16 v[176:179], v[108:111], v[48:51], v[176:179]
    v_mfma_f32_16x16x32_bf16 v[180:183], v[108:111], v[52:55], v[180:183]
    s_add_u32 s33, s31, 256000
    s_add_u32 m0, s32, 34816
    s_cmp_ge_u32 s26, 2
    s_cbranch_scc1 k4_kernel_skip5_14
    buffer_load_dwordx4 v2, s[12:15], s33 offen lds
k4_kernel_skip5_14:
    ds_read_b128 v[100:103], v3 offset:15360
    s_waitcnt lgkmcnt(7)
    v_mfma_f32_16x16x32_bf16 v[184:187], v[112:115], v[48:51], v[184:187]
    v_mfma_f32_16x16x32_bf16 v[188:191], v[112:115], v[52:55], v[188:191]
    ds_read_b128 v[104:107], v3 offset:16384
    s_waitcnt lgkmcnt(7)
    v_mfma_f32_16x16x32_bf16 v[120:123], v[116:119], v[56:59], v[120:123]
    v_mfma_f32_16x16x32_bf16 v[124:127], v[116:119], v[60:63], v[124:127]
    s_add_u32 s34, s31, 239616
    s_add_u32 m0, s32, 18432
    s_nop 0
    buffer_load_dwordx4 v2, s[12:15], s34 offen lds
    ds_read_b128 v[108:111], v3 offset:17408
    s_waitcnt lgkmcnt(7)
    v_mfma_f32_16x16x32_bf16 v[128:131], v[80:83], v[56:59], v[128:131]
    v_mfma_f32_16x16x32_bf16 v[132:135], v[80:83], v[60:63], v[132:135]
    ds_read_b128 v[112:115], v3 offset:18432
    s_waitcnt lgkmcnt(7)
    v_mfma_f32_16x16x32_bf16 v[136:139], v[84:87], v[56:59], v[136:139]
    v_mfma_f32_16x16x32_bf16 v[140:143], v[84:87], v[60:63], v[140:143]
    s_add_u32 s35, s31, 243712
    s_add_u32 m0, s32, 22528
    s_nop 0
    buffer_load_dwordx4 v2, s[12:15], s35 offen lds
    ds_read_b128 v[116:119], v3 offset:19456
    s_waitcnt lgkmcnt(7)
    v_mfma_f32_16x16x32_bf16 v[144:147], v[88:91], v[56:59], v[144:147]
    v_mfma_f32_16x16x32_bf16 v[148:151], v[88:91], v[60:63], v[148:151]
    ds_read_b128 v[80:83], v3 offset:20480
    s_waitcnt lgkmcnt(7)
    v_mfma_f32_16x16x32_bf16 v[152:155], v[92:95], v[56:59], v[152:155]
    v_mfma_f32_16x16x32_bf16 v[156:159], v[92:95], v[60:63], v[156:159]
    s_add_u32 s36, s31, 247808
    s_add_u32 m0, s32, 26624
    s_nop 0
    buffer_load_dwordx4 v2, s[12:15], s36 offen lds
    ds_read_b128 v[84:87], v3 offset:21504
    s_waitcnt lgkmcnt(7)
    v_mfma_f32_16x16x32_bf16 v[160:163], v[96:99], v[56:59], v[160:163]
    v_mfma_f32_16x16x32_bf16 v[164:167], v[96:99], v[60:63], v[164:167]
    ds_read_b128 v[88:91], v3 offset:22528
    s_waitcnt lgkmcnt(7)
    v_mfma_f32_16x16x32_bf16 v[168:171], v[100:103], v[56:59], v[168:171]
    v_mfma_f32_16x16x32_bf16 v[172:175], v[100:103], v[60:63], v[172:175]
    s_add_u32 s37, s31, 251904
    s_add_u32 m0, s32, 30720
    s_nop 0
    buffer_load_dwordx4 v2, s[12:15], s37 offen lds
    ds_read_b128 v[92:95], v3 offset:23552
    s_waitcnt lgkmcnt(7)
    v_mfma_f32_16x16x32_bf16 v[176:179], v[104:107], v[56:59], v[176:179]
    v_mfma_f32_16x16x32_bf16 v[180:183], v[104:107], v[60:63], v[180:183]
    ds_read_b128 v[96:99], v3 offset:24576
    s_waitcnt lgkmcnt(7)
    v_mfma_f32_16x16x32_bf16 v[184:187], v[108:111], v[56:59], v[184:187]
    v_mfma_f32_16x16x32_bf16 v[188:191], v[108:111], v[60:63], v[188:191]
    s_add_u32 s38, s30, 27648
    buffer_load_dwordx4 v[40:43], v2, s[8:11], s38 offen
    ds_read_b128 v[100:103], v3 offset:25600
    s_waitcnt lgkmcnt(7)
    v_mfma_f32_16x16x32_bf16 v[120:123], v[112:115], v[64:67], v[120:123]
    v_mfma_f32_16x16x32_bf16 v[124:127], v[112:115], v[68:71], v[124:127]
    ds_read_b128 v[104:107], v3 offset:26624
    s_waitcnt lgkmcnt(7)
    v_mfma_f32_16x16x32_bf16 v[128:131], v[116:119], v[64:67], v[128:131]
    v_mfma_f32_16x16x32_bf16 v[132:135], v[116:119], v[68:71], v[132:135]
    s_add_u32 s33, s30, 175104
    buffer_load_dwordx4 v[44:47], v2, s[8:11], s33 offen
    ds_read_b128 v[108:111], v3 offset:27648
    s_waitcnt lgkmcnt(7)
    v_mfma_f32_16x16x32_bf16 v[136:139], v[80:83], v[64:67], v[136:139]
    v_mfma_f32_16x16x32_bf16 v[140:143], v[80:83], v[68:71], v[140:143]
    ds_read_b128 v[112:115], v3 offset:28672
    s_waitcnt lgkmcnt(7)
    v_mfma_f32_16x16x32_bf16 v[144:147], v[84:87], v[64:67], v[144:147]
    v_mfma_f32_16x16x32_bf16 v[148:151], v[84:87], v[68:71], v[148:151]
    s_add_u32 s34, s30, 28672
    buffer_load_dwordx4 v[48:51], v2, s[8:11], s34 offen
    ds_read_b128 v[116:119], v3 offset:29696
    s_waitcnt lgkmcnt(7)
    v_mfma_f32_16x16x32_bf16 v[152:155], v[88:91], v[64:67], v[152:155]
    v_mfma_f32_16x16x32_bf16 v[156:159], v[88:91], v[68:71], v[156:159]
    ds_read_b128 v[80:83], v3 offset:30720
    s_waitcnt lgkmcnt(7)
    v_mfma_f32_16x16x32_bf16 v[160:163], v[92:95], v[64:67], v[160:163]
    v_mfma_f32_16x16x32_bf16 v[164:167], v[92:95], v[68:71], v[164:167]
    s_add_u32 s35, s30, 176128
    buffer_load_dwordx4 v[52:55], v2, s[8:11], s35 offen
    s_waitcnt vmcnt(12)
    s_barrier
    ds_read_b128 v[84:87], v3 offset:31744
    s_waitcnt lgkmcnt(7)
    v_mfma_f32_16x16x32_bf16 v[168:171], v[96:99], v[64:67], v[168:171]
    v_mfma_f32_16x16x32_bf16 v[172:175], v[96:99], v[68:71], v[172:175]
    ds_read_b128 v[88:91], v3 offset:32768
    s_waitcnt lgkmcnt(7)
    v_mfma_f32_16x16x32_bf16 v[176:179], v[100:103], v[64:67], v[176:179]
    v_mfma_f32_16x16x32_bf16 v[180:183], v[100:103], v[68:71], v[180:183]
    s_add_u32 s36, s31, 274432
    s_add_u32 m0, s32, 53248
    s_cmp_ge_u32 s26, 2
    s_cbranch_scc1 k4_kernel_skip5_15
    buffer_load_dwordx4 v2, s[12:15], s36 offen lds
k4_kernel_skip5_15:
    ds_read_b128 v[92:95], v3 offset:33792
    s_waitcnt lgkmcnt(7)
    v_mfma_f32_16x16x32_bf16 v[184:187], v[104:107], v[64:67], v[184:187]
    v_mfma_f32_16x16x32_bf16 v[188:191], v[104:107], v[68:71], v[188:191]
    ds_read_b128 v[96:99], v3 offset:34816
    s_waitcnt lgkmcnt(7)
    v_mfma_f32_16x16x32_bf16 v[120:123], v[108:111], v[72:75], v[120:123]
    v_mfma_f32_16x16x32_bf16 v[124:127], v[108:111], v[76:79], v[124:127]
    s_add_u32 s37, s31, 258048
    s_add_u32 m0, s32, 36864
    s_nop 0
    buffer_load_dwordx4 v2, s[12:15], s37 offen lds
    ds_read_b128 v[100:103], v3 offset:35840
    s_waitcnt lgkmcnt(7)
    v_mfma_f32_16x16x32_bf16 v[128:131], v[112:115], v[72:75], v[128:131]
    v_mfma_f32_16x16x32_bf16 v[132:135], v[112:115], v[76:79], v[132:135]
    ds_read_b128 v[104:107], v2 offset:0
    s_waitcnt lgkmcnt(7)
    v_mfma_f32_16x16x32_bf16 v[136:139], v[116:119], v[72:75], v[136:139]
    v_mfma_f32_16x16x32_bf16 v[140:143], v[116:119], v[76:79], v[140:143]
    s_add_u32 s38, s31, 262144
    s_add_u32 m0, s32, 40960
    s_nop 0
    buffer_load_dwordx4 v2, s[12:15], s38 offen lds
    ds_read_b128 v[108:111], v2 offset:1024
    s_waitcnt lgkmcnt(7)
    v_mfma_f32_16x16x32_bf16 v[144:147], v[80:83], v[72:75], v[144:147]
    v_mfma_f32_16x16x32_bf16 v[148:151], v[80:83], v[76:79], v[148:151]
    ds_read_b128 v[112:115], v2 offset:2048
    s_waitcnt lgkmcnt(7)
    v_mfma_f32_16x16x32_bf16 v[152:155], v[84:87], v[72:75], v[152:155]
    v_mfma_f32_16x16x32_bf16 v[156:159], v[84:87], v[76:79], v[156:159]
    s_add_u32 s33, s31, 266240
    s_add_u32 m0, s32, 45056
    s_nop 0
    buffer_load_dwordx4 v2, s[12:15], s33 offen lds
    ds_read_b128 v[116:119], v2 offset:3072
    s_waitcnt lgkmcnt(7)
    v_mfma_f32_16x16x32_bf16 v[160:163], v[88:91], v[72:75], v[160:163]
    v_mfma_f32_16x16x32_bf16 v[164:167], v[88:91], v[76:79], v[164:167]
    ds_read_b128 v[80:83], v2 offset:4096
    s_waitcnt lgkmcnt(7)
    v_mfma_f32_16x16x32_bf16 v[168:171], v[92:95], v[72:75], v[168:171]
    v_mfma_f32_16x16x32_bf16 v[172:175], v[92:95], v[76:79], v[172:175]
    s_add_u32 s34, s31, 270336
    s_add_u32 m0, s32, 49152
    s_nop 0
    buffer_load_dwordx4 v2, s[12:15], s34 offen lds
    ds_read_b128 v[84:87], v2 offset:5120
    s_waitcnt lgkmcnt(7)
    v_mfma_f32_16x16x32_bf16 v[176:179], v[96:99], v[72:75], v[176:179]
    v_mfma_f32_16x16x32_bf16 v[180:183], v[96:99], v[76:79], v[180:183]
    ds_read_b128 v[88:91], v2 offset:6144
    s_waitcnt lgkmcnt(7)
    v_mfma_f32_16x16x32_bf16 v[184:187], v[100:103], v[72:75], v[184:187]
    v_mfma_f32_16x16x32_bf16 v[188:191], v[100:103], v[76:79], v[188:191]
    s_add_u32 s35, s30, 29696
    buffer_load_dwordx4 v[56:59], v2, s[8:11], s35 offen
    ds_read_b128 v[92:95], v2 offset:7168
    s_waitcnt lgkmcnt(7)
    v_mfma_f32_16x16x32_bf16 v[120:123], v[104:107], v[16:19], v[120:123]
    v_mfma_f32_16x16x32_bf16 v[124:127], v[104:107], v[20:23], v[124:127]
    ds_read_b128 v[96:99], v2 offset:8192
    s_waitcnt lgkmcnt(7)
    v_mfma_f32_16x16x32_bf16 v[128:131], v[108:111], v[16:19], v[128:131]
    v_mfma_f32_16x16x32_bf16 v[132:135], v[108:111], v[20:23], v[132:135]
    s_add_u32 s36, s30, 177152
    buffer_load_dwordx4 v[60:63], v2, s[8:11], s36 offen
    ds_read_b128 v[100:103], v2 offset:9216
    s_waitcnt lgkmcnt(7)
    v_mfma_f32_16x16x32_bf16 v[136:139], v[112:115], v[16:19], v[136:139]
    v_mfma_f32_16x16x32_bf16 v[140:143], v[112:115], v[20:23], v[140:143]
    ds_read_b128 v[104:107], v2 offset:10240
    s_waitcnt lgkmcnt(7)
    v_mfma_f32_16x16x32_bf16 v[144:147], v[116:119], v[16:19], v[144:147]
    v_mfma_f32_16x16x32_bf16 v[148:151], v[116:119], v[20:23], v[148:151]
    s_add_u32 s37, s30, 30720
    buffer_load_dwordx4 v[64:67], v2, s[8:11], s37 offen
    ds_read_b128 v[108:111], v2 offset:11264
    s_waitcnt lgkmcnt(7)
    v_mfma_f32_16x16x32_bf16 v[152:155], v[80:83], v[16:19], v[152:155]
    v_mfma_f32_16x16x32_bf16 v[156:159], v[80:83], v[20:23], v[156:159]
    ds_read_b128 v[112:115], v2 offset:12288
    s_waitcnt lgkmcnt(7)
    v_mfma_f32_16x16x32_bf16 v[160:163], v[84:87], v[16:19], v[160:163]
    v_mfma_f32_16x16x32_bf16 v[164:167], v[84:87], v[20:23], v[164:167]
    s_add_u32 s38, s30, 178176
    buffer_load_dwordx4 v[68:71], v2, s[8:11], s38 offen
    s_waitcnt vmcnt(12)
    s_barrier
    ds_read_b128 v[116:119], v2 offset:13312
    s_waitcnt lgkmcnt(7)
    v_mfma_f32_16x16x32_bf16 v[168:171], v[88:91], v[16:19], v[168:171]
    v_mfma_f32_16x16x32_bf16 v[172:175], v[88:91], v[20:23], v[172:175]
    ds_read_b128 v[80:83], v2 offset:14336
    s_waitcnt lgkmcnt(7)
    v_mfma_f32_16x16x32_bf16 v[176:179], v[92:95], v[16:19], v[176:179]
    v_mfma_f32_16x16x32_bf16 v[180:183], v[92:95], v[20:23], v[180:183]
    s_add_u32 s33, s31, 292864
    s_add_u32 m0, s32, 71680
    s_cmp_ge_u32 s26, 2
    s_cbranch_scc1 k4_kernel_skip5_16
    buffer_load_dwordx4 v2, s[12:15], s33 offen lds
k4_kernel_skip5_16:
    ds_read_b128 v[84:87], v2 offset:15360
    s_waitcnt lgkmcnt(7)
    v_mfma_f32_16x16x32_bf16 v[184:187], v[96:99], v[16:19], v[184:187]
    v_mfma_f32_16x16x32_bf16 v[188:191], v[96:99], v[20:23], v[188:191]
    ds_read_b128 v[88:91], v2 offset:16384
    s_waitcnt lgkmcnt(7)
    v_mfma_f32_16x16x32_bf16 v[120:123], v[100:103], v[24:27], v[120:123]
    v_mfma_f32_16x16x32_bf16 v[124:127], v[100:103], v[28:31], v[124:127]
    s_add_u32 s34, s31, 276480
    s_add_u32 m0, s32, 55296
    s_nop 0
    buffer_load_dwordx4 v2, s[12:15], s34 offen lds
    ds_read_b128 v[92:95], v2 offset:17408
    s_waitcnt lgkmcnt(7)
    v_mfma_f32_16x16x32_bf16 v[128:131], v[104:107], v[24:27], v[128:131]
    v_mfma_f32_16x16x32_bf16 v[132:135], v[104:107], v[28:31], v[132:135]
    ds_read_b128 v[96:99], v2 offset:18432
    s_waitcnt lgkmcnt(7)
    v_mfma_f32_16x16x32_bf16 v[136:139], v[108:111], v[24:27], v[136:139]
    v_mfma_f32_16x16x32_bf16 v[140:143], v[108:111], v[28:31], v[140:143]
    s_add_u32 s35, s31, 280576
    s_add_u32 m0, s32, 59392
    s_nop 0
    buffer_load_dwordx4 v2, s[12:15], s35 offen lds
    ds_read_b128 v[100:103], v2 offset:19456
    s_waitcnt lgkmcnt(7)
    v_mfma_f32_16x16x32_bf16 v[144:147], v[112:115], v[24:27], v[144:147]
    v_mfma_f32_16x16x32_bf16 v[148:151], v[112:115], v[28:31], v[148:151]
    ds_read_b128 v[104:107], v2 offset:20480
    s_waitcnt lgkmcnt(7)
    v_mfma_f32_16x16x32_bf16 v[152:155], v[116:119], v[24:27], v[152:155]
    v_mfma_f32_16x16x32_bf16 v[156:159], v[116:119], v[28:31], v[156:159]
    s_add_u32 s36, s31, 284672
    s_add_u32 m0, s32, 63488
    s_nop 0
    buffer_load_dwordx4 v2, s[12:15], s36 offen lds
    ds_read_b128 v[108:111], v2 offset:21504
    s_waitcnt lgkmcnt(7)
    v_mfma_f32_16x16x32_bf16 v[160:163], v[80:83], v[24:27], v[160:163]
    v_mfma_f32_16x16x32_bf16 v[164:167], v[80:83], v[28:31], v[164:167]
    ds_read_b128 v[112:115], v2 offset:22528
    s_waitcnt lgkmcnt(7)
    v_mfma_f32_16x16x32_bf16 v[168:171], v[84:87], v[24:27], v[168:171]
    v_mfma_f32_16x16x32_bf16 v[172:175], v[84:87], v[28:31], v[172:175]
    s_add_u32 s37, s31, 288768
    s_add_u32 m0, s32, 67584
    s_nop 0
    buffer_load_dwordx4 v2, s[12:15], s37 offen lds
    ds_read_b128 v[116:119], v2 offset:23552
    s_waitcnt lgkmcnt(7)
    v_mfma_f32_16x16x32_bf16 v[176:179], v[88:91], v[24:27], v[176:179]
    v_mfma_f32_16x16x32_bf16 v[180:183], v[88:91], v[28:31], v[180:183]
    ds_read_b128 v[80:83], v2 offset:24576
    s_waitcnt lgkmcnt(7)
    v_mfma_f32_16x16x32_bf16 v[184:187], v[92:95], v[24:27], v[184:187]
    v_mfma_f32_16x16x32_bf16 v[188:191], v[92:95], v[28:31], v[188:191]
    s_add_u32 s38, s30, 31744
    buffer_load_dwordx4 v[72:75], v2, s[8:11], s38 offen
    ds_read_b128 v[84:87], v2 offset:25600
    s_waitcnt lgkmcnt(7)
    v_mfma_f32_16x16x32_bf16 v[120:123], v[96:99], v[32:35], v[120:123]
    v_mfma_f32_16x16x32_bf16 v[124:127], v[96:99], v[36:39], v[124:127]
    ds_read_b128 v[88:91], v2 offset:26624
    s_waitcnt lgkmcnt(7)
    v_mfma_f32_16x16x32_bf16 v[128:131], v[100:103], v[32:35], v[128:131]
    v_mfma_f32_16x16x32_bf16 v[132:135], v[100:103], v[36:39], v[132:135]
    s_add_u32 s33, s30, 179200
    buffer_load_dwordx4 v[76:79], v2, s[8:11], s33 offen
    ds_read_b128 v[92:95], v2 offset:27648
    s_waitcnt lgkmcnt(7)
    v_mfma_f32_16x16x32_bf16 v[136:139], v[104:107], v[32:35], v[136:139]
    v_mfma_f32_16x16x32_bf16 v[140:143], v[104:107], v[36:39], v[140:143]
    ds_read_b128 v[96:99], v2 offset:28672
    s_waitcnt lgkmcnt(7)
    v_mfma_f32_16x16x32_bf16 v[144:147], v[108:111], v[32:35], v[144:147]
    v_mfma_f32_16x16x32_bf16 v[148:151], v[108:111], v[36:39], v[148:151]
    s_add_u32 s34, s30, 32768
    buffer_load_dwordx4 v[16:19], v2, s[8:11], s34 offen
    ds_read_b128 v[100:103], v2 offset:29696
    s_waitcnt lgkmcnt(7)
    v_mfma_f32_16x16x32_bf16 v[152:155], v[112:115], v[32:35], v[152:155]
    v_mfma_f32_16x16x32_bf16 v[156:159], v[112:115], v[36:39], v[156:159]
    ds_read_b128 v[104:107], v2 offset:30720
    s_waitcnt lgkmcnt(7)
    v_mfma_f32_16x16x32_bf16 v[160:163], v[116:119], v[32:35], v[160:163]
    v_mfma_f32_16x16x32_bf16 v[164:167], v[116:119], v[36:39], v[164:167]
    s_add_u32 s35, s30, 180224
    buffer_load_dwordx4 v[20:23], v2, s[8:11], s35 offen
    s_waitcnt vmcnt(12)
    s_barrier
    ds_read_b128 v[108:111], v2 offset:31744
    s_waitcnt lgkmcnt(7)
    v_mfma_f32_16x16x32_bf16 v[168:171], v[80:83], v[32:35], v[168:171]
    v_mfma_f32_16x16x32_bf16 v[172:175], v[80:83], v[36:39], v[172:175]
    ds_read_b128 v[112:115], v2 offset:32768
    s_waitcnt lgkmcnt(7)
    v_mfma_f32_16x16x32_bf16 v[176:179], v[84:87], v[32:35], v[176:179]
    v_mfma_f32_16x16x32_bf16 v[180:183], v[84:87], v[36:39], v[180:183]
    s_add_u32 s36, s31, 311296
    s_add_u32 m0, s32, 16384
    s_cmp_ge_u32 s26, 2
    s_cbranch_scc1 k4_kernel_skip5_17
    buffer_load_dwordx4 v2, s[12:15], s36 offen lds
k4_kernel_skip5_17:
    ds_read_b128 v[116:119], v2 offset:33792
    s_waitcnt lgkmcnt(7)
    v_mfma_f32_16x16x32_bf16 v[184:187], v[88:91], v[32:35], v[184:187]
    v_mfma_f32_16x16x32_bf16 v[188:191], v[88:91], v[36:39], v[188:191]
    ds_read_b128 v[80:83], v2 offset:34816
    s_waitcnt lgkmcnt(7)
    v_mfma_f32_16x16x32_bf16 v[120:123], v[92:95], v[40:43], v[120:123]
    v_mfma_f32_16x16x32_bf16 v[124:127], v[92:95], v[44:47], v[124:127]
    s_add_u32 s37, s31, 294912
    s_add_u32 m0, s32, 0
    s_nop 0
    buffer_load_dwordx4 v2, s[12:15], s37 offen lds
    ds_read_b128 v[84:87], v2 offset:35840
    s_waitcnt lgkmcnt(7)
    v_mfma_f32_16x16x32_bf16 v[128:131], v[96:99], v[40:43], v[128:131]
    v_mfma_f32_16x16x32_bf16 v[132:135], v[96:99], v[44:47], v[132:135]
    ds_read_b128 v[88:91], v3 offset:0
    s_waitcnt lgkmcnt(7)
    v_mfma_f32_16x16x32_bf16 v[136:139], v[100:103], v[40:43], v[136:139]
    v_mfma_f32_16x16x32_bf16 v[140:143], v[100:103], v[44:47], v[140:143]
    s_add_u32 s38, s31, 299008
    s_add_u32 m0, s32, 4096
    s_nop 0
    buffer_load_dwordx4 v2, s[12:15], s38 offen lds
    ds_read_b128 v[92:95], v3 offset:1024
    s_waitcnt lgkmcnt(7)
    v_mfma_f32_16x16x32_bf16 v[144:147], v[104:107], v[40:43], v[144:147]
    v_mfma_f32_16x16x32_bf16 v[148:151], v[104:107], v[44:47], v[148:151]
    ds_read_b128 v[96:99], v3 offset:2048
    s_waitcnt lgkmcnt(7)
    v_mfma_f32_16x16x32_bf16 v[152:155], v[108:111], v[40:43], v[152:155]
    v_mfma_f32_16x16x32_bf16 v[156:159], v[108:111], v[44:47], v[156:159]
    s_add_u32 s33, s31, 303104
    s_add_u32 m0, s32, 8192
    s_nop 0
    buffer_load_dwordx4 v2, s[12:15], s33 offen lds
    ds_read_b128 v[100:103], v3 offset:3072
    s_waitcnt lgkmcnt(7)
    v_mfma_f32_16x16x32_bf16 v[160:163], v[112:115], v[40:43], v[160:163]
    v_mfma_f32_16x16x32_bf16 v[164:167], v[112:115], v[44:47], v[164:167]
    ds_read_b128 v[104:107], v3 offset:4096
    s_waitcnt lgkmcnt(7)
    v_mfma_f32_16x16x32_bf16 v[168:171], v[116:119], v[40:43], v[168:171]
    v_mfma_f32_16x16x32_bf16 v[172:175], v[116:119], v[44:47], v[172:175]
    s_add_u32 s34, s31, 307200
    s_add_u32 m0, s32, 12288
    s_nop 0
    buffer_load_dwordx4 v2, s[12:15], s34 offen lds
    ds_read_b128 v[108:111], v3 offset:5120
    s_waitcnt lgkmcnt(7)
    v_mfma_f32_16x16x32_bf16 v[176:179], v[80:83], v[40:43], v[176:179]
    v_mfma_f32_16x16x32_bf16 v[180:183], v[80:83], v[44:47], v[180:183]
    ds_read_b128 v[112:115], v3 offset:6144
    s_waitcnt lgkmcnt(7)
    v_mfma_f32_16x16x32_bf16 v[184:187], v[84:87], v[40:43], v[184:187]
    v_mfma_f32_16x16x32_bf16 v[188:191], v[84:87], v[44:47], v[188:191]
    s_add_u32 s35, s30, 33792
    buffer_load_dwordx4 v[24:27], v2, s[8:11], s35 offen
    ds_read_b128 v[116:119], v3 offset:7168
    s_waitcnt lgkmcnt(7)
    v_mfma_f32_16x16x32_bf16 v[120:123], v[88:91], v[48:51], v[120:123]
    v_mfma_f32_16x16x32_bf16 v[124:127], v[88:91], v[52:55], v[124:127]
    ds_read_b128 v[80:83], v3 offset:8192
    s_waitcnt lgkmcnt(7)
    v_mfma_f32_16x16x32_bf16 v[128:131], v[92:95], v[48:51], v[128:131]
    v_mfma_f32_16x16x32_bf16 v[132:135], v[92:95], v[52:55], v[132:135]
    s_add_u32 s36, s30, 181248
    buffer_load_dwordx4 v[28:31], v2, s[8:11], s36 offen
    ds_read_b128 v[84:87], v3 offset:9216
    s_waitcnt lgkmcnt(7)
    v_mfma_f32_16x16x32_bf16 v[136:139], v[96:99], v[48:51], v[136:139]
    v_mfma_f32_16x16x32_bf16 v[140:143], v[96:99], v[52:55], v[140:143]
    ds_read_b128 v[88:91], v3 offset:10240
    s_waitcnt lgkmcnt(7)
    v_mfma_f32_16x16x32_bf16 v[144:147], v[100:103], v[48:51], v[144:147]
    v_mfma_f32_16x16x32_bf16 v[148:151], v[100:103], v[52:55], v[148:151]
    s_add_u32 s37, s30, 34816
    buffer_load_dwordx4 v[32:35], v2, s[8:11], s37 offen
    ds_read_b128 v[92:95], v3 offset:11264
    s_waitcnt lgkmcnt(7)
    v_mfma_f32_16x16x32_bf16 v[152:155], v[104:107], v[48:51], v[152:155]
    v_mfma_f32_16x16x32_bf16 v[156:159], v[104:107], v[52:55], v[156:159]
    ds_read_b128 v[96:99], v3 offset:12288
    s_waitcnt lgkmcnt(7)
    v_mfma_f32_16x16x32_bf16 v[160:163], v[108:111], v[48:51], v[160:163]
    v_mfma_f32_16x16x32_bf16 v[164:167], v[108:111], v[52:55], v[164:167]
    s_add_u32 s38, s30, 182272
    buffer_load_dwordx4 v[36:39], v2, s[8:11], s38 offen
    s_waitcnt vmcnt(12)
    s_barrier
    ds_read_b128 v[100:103], v3 offset:13312
    s_waitcnt lgkmcnt(7)
    v_mfma_f32_16x16x32_bf16 v[168:171], v[112:115], v[48:51], v[168:171]
    v_mfma_f32_16x16x32_bf16 v[172:175], v[112:115], v[52:55], v[172:175]
    ds_read_b128 v[104:107], v3 offset:14336
    s_waitcnt lgkmcnt(7)
    v_mfma_f32_16x16x32_bf16 v[176:179], v[116:119], v[48:51], v[176:179]
    v_mfma_f32_16x16x32_bf16 v[180:183], v[116:119], v[52:55], v[180:183]
    s_add_u32 s33, s31, 329728
    s_add_u32 m0, s32, 34816
    s_cmp_ge_u32 s26, 2
    s_cbranch_scc1 k4_kernel_skip5_18
    buffer_load_dwordx4 v2, s[12:15], s33 offen lds
k4_kernel_skip5_18:
    ds_read_b128 v[108:111], v3 offset:15360
    s_waitcnt lgkmcnt(7)
    v_mfma_f32_16x16x32_bf16 v[184:187], v[80:83], v[48:51], v[184:187]
    v_mfma_f32_16x16x32_bf16 v[188:191], v[80:83], v[52:55], v[188:191]
    ds_read_b128 v[112:115], v3 offset:16384
    s_waitcnt lgkmcnt(7)
    v_mfma_f32_16x16x32_bf16 v[120:123], v[84:87], v[56:59], v[120:123]
    v_mfma_f32_16x16x32_bf16 v[124:127], v[84:87], v[60:63], v[124:127]
    s_add_u32 s34, s31, 313344
    s_add_u32 m0, s32, 18432
    s_nop 0
    buffer_load_dwordx4 v2, s[12:15], s34 offen lds
    ds_read_b128 v[116:119], v3 offset:17408
    s_waitcnt lgkmcnt(7)
    v_mfma_f32_16x16x32_bf16 v[128:131], v[88:91], v[56:59], v[128:131]
    v_mfma_f32_16x16x32_bf16 v[132:135], v[88:91], v[60:63], v[132:135]
    ds_read_b128 v[80:83], v3 offset:18432
    s_waitcnt lgkmcnt(7)
    v_mfma_f32_16x16x32_bf16 v[136:139], v[92:95], v[56:59], v[136:139]
    v_mfma_f32_16x16x32_bf16 v[140:143], v[92:95], v[60:63], v[140:143]
    s_add_u32 s35, s31, 317440
    s_add_u32 m0, s32, 22528
    s_nop 0
    buffer_load_dwordx4 v2, s[12:15], s35 offen lds
    ds_read_b128 v[84:87], v3 offset:19456
    s_waitcnt lgkmcnt(7)
    v_mfma_f32_16x16x32_bf16 v[144:147], v[96:99], v[56:59], v[144:147]
    v_mfma_f32_16x16x32_bf16 v[148:151], v[96:99], v[60:63], v[148:151]
    ds_read_b128 v[88:91], v3 offset:20480
    s_waitcnt lgkmcnt(7)
    v_mfma_f32_16x16x32_bf16 v[152:155], v[100:103], v[56:59], v[152:155]
    v_mfma_f32_16x16x32_bf16 v[156:159], v[100:103], v[60:63], v[156:159]
    s_add_u32 s36, s31, 321536
    s_add_u32 m0, s32, 26624
    s_nop 0
    buffer_load_dwordx4 v2, s[12:15], s36 offen lds
    ds_read_b128 v[92:95], v3 offset:21504
    s_waitcnt lgkmcnt(7)
    v_mfma_f32_16x16x32_bf16 v[160:163], v[104:107], v[56:59], v[160:163]
    v_mfma_f32_16x16x32_bf16 v[164:167], v[104:107], v[60:63], v[164:167]
    ds_read_b128 v[96:99], v3 offset:22528
    s_waitcnt lgkmcnt(7)
    v_mfma_f32_16x16x32_bf16 v[168:171], v[108:111], v[56:59], v[168:171]
    v_mfma_f32_16x16x32_bf16 v[172:175], v[108:111], v[60:63], v[172:175]
    s_add_u32 s37, s31, 325632
    s_add_u32 m0, s32, 30720
    s_nop 0
    buffer_load_dwordx4 v2, s[12:15], s37 offen lds
    ds_read_b128 v[100:103], v3 offset:23552
    s_waitcnt lgkmcnt(7)
    v_mfma_f32_16x16x32_bf16 v[176:179], v[112:115], v[56:59], v[176:179]
    v_mfma_f32_16x16x32_bf16 v[180:183], v[112:115], v[60:63], v[180:183]
    ds_read_b128 v[104:107], v3 offset:24576
    s_waitcnt lgkmcnt(7)
    v_mfma_f32_16x16x32_bf16 v[184:187], v[116:119], v[56:59], v[184:187]
    v_mfma_f32_16x16x32_bf16 v[188:191], v[116:119], v[60:63], v[188:191]
    s_add_u32 s38, s30, 35840
    buffer_load_dwordx4 v[40:43], v2, s[8:11], s38 offen
    v_lshrrev_b32 v6, 5, v0
    v_and_b32 v9, 15, v0
    v_bfe_u32 v8, v0, 4, 1
    v_lshl_add_u32 v6, v6, 5, v9
    v_lshlrev_b32 v6, 4, v6
    v_lshl_add_u32 v6, v8, 3, v6
    s_lshl_b32 s28, s25, 2
    s_add_u32 s28, s28, s26
    s_mul_i32 s28, s28, 36
    s_mul_i32 s29, s24, 9
    s_add_u32 s28, s28, s29
    s_add_u32 s28, s28, s22
    s_lshl_b32 s28, s28, 10
    s_add_u32 s29, s28, 0
    buffer_load_dwordx2 v[192:193], v6, s[44:47], s29 offen offset:0
    buffer_load_dwordx2 v[194:195], v6, s[44:47], s29 offen offset:256
    s_add_u32 s29, s28, 4096
    buffer_load_dwordx2 v[196:197], v6, s[44:47], s29 offen offset:0
    buffer_load_dwordx2 v[198:199], v6, s[44:47], s29 offen offset:256
    s_add_u32 s29, s28, 8192
    buffer_load_dwordx2 v[200:201], v6, s[44:47], s29 offen offset:0
    buffer_load_dwordx2 v[202:203], v6, s[44:47], s29 offen offset:256
    ds_read_b128 v[108:111], v3 offset:25600
    s_waitcnt lgkmcnt(7)
    v_mfma_f32_16x16x32_bf16 v[120:123], v[80:83], v[64:67], v[120:123]
    v_mfma_f32_16x16x32_bf16 v[124:127], v[80:83], v[68:71], v[124:127]
    ds_read_b128 v[112:115], v3 offset:26624
    s_waitcnt lgkmcnt(7)
    v_mfma_f32_16x16x32_bf16 v[128:131], v[84:87], v[64:67], v[128:131]
    v_mfma_f32_16x16x32_bf16 v[132:135], v[84:87], v[68:71], v[132:135]
    s_add_u32 s33, s30, 183296
    buffer_load_dwordx4 v[44:47], v2, s[8:11], s33 offen
    ds_read_b128 v[116:119], v3 offset:27648
    s_waitcnt lgkmcnt(7)
    v_mfma_f32_16x16x32_bf16 v[136:139], v[88:91], v[64:67], v[136:139]
    v_mfma_f32_16x16x32_bf16 v[140:143], v[88:91], v[68:71], v[140:143]
    ds_read_b128 v[80:83], v3 offset:28672
    s_waitcnt lgkmcnt(7)
    v_mfma_f32_16x16x32_bf16 v[144:147], v[92:95], v[64:67], v[144:147]
    v_mfma_f32_16x16x32_bf16 v[148:151], v[92:95], v[68:71], v[148:151]
    ds_read_b128 v[84:87], v3 offset:29696
    s_waitcnt lgkmcnt(7)
    v_mfma_f32_16x16x32_bf16 v[152:155], v[96:99], v[64:67], v[152:155]
    v_mfma_f32_16x16x32_bf16 v[156:159], v[96:99], v[68:71], v[156:159]
    ds_read_b128 v[88:91], v3 offset:30720
    s_waitcnt lgkmcnt(7)
    v_mfma_f32_16x16x32_bf16 v[160:163], v[100:103], v[64:67], v[160:163]
    v_mfma_f32_16x16x32_bf16 v[164:167], v[100:103], v[68:71], v[164:167]
    s_waitcnt vmcnt(16)
    s_barrier
    ds_read_b128 v[92:95], v3 offset:31744
    s_waitcnt lgkmcnt(7)
    v_mfma_f32_16x16x32_bf16 v[168:171], v[104:107], v[64:67], v[168:171]
    v_mfma_f32_16x16x32_bf16 v[172:175], v[104:107], v[68:71], v[172:175]
    ds_read_b128 v[96:99], v3 offset:32768
    s_waitcnt lgkmcnt(7)
    v_mfma_f32_16x16x32_bf16 v[176:179], v[108:111], v[64:67], v[176:179]
    v_mfma_f32_16x16x32_bf16 v[180:183], v[108:111], v[68:71], v[180:183]
    ds_read_b128 v[100:103], v3 offset:33792
    s_waitcnt lgkmcnt(7)
    v_mfma_f32_16x16x32_bf16 v[184:187], v[112:115], v[64:67], v[184:187]
    v_mfma_f32_16x16x32_bf16 v[188:191], v[112:115], v[68:71], v[188:191]
    ds_read_b128 v[104:107], v3 offset:34816
    s_waitcnt lgkmcnt(7)
    v_mfma_f32_16x16x32_bf16 v[120:123], v[116:119], v[72:75], v[120:123]
    v_mfma_f32_16x16x32_bf16 v[124:127], v[116:119], v[76:79], v[124:127]
    ds_read_b128 v[108:111], v3 offset:35840
    s_waitcnt lgkmcnt(7)
    v_mfma_f32_16x16x32_bf16 v[128:131], v[80:83], v[72:75], v[128:131]
    v_mfma_f32_16x16x32_bf16 v[132:135], v[80:83], v[76:79], v[132:135]
    ds_read_b128 v[112:115], v2 offset:0
    s_waitcnt lgkmcnt(7)
    v_mfma_f32_16x16x32_bf16 v[136:139], v[84:87], v[72:75], v[136:139]
    v_mfma_f32_16x16x32_bf16 v[140:143], v[84:87], v[76:79], v[140:143]
    ds_read_b128 v[116:119], v2 offset:1024
    s_waitcnt lgkmcnt(7)
    v_mfma_f32_16x16x32_bf16 v[144:147], v[88:91], v[72:75], v[144:147]
    v_mfma_f32_16x16x32_bf16 v[148:151], v[88:91], v[76:79], v[148:151]
    ds_read_b128 v[80:83], v2 offset:2048
    s_waitcnt lgkmcnt(7)
    v_mfma_f32_16x16x32_bf16 v[152:155], v[92:95], v[72:75], v[152:155]
    v_mfma_f32_16x16x32_bf16 v[156:159], v[92:95], v[76:79], v[156:159]
    ds_read_b128 v[84:87], v2 offset:3072
    s_waitcnt lgkmcnt(7)
    v_mfma_f32_16x16x32_bf16 v[160:163], v[96:99], v[72:75], v[160:163]
    v_mfma_f32_16x16x32_bf16 v[164:167], v[96:99], v[76:79], v[164:167]
    ds_read_b128 v[88:91], v2 offset:4096
    s_waitcnt lgkmcnt(7)
    v_mfma_f32_16x16x32_bf16 v[168:171], v[100:103], v[72:75], v[168:171]
    v_mfma_f32_16x16x32_bf16 v[172:175], v[100:103], v[76:79], v[172:175]
    ds_read_b128 v[92:95], v2 offset:5120
    s_waitcnt lgkmcnt(7)
    v_mfma_f32_16x16x32_bf16 v[176:179], v[104:107], v[72:75], v[176:179]
    v_mfma_f32_16x16x32_bf16 v[180:183], v[104:107], v[76:79], v[180:183]
    ds_read_b128 v[96:99], v2 offset:6144
    s_waitcnt lgkmcnt(7)
    v_mfma_f32_16x16x32_bf16 v[184:187], v[108:111], v[72:75], v[184:187]
    v_mfma_f32_16x16x32_bf16 v[188:191], v[108:111], v[76:79], v[188:191]
    ds_read_b128 v[100:103], v2 offset:7168
    s_waitcnt lgkmcnt(7)
    v_mfma_f32_16x16x32_bf16 v[120:123], v[112:115], v[16:19], v[120:123]
    v_mfma_f32_16x16x32_bf16 v[124:127], v[112:115], v[20:23], v[124:127]
    ds_read_b128 v[104:107], v2 offset:8192
    s_waitcnt lgkmcnt(7)
    v_mfma_f32_16x16x32_bf16 v[128:131], v[116:119], v[16:19], v[128:131]
    v_mfma_f32_16x16x32_bf16 v[132:135], v[116:119], v[20:23], v[132:135]
    ds_read_b128 v[108:111], v2 offset:9216
    s_waitcnt lgkmcnt(7)
    v_mfma_f32_16x16x32_bf16 v[136:139], v[80:83], v[16:19], v[136:139]
    v_mfma_f32_16x16x32_bf16 v[140:143], v[80:83], v[20:23], v[140:143]
    ds_read_b128 v[112:115], v2 offset:10240
    s_waitcnt lgkmcnt(7)
    v_mfma_f32_16x16x32_bf16 v[144:147], v[84:87], v[16:19], v[144:147]
    v_mfma_f32_16x16x32_bf16 v[148:151], v[84:87], v[20:23], v[148:151]
    ds_read_b128 v[116:119], v2 offset:11264
    s_waitcnt lgkmcnt(7)
    v_mfma_f32_16x16x32_bf16 v[152:155], v[88:91], v[16:19], v[152:155]
    v_mfma_f32_16x16x32_bf16 v[156:159], v[88:91], v[20:23], v[156:159]
    ds_read_b128 v[80:83], v2 offset:12288
    s_waitcnt lgkmcnt(7)
    v_mfma_f32_16x16x32_bf16 v[160:163], v[92:95], v[16:19], v[160:163]
    v_mfma_f32_16x16x32_bf16 v[164:167], v[92:95], v[20:23], v[164:167]
    s_waitcnt vmcnt(8)
    s_barrier
    ds_read_b128 v[84:87], v2 offset:13312
    s_waitcnt lgkmcnt(7)
    v_mfma_f32_16x16x32_bf16 v[168:171], v[96:99], v[16:19], v[168:171]
    v_mfma_f32_16x16x32_bf16 v[172:175], v[96:99], v[20:23], v[172:175]
    ds_read_b128 v[88:91], v2 offset:14336
    s_waitcnt lgkmcnt(7)
    v_mfma_f32_16x16x32_bf16 v[176:179], v[100:103], v[16:19], v[176:179]
    v_mfma_f32_16x16x32_bf16 v[180:183], v[100:103], v[20:23], v[180:183]
    ds_read_b128 v[92:95], v2 offset:15360
    s_waitcnt lgkmcnt(7)
    v_mfma_f32_16x16x32_bf16 v[184:187], v[104:107], v[16:19], v[184:187]
    v_mfma_f32_16x16x32_bf16 v[188:191], v[104:107], v[20:23], v[188:191]
    ds_read_b128 v[96:99], v2 offset:16384
    s_waitcnt lgkmcnt(7)
    v_mfma_f32_16x16x32_bf16 v[120:123], v[108:111], v[24:27], v[120:123]
    v_mfma_f32_16x16x32_bf16 v[124:127], v[108:111], v[28:31], v[124:127]
    ds_read_b128 v[100:103], v2 offset:17408
    s_waitcnt lgkmcnt(7)
    v_mfma_f32_16x16x32_bf16 v[128:131], v[112:115], v[24:27], v[128:131]
    v_mfma_f32_16x16x32_bf16 v[132:135], v[112:115], v[28:31], v[132:135]
    ds_read_b128 v[104:107], v2 offset:18432
    s_waitcnt lgkmcnt(7)
    v_mfma_f32_16x16x32_bf16 v[136:139], v[116:119], v[24:27], v[136:139]
    v_mfma_f32_16x16x32_bf16 v[140:143], v[116:119], v[28:31], v[140:143]
    ds_read_b128 v[108:111], v2 offset:19456
    s_waitcnt lgkmcnt(7)
    v_mfma_f32_16x16x32_bf16 v[144:147], v[80:83], v[24:27], v[144:147]
    v_mfma_f32_16x16x32_bf16 v[148:151], v[80:83], v[28:31], v[148:151]
    ds_read_b128 v[112:115], v2 offset:20480
    s_waitcnt lgkmcnt(7)
    v_mfma_f32_16x16x32_bf16 v[152:155], v[84:87], v[24:27], v[152:155]
    v_mfma_f32_16x16x32_bf16 v[156:159], v[84:87], v[28:31], v[156:159]
    ds_read_b128 v[116:119], v2 offset:21504
    s_waitcnt lgkmcnt(7)
    v_mfma_f32_16x16x32_bf16 v[160:163], v[88:91], v[24:27], v[160:163]
    v_mfma_f32_16x16x32_bf16 v[164:167], v[88:91], v[28:31], v[164:167]
    ds_read_b128 v[80:83], v2 offset:22528
    s_waitcnt lgkmcnt(7)
    v_mfma_f32_16x16x32_bf16 v[168:171], v[92:95], v[24:27], v[168:171]
    v_mfma_f32_16x16x32_bf16 v[172:175], v[92:95], v[28:31], v[172:175]
    ds_read_b128 v[84:87], v2 offset:23552
    s_waitcnt lgkmcnt(7)
    v_mfma_f32_16x16x32_bf16 v[176:179], v[96:99], v[24:27], v[176:179]
    v_mfma_f32_16x16x32_bf16 v[180:183], v[96:99], v[28:31], v[180:183]
    ds_read_b128 v[88:91], v2 offset:24576
    s_waitcnt lgkmcnt(7)
    v_mfma_f32_16x16x32_bf16 v[184:187], v[100:103], v[24:27], v[184:187]
    v_mfma_f32_16x16x32_bf16 v[188:191], v[100:103], v[28:31], v[188:191]
    ds_read_b128 v[92:95], v2 offset:25600
    s_waitcnt lgkmcnt(7)
    v_mfma_f32_16x16x32_bf16 v[120:123], v[104:107], v[32:35], v[120:123]
    v_mfma_f32_16x16x32_bf16 v[124:127], v[104:107], v[36:39], v[124:127]
    ds_read_b128 v[96:99], v2 offset:26624
    s_waitcnt lgkmcnt(7)
    v_mfma_f32_16x16x32_bf16 v[128:131], v[108:111], v[32:35], v[128:131]
    v_mfma_f32_16x16x32_bf16 v[132:135], v[108:111], v[36:39], v[132:135]
    ds_read_b128 v[100:103], v2 offset:27648
    s_waitcnt lgkmcnt(7)
    v_mfma_f32_16x16x32_bf16 v[136:139], v[112:115], v[32:35], v[136:139]
    v_mfma_f32_16x16x32_bf16 v[140:143], v[112:115], v[36:39], v[140:143]
    ds_read_b128 v[104:107], v2 offset:28672
    s_waitcnt lgkmcnt(7)
    v_mfma_f32_16x16x32_bf16 v[144:147], v[116:119], v[32:35], v[144:147]
    v_mfma_f32_16x16x32_bf16 v[148:151], v[116:119], v[36:39], v[148:151]
    ds_read_b128 v[108:111], v2 offset:29696
    s_waitcnt lgkmcnt(7)
    v_mfma_f32_16x16x32_bf16 v[152:155], v[80:83], v[32:35], v[152:155]
    v_mfma_f32_16x16x32_bf16 v[156:159], v[80:83], v[36:39], v[156:159]
    ds_read_b128 v[112:115], v2 offset:30720
    s_waitcnt lgkmcnt(7)
    v_mfma_f32_16x16x32_bf16 v[160:163], v[84:87], v[32:35], v[160:163]
    v_mfma_f32_16x16x32_bf16 v[164:167], v[84:87], v[36:39], v[164:167]
    ds_read_b128 v[116:119], v2 offset:31744
    s_waitcnt lgkmcnt(7)
    v_mfma_f32_16x16x32_bf16 v[168:171], v[88:91], v[32:35], v[168:171]
    v_mfma_f32_16x16x32_bf16 v[172:175], v[88:91], v[36:39], v[172:175]
    ds_read_b128 v[80:83], v2 offset:32768
    s_waitcnt lgkmcnt(7)
    v_mfma_f32_16x16x32_bf16 v[176:179], v[92:95], v[32:35], v[176:179]
    v_mfma_f32_16x16x32_bf16 v[180:183], v[92:95], v[36:39], v[180:183]
    ds_read_b128 v[84:87], v2 offset:33792
    s_waitcnt lgkmcnt(7)
    v_mfma_f32_16x16x32_bf16 v[184:187], v[96:99], v[32:35], v[184:187]
    v_mfma_f32_16x16x32_bf16 v[188:191], v[96:99], v[36:39], v[188:191]
    s_waitcnt vmcnt(0)
    ds_read_b128 v[88:91], v2 offset:34816
    s_waitcnt lgkmcnt(7)
    v_mfma_f32_16x16x32_bf16 v[120:123], v[100:103], v[40:43], v[120:123]
    v_mfma_f32_16x16x32_bf16 v[124:127], v[100:103], v[44:47], v[124:127]
    ds_read_b128 v[92:95], v2 offset:35840
    s_waitcnt lgkmcnt(7)
    v_mfma_f32_16x16x32_bf16 v[128:131], v[104:107], v[40:43], v[128:131]
    v_mfma_f32_16x16x32_bf16 v[132:135], v[104:107], v[44:47], v[132:135]
    s_waitcnt lgkmcnt(6)
    v_mfma_f32_16x16x32_bf16 v[136:139], v[108:111], v[40:43], v[136:139]
    v_mfma_f32_16x16x32_bf16 v[140:143], v[108:111], v[44:47], v[140:143]
    s_cmp_lg_u32 s22, 0
    s_cbranch_scc1 k4_kernel_noh_19
    v_lshlrev_b32 v10, 16, v192
    v_and_b32 v11, 0xffff0000, v192
    v_lshlrev_b32 v12, 16, v193
    v_and_b32 v13, 0xffff0000, v193
    v_add_f32 v120, v120, v10
    v_add_f32 v121, v121, v11
    v_add_f32 v122, v122, v12
    v_add_f32 v123, v123, v13
    v_lshlrev_b32 v10, 16, v194
    v_and_b32 v11, 0xffff0000, v194
    v_lshlrev_b32 v12, 16, v195
    v_and_b32 v13, 0xffff0000, v195
    v_add_f32 v124, v124, v10
    v_add_f32 v125, v125, v11
    v_add_f32 v126, v126, v12
    v_add_f32 v127, v127, v13
k4_kernel_noh_19:
    v_cvt_pk_bf16_f32 v120, v120, v121
    v_cvt_pk_bf16_f32 v121, v122, v123
    ds_write_b64 v7, v[120:121] offset:0
    v_cvt_pk_bf16_f32 v124, v124, v125
    v_cvt_pk_bf16_f32 v125, v126, v127
    ds_write_b64 v7, v[124:125] offset:4864
    s_waitcnt lgkmcnt(7)
    v_mfma_f32_16x16x32_bf16 v[144:147], v[112:115], v[40:43], v[144:147]
    v_mfma_f32_16x16x32_bf16 v[148:151], v[112:115], v[44:47], v[148:151]
    s_cmp_lg_u32 s22, 1
    s_cbranch_scc1 k4_kernel_noh_20
    v_lshlrev_b32 v10, 16, v192
    v_and_b32 v11, 0xffff0000, v192
    v_lshlrev_b32 v12, 16, v193
    v_and_b32 v13, 0xffff0000, v193
    v_add_f32 v128, v128, v10
    v_add_f32 v129, v129, v11
    v_add_f32 v130, v130, v12
    v_add_f32 v131, v131, v13
    v_lshlrev_b32 v10, 16, v194
    v_and_b32 v11, 0xffff0000, v194
    v_lshlrev_b32 v12, 16, v195
    v_and_b32 v13, 0xffff0000, v195
    v_add_f32 v132, v132, v10
    v_add_f32 v133, v133, v11
    v_add_f32 v134, v134, v12
    v_add_f32 v135, v135, v13
k4_kernel_noh_20:
    v_cvt_pk_bf16_f32 v128, v128, v129
    v_cvt_pk_bf16_f32 v129, v130, v131
    ds_write_b64 v7, v[128:129] offset:32
    v_cvt_pk_bf16_f32 v132, v132, v133
    v_cvt_pk_bf16_f32 v133, v134, v135
    ds_write_b64 v7, v[132:133] offset:4896
    s_waitcnt lgkmcnt(8)
    v_mfma_f32_16x16x32_bf16 v[152:155], v[116:119], v[40:43], v[152:155]
    v_mfma_f32_16x16x32_bf16 v[156:159], v[116:119], v[44:47], v[156:159]
    s_cmp_lg_u32 s22, 2
    s_cbranch_scc1 k4_kernel_noh_21
    v_lshlrev_b32 v10, 16, v192
    v_and_b32 v11, 0xffff0000, v192
    v_lshlrev_b32 v12, 16, v193
    v_and_b32 v13, 0xffff0000, v193
    v_add_f32 v136, v136, v10
    v_add_f32 v137, v137, v11
    v_add_f32 v138, v138, v12
    v_add_f32 v139, v139, v13
    v_lshlrev_b32 v10, 16, v194
    v_and_b32 v11, 0xffff0000, v194
    v_lshlrev_b32 v12, 16, v195
    v_and_b32 v13, 0xffff0000, v195
    v_add_f32 v140, v140, v10
    v_add_f32 v141, v141, v11
    v_add_f32 v142, v142, v12
    v_add_f32 v143, v143, v13
k4_kernel_noh_21:
    v_cvt_pk_bf16_f32 v136, v136, v137
    v_cvt_pk_bf16_f32 v137, v138, v139
    ds_write_b64 v7, v[136:137] offset:64
    v_cvt_pk_bf16_f32 v140, v140, v141
    v_cvt_pk_bf16_f32 v141, v142, v143
    ds_write_b64 v7, v[140:141] offset:4928
    s_waitcnt lgkmcnt(9)
    v_mfma_f32_16x16x32_bf16 v[160:163], v[80:83], v[40:43], v[160:163]
    v_mfma_f32_16x16x32_bf16 v[164:167], v[80:83], v[44:47], v[164:167]
    s_cmp_lg_u32 s22, 3
    s_cbranch_scc1 k4_kernel_noh_22
    v_lshlrev_b32 v10, 16, v192
    v_and_b32 v11, 0xffff0000, v192
    v_lshlrev_b32 v12, 16, v193
    v_and_b32 v13, 0xffff0000, v193
    v_add_f32 v144, v144, v10
    v_add_f32 v145, v145, v11
    v_add_f32 v146, v146, v12
    v_add_f32 v147, v147, v13
    v_lshlrev_b32 v10, 16, v194
    v_and_b32 v11, 0xffff0000, v194
    v_lshlrev_b32 v12, 16, v195
    v_and_b32 v13, 0xffff0000, v195
    v_add_f32 v148, v148, v10
    v_add_f32 v149, v149, v11
    v_add_f32 v150, v150, v12
    v_add_f32 v151, v151, v13
k4_kernel_noh_22:
    v_cvt_pk_bf16_f32 v144, v144, v145
    v_cvt_pk_bf16_f32 v145, v146, v147
    ds_write_b64 v7, v[144:145] offset:96
    v_cvt_pk_bf16_f32 v148, v148, v149
    v_cvt_pk_bf16_f32 v149, v150, v151
    ds_write_b64 v7, v[148:149] offset:4960
    s_waitcnt lgkmcnt(10)
    v_mfma_f32_16x16x32_bf16 v[168:171], v[84:87], v[40:43], v[168:171]
    v_mfma_f32_16x16x32_bf16 v[172:175], v[84:87], v[44:47], v[172:175]
    s_cmp_lg_u32 s22, 0
    s_cbranch_scc1 k4_kernel_noh_23
    v_lshlrev_b32 v10, 16, v196
    v_and_b32 v11, 0xffff0000, v196
    v_lshlrev_b32 v12, 16, v197
    v_and_b32 v13, 0xffff0000, v197
    v_add_f32 v152, v152, v10
    v_add_f32 v153, v153, v11
    v_add_f32 v154, v154, v12
    v_add_f32 v155, v155, v13
    v_lshlrev_b32 v10, 16, v198
    v_and_b32 v11, 0xffff0000, v198
    v_lshlrev_b32 v12, 16, v199
    v_and_b32 v13, 0xffff0000, v199
    v_add_f32 v156, v156, v10
    v_add_f32 v157, v157, v11
    v_add_f32 v158, v158, v12
    v_add_f32 v159, v159, v13
k4_kernel_noh_23:
    v_cvt_pk_bf16_f32 v152, v152, v153
    v_cvt_pk_bf16_f32 v153, v154, v155
    ds_write_b64 v7, v[152:153] offset:128
    v_cvt_pk_bf16_f32 v156, v156, v157
    v_cvt_pk_bf16_f32 v157, v158, v159
    ds_write_b64 v7, v[156:157] offset:4992
    s_waitcnt lgkmcnt(11)
    v_mfma_f32_16x16x32_bf16 v[176:179], v[88:91], v[40:43], v[176:179]
    v_mfma_f32_16x16x32_bf16 v[180:183], v[88:91], v[44:47], v[180:183]
    s_cmp_lg_u32 s22, 1
    s_cbranch_scc1 k4_kernel_noh_24
    v_lshlrev_b32 v10, 16, v196
    v_and_b32 v11, 0xffff0000, v196
    v_lshlrev_b32 v12, 16, v197
    v_and_b32 v13, 0xffff0000, v197
    v_add_f32 v160, v160, v10
    v_add_f32 v161, v161, v11
    v_add_f32 v162, v162, v12
    v_add_f32 v163, v163, v13
    v_lshlrev_b32 v10, 16, v198
    v_and_b32 v11, 0xffff0000, v198
    v_lshlrev_b32 v12, 16, v199
    v_and_b32 v13, 0xffff0000, v199
    v_add_f32 v164, v164, v10
    v_add_f32 v165, v165, v11
    v_add_f32 v166, v166, v12
    v_add_f32 v167, v167, v13
k4_kernel_noh_24:
    v_cvt_pk_bf16_f32 v160, v160, v161
    v_cvt_pk_bf16_f32 v161, v162, v163
    ds_write_b64 v7, v[160:161] offset:160
    v_cvt_pk_bf16_f32 v164, v164, v165
    v_cvt_pk_bf16_f32 v165, v166, v167
    ds_write_b64 v7, v[164:165] offset:5024
    s_waitcnt lgkmcnt(12)
    v_mfma_f32_16x16x32_bf16 v[184:187], v[92:95], v[40:43], v[184:187]
    v_mfma_f32_16x16x32_bf16 v[188:191], v[92:95], v[44:47], v[188:191]
    s_cmp_lg_u32 s22, 2
    s_cbranch_scc1 k4_kernel_noh_25
    v_lshlrev_b32 v10, 16, v196
    v_and_b32 v11, 0xffff0000, v196
    v_lshlrev_b32 v12, 16, v197
    v_and_b32 v13, 0xffff0000, v197
    v_add_f32 v168, v168, v10
    v_add_f32 v169, v169, v11
    v_add_f32 v170, v170, v12
    v_add_f32 v171, v171, v13
    v_lshlrev_b32 v10, 16, v198
    v_and_b32 v11, 0xffff0000, v198
    v_lshlrev_b32 v12, 16, v199
    v_and_b32 v13, 0xffff0000, v199
    v_add_f32 v172, v172, v10
    v_add_f32 v173, v173, v11
    v_add_f32 v174, v174, v12
    v_add_f32 v175, v175, v13
k4_kernel_noh_25:
    v_cvt_pk_bf16_f32 v168, v168, v169
    v_cvt_pk_bf16_f32 v169, v170, v171
    ds_write_b64 v7, v[168:169] offset:192
    v_cvt_pk_bf16_f32 v172, v172, v173
    v_cvt_pk_bf16_f32 v173, v174, v175
    ds_write_b64 v7, v[172:173] offset:5056
    s_cmp_lg_u32 s22, 3
    s_cbranch_scc1 k4_kernel_noh_26
    v_lshlrev_b32 v10, 16, v196
    v_and_b32 v11, 0xffff0000, v196
    v_lshlrev_b32 v12, 16, v197
    v_and_b32 v13, 0xffff0000, v197
    v_add_f32 v176, v176, v10
    v_add_f32 v177, v177, v11
    v_add_f32 v178, v178, v12
    v_add_f32 v179, v179, v13
    v_lshlrev_b32 v10, 16, v198
    v_and_b32 v11, 0xffff0000, v198
    v_lshlrev_b32 v12, 16, v199
    v_and_b32 v13, 0xffff0000, v199
    v_add_f32 v180, v180, v10
    v_add_f32 v181, v181, v11
    v_add_f32 v182, v182, v12
    v_add_f32 v183, v183, v13
k4_kernel_noh_26:
    v_cvt_pk_bf16_f32 v176, v176, v177
    v_cvt_pk_bf16_f32 v177, v178, v179
    ds_write_b64 v7, v[176:177] offset:224
    v_cvt_pk_bf16_f32 v180, v180, v181
    v_cvt_pk_bf16_f32 v181, v182, v183
    ds_write_b64 v7, v[180:181] offset:5088
    s_cmp_lg_u32 s22, 0
    s_cbranch_scc1 k4_kernel_noh_27
    v_lshlrev_b32 v10, 16, v200
    v_and_b32 v11, 0xffff0000, v200
    v_lshlrev_b32 v12, 16, v201
    v_and_b32 v13, 0xffff0000, v201
    v_add_f32 v184, v184, v10
    v_add_f32 v185, v185, v11
    v_add_f32 v186, v186, v12
    v_add_f32 v187, v187, v13
    v_lshlrev_b32 v10, 16, v202
    v_and_b32 v11, 0xffff0000, v202
    v_lshlrev_b32 v12, 16, v203
    v_and_b32 v13, 0xffff0000, v203
    v_add_f32 v188, v188, v10
    v_add_f32 v189, v189, v11
    v_add_f32 v190, v190, v12
    v_add_f32 v191, v191, v13
k4_kernel_noh_27:
    v_cvt_pk_bf16_f32 v184, v184, v185
    v_cvt_pk_bf16_f32 v185, v186, v187
    ds_write_b64 v7, v[184:185] offset:256
    v_cvt_pk_bf16_f32 v188, v188, v189
    v_cvt_pk_bf16_f32 v189, v190, v191
    ds_write_b64 v7, v[188:189] offset:5120
    s_waitcnt lgkmcnt(0)
    ds_read_b128 v[80:83], v204
    ds_read_b128 v[84:87], v205
    ds_read_b128 v[88:91], v206
    ds_read_b128 v[92:95], v207
    ds_read_b128 v[96:99], v208
    ds_read_b128 v[100:103], v209
    ds_read_b128 v[104:107], v210
    ds_read_b128 v[108:111], v211
    ds_read_b128 v[112:115], v212
    s_waitcnt lgkmcnt(8)
    buffer_store_dwordx4 v[80:83], v213, s[16:19], s41 offen
    s_waitcnt lgkmcnt(7)
    buffer_store_dwordx4 v[84:87], v214, s[16:19], s41 offen
    s_waitcnt lgkmcnt(6)
    buffer_store_dwordx4 v[88:91], v215, s[16:19], s41 offen
    s_waitcnt lgkmcnt(5)
    buffer_store_dwordx4 v[92:95], v216, s[16:19], s41 offen
    s_waitcnt lgkmcnt(4)
    buffer_store_dwordx4 v[96:99], v217, s[16:19], s41 offen
    s_waitcnt lgkmcnt(3)
    buffer_store_dwordx4 v[100:103], v218, s[16:19], s41 offen
    s_waitcnt lgkmcnt(2)
    buffer_store_dwordx4 v[104:107], v219, s[16:19], s41 offen
    s_waitcnt lgkmcnt(1)
    buffer_store_dwordx4 v[108:111], v220, s[16:19], s41 offen
    s_waitcnt lgkmcnt(0)
    buffer_store_dwordx4 v[112:115], v221, s[16:19], s41 offen
k4_kernel_end:
    s_endpgm
.globl k5_kernel
.p2align 8
.type k5_kernel,@function
k5_kernel:
    s_cmp_ge_u32 s2, 576
    s_cbranch_scc1 k5_kernel_end
    s_load_dwordx2 s[4:5], s[0:1], 72
    s_load_dwordx2 s[6:7], s[0:1], 56
    s_lshl_b32 s3, s2, 8
    v_add_u32 v1, s3, v0
    v_lshlrev_b32 v3, 4, v1
    s_waitcnt lgkmcnt(0)
    s_add_u32 s8, s4, 0x3800000
    s_addc_u32 s9, s5, 0
    s_mov_b32 s10, 0x900000
    s_mov_b32 s11, 0x20000
    s_mov_b32 s16, s6
    s_mov_b32 s17, s7
    s_mov_b32 s18, 0x240000
    s_mov_b32 s19, 0x20000
    s_mov_b32 s20, 2359296
    s_mov_b32 s21, 4718592
    s_mov_b32 s22, 7077888
    buffer_load_dwordx4 v[4:7], v3, s[8:11], 0 offen
    buffer_load_dwordx4 v[8:11], v3, s[8:11], s20 offen
    buffer_load_dwordx4 v[12:15], v3, s[8:11], s21 offen
    buffer_load_dwordx4 v[16:19], v3, s[8:11], s22 offen
    s_waitcnt vmcnt(3)
    v_lshlrev_b32 v20, 16, v4
    v_and_b32 v21, 0xffff0000, v4
    v_lshlrev_b32 v22, 16, v5
    v_and_b32 v23, 0xffff0000, v5
    v_lshlrev_b32 v24, 16, v6
    v_and_b32 v25, 0xffff0000, v6
    v_lshlrev_b32 v26, 16, v7
    v_and_b32 v27, 0xffff0000, v7
    s_waitcnt vmcnt(2)
    v_lshlrev_b32 v28, 16, v8
    v_and_b32 v29, 0xffff0000, v8
    v_lshlrev_b32 v30, 16, v9
    v_and_b32 v31, 0xffff0000, v9
    v_lshlrev_b32 v32, 16, v10
    v_and_b32 v33, 0xffff0000, v10
    v_lshlrev_b32 v34, 16, v11
    v_and_b32 v35, 0xffff0000, v11
    v_add_f32 v20, v20, v28
    v_add_f32 v21, v21, v29
    v_add_f32 v22, v22, v30
    v_add_f32 v23, v23, v31
    v_add_f32 v24, v24, v32
    v_add_f32 v25, v25, v33
    v_add_f32 v26, v26, v34
    v_add_f32 v27, v27, v35
    s_waitcnt vmcnt(1)
    v_lshlrev_b32 v28, 16, v12
    v_and_b32 v29, 0xffff0000, v12
    v_lshlrev_b32 v30, 16, v13
    v_and_b32 v31, 0xffff0000, v13
    v_lshlrev_b32 v32, 16, v14
    v_and_b32 v33, 0xffff0000, v14
    v_lshlrev_b32 v34, 16, v15
    v_and_b32 v35, 0xffff0000, v15
    v_add_f32 v20, v20, v28
    v_add_f32 v21, v21, v29
    v_add_f32 v22, v22, v30
    v_add_f32 v23, v23, v31
    v_add_f32 v24, v24, v32
    v_add_f32 v25, v25, v33
    v_add_f32 v26, v26, v34
    v_add_f32 v27, v27, v35
    s_waitcnt vmcnt(0)
    v_lshlrev_b32 v28, 16, v16
    v_and_b32 v29, 0xffff0000, v16
    v_lshlrev_b32 v30, 16, v17
    v_and_b32 v31, 0xffff0000, v17
    v_lshlrev_b32 v32, 16, v18
    v_and_b32 v33, 0xffff0000, v18
    v_lshlrev_b32 v34, 16, v19
    v_and_b32 v35, 0xffff0000, v19
    v_add_f32 v20, v20, v28
    v_add_f32 v21, v21, v29
    v_add_f32 v22, v22, v30
    v_add_f32 v23, v23, v31
    v_add_f32 v24, v24, v32
    v_add_f32 v25, v25, v33
    v_add_f32 v26, v26, v34
    v_add_f32 v27, v27, v35
    v_cvt_pk_bf16_f32 v4, v20, v21
    v_cvt_pk_bf16_f32 v5, v22, v23
    v_cvt_pk_bf16_f32 v6, v24, v25
    v_cvt_pk_bf16_f32 v7, v26, v27
    buffer_store_dwordx4 v[4:7], v3, s[16:19], 0 offen
k5_kernel_end:
    s_endpgm
.section .rodata,"a"
.p2align 6
.amdhsa_kernel k1_kernel
  .amdhsa_next_free_vgpr 248
  .amdhsa_next_free_sgpr 102
  .amdhsa_accum_offset 148
  .amdhsa_group_segment_fixed_size 0
  .amdhsa_kernarg_size 80
  .amdhsa_user_sgpr_count 2
  .amdhsa_user_sgpr_kernarg_segment_ptr 1
  .amdhsa_system_sgpr_workgroup_id_x 1
  .amdhsa_float_denorm_mode_32 3
.end_amdhsa_kernel
.p2align 6
.amdhsa_kernel k2_kernel
  .amdhsa_next_free_vgpr 256
  .amdhsa_next_free_sgpr 102
  .amdhsa_accum_offset 200
  .amdhsa_group_segment_fixed_size 0
  .amdhsa_kernarg_size 80
  .amdhsa_user_sgpr_count 2
  .amdhsa_user_sgpr_kernarg_segment_ptr 1
  .amdhsa_system_sgpr_workgroup_id_x 1
  .amdhsa_float_denorm_mode_32 3
.end_amdhsa_kernel
.p2align 6
.amdhsa_kernel k3_kernel
  .amdhsa_next_free_vgpr 512
  .amdhsa_next_free_sgpr 102
  .amdhsa_accum_offset 256
  .amdhsa_group_segment_fixed_size 0
  .amdhsa_kernarg_size 80
  .amdhsa_user_sgpr_count 2
  .amdhsa_user_sgpr_kernarg_segment_ptr 1
  .amdhsa_system_sgpr_workgroup_id_x 1
  .amdhsa_float_denorm_mode_32 3
.end_amdhsa_kernel
.p2align 6
.amdhsa_kernel k4_kernel
  .amdhsa_next_free_vgpr 232
  .amdhsa_next_free_sgpr 102
  .amdhsa_accum_offset 232
  .amdhsa_group_segment_fixed_size 0
  .amdhsa_kernarg_size 80
  .amdhsa_user_sgpr_count 2
  .amdhsa_user_sgpr_kernarg_segment_ptr 1
  .amdhsa_system_sgpr_workgroup_id_x 1
  .amdhsa_float_denorm_mode_32 3
.end_amdhsa_kernel
.p2align 6
.amdhsa_kernel k5_kernel
  .amdhsa_next_free_vgpr 40
  .amdhsa_next_free_sgpr 32
  .amdhsa_accum_offset 40
  .amdhsa_group_segment_fixed_size 0
  .amdhsa_kernarg_size 80
  .amdhsa_user_sgpr_count 2
  .amdhsa_user_sgpr_kernarg_segment_ptr 1
  .amdhsa_system_sgpr_workgroup_id_x 1
  .amdhsa_float_denorm_mode_32 3
.end_amdhsa_kernel
```
